```python
import torch

def _softmax(x, axis=-1):
    return torch.softmax(x, dim=axis)
def _gelu(x):
    return torch.nn.functional.gelu(x, approximate="tanh")
def _silu(x):
    return torch.nn.functional.silu(x)
def _sigmoid(x):
    return torch.sigmoid(x)
def _layernorm(x, axis=-1, eps=1e-5):
    m = x.mean(dim=axis, keepdim=True)
    v = x.var(dim=axis, keepdim=True, unbiased=False)
    return (x - m) / torch.sqrt(v + eps)
def _scatter_add(tgt, idx, src, axis=0):
    return tgt.clone().index_add_(axis, idx, src)
def _segment_sum(src, seg, n):
    out = torch.zeros((n,) + src.shape[1:], dtype=src.dtype)
    return out.index_add_(0, seg, src)
def _pad(x, pw):
    flat = tuple(v for pair in reversed(pw) for v in pair)
    return torch.nn.functional.pad(x, flat)

kernel_name = 'gated_mix__softmax_full_mha__mixer_s_mlp__prompt'

def setup_inputs():

    _w = (lambda a: (lambda t: t.to(torch.bfloat16) if t.is_floating_point() else t)(torch.as_tensor(a)))
    def _A_setup():
        B, S, D = 1, 2048, 512
        return {
            "x": _w((lambda *s: torch.randn(*s, dtype=torch.bfloat16) * 0.05)(B, S, D)),
            "wqkv": _w((lambda *s: torch.randn(*s, dtype=torch.bfloat16) * 1.6)(D, 3 * D)),
            "wo": _w((lambda *s: torch.randn(*s, dtype=torch.bfloat16) * 0.1)(D, D)),
        }
    _A_in = _A_setup()

    def _B_setup():
        B, S, D, F = 1, 2048, 512, 1792
        return {
            "x":  _w((lambda *s: torch.randn(*s, dtype=torch.bfloat16) * 0.05)(B, S, D)),
            "w1": _w((lambda *s: torch.randn(*s, dtype=torch.bfloat16) * 3.2)(D, D) * (D ** -0.5)),
            "w2": _w((lambda *s: torch.randn(*s, dtype=torch.bfloat16) * 3.2)(D, D) * (D ** -0.5)),
            "w3": _w((lambda *s: torch.randn(*s, dtype=torch.bfloat16) * 3.2)(D, F) * (D ** -0.5)),
            "w4": _w((lambda *s: torch.randn(*s, dtype=torch.bfloat16) * 1.6)(F, D) * (F ** -0.5)),
        }
    _B_in = _B_setup()

    return {
        "A_x": _A_in["x"],
        "A_wqkv": _A_in["wqkv"],
        "A_wo": _A_in["wo"],
        "B_x": _B_in["x"],
        "B_w1": _B_in["w1"],
        "B_w2": _B_in["w2"],
        "B_w3": _B_in["w3"],
        "B_w4": _B_in["w4"],
        "gate_w": _w((lambda *s: torch.randn(*s, dtype=torch.bfloat16) * 0.05)(512) * 16.0),
    }

def reference(A_x, A_wqkv, A_wo, B_x, B_w1, B_w2, B_w3, B_w4, gate_w):
    def _A_ref(x, wqkv, wo):
        B, S, D = x.shape
        H = 32; Dh = D // H
        qkv = (lambda x, *d: x.permute(*d))((x @ wqkv).reshape(B, S, 3, H, Dh), 2, 0, 3, 1, 4)
        q, k, v = qkv[0], qkv[1], qkv[2]
        scale = Dh ** -0.5
        scores = torch.einsum("bhqd,bhkd->bhqk", q, k) * scale
        p = _softmax(scores, axis=-1)
        o = torch.einsum("bhqk,bhkd->bhqd", p, v)
        return (lambda x, *d: x.permute(*d))(o, 0, 2, 1, 3).reshape(B, S, D) @ wo

    def _B_ref(x, w1, w2, w3, w4):
        B, S, D = x.shape
        h = _gelu(_layernorm(x, axis=-1) @ w1)
        c = D // 4
        g0 = _pad(h[:, :, 0*c:1*c], ((0, 0), (1, 0), (0, 0)))[:, :S, :]
        g1 = _pad(h[:, :, 1*c:2*c], ((0, 0), (0, 1), (0, 0)))[:, 1:, :]
        g2 = _pad(h[:, :, 2*c:3*c], ((0, 0), (2, 0), (0, 0)))[:, :S, :]
        g3 = _pad(h[:, :, 3*c:   ], ((0, 0), (0, 2), (0, 0)))[:, 2:, :]
        hs = torch.concatenate([g0, g1, g2, g3], axis=-1) @ w2
        x1 = x + hs
        h2 = _gelu(_layernorm(x1, axis=-1) @ w3) @ w4
        return x1 + h2

    x = A_x
    g = _sigmoid((x * gate_w).sum(-1, keepdims=True))
    a = _A_ref(x, A_wqkv, A_wo)
    b = _B_ref(x, B_w1, B_w2, B_w3, B_w4)
    return g * a + (1 - g) * b
```

```asm
; @launch grid=(256,1,1) block=(512,1,1) lds=163840
.amdgcn_target "amdgcn-amd-amdhsa--gfx950"
.text
.globl gated_mix__softmax_full_mha__mixer_s_mlp__prompt_kernel
.p2align 8
.type gated_mix__softmax_full_mha__mixer_s_mlp__prompt_kernel,@function
gated_mix__softmax_full_mha__mixer_s_mlp__prompt_kernel:
    s_cmp_ge_u32 s2, 256
    s_cbranch_scc1 k_end
    s_load_dwordx16 s[20:35], s[0:1], 0
    s_load_dwordx8 s[36:43], s[0:1], 64
    s_getpc_b64 s[98:99]
k_pc:
    s_lshr_b32 s47, s2, 3
    s_lshl_b32 s47, s47, 7
    v_subrev_u32 v4, 448, v0
    v_lshl_add_u32 v3, v4, 12, s47
    v_min_u32 v3, k_codeend-k_pc-4, v3
    v_cmp_gt_u32 vcc, 12, v4
    s_nop 0
    s_and_saveexec_b64 s[96:97], vcc
    s_cbranch_execz k_nocode
    global_load_dword v251, v3, s[98:99]
k_nocode:
    s_mov_b64 exec, -1
    v_lshrrev_b32 v3, 6, v0
    s_and_b32 s51, s2, 7
    s_lshr_b32 s52, s2, 3
    v_readfirstlane_b32 s44, v3
    s_and_b32 s47, s51, 3
    s_lshl_b32 s45, s47, 2
    s_and_b32 s47, s52, 3
    s_add_u32 s45, s45, s47
    s_lshr_b32 s47, s51, 2
    s_lshl_b32 s46, s47, 3
    s_lshr_b32 s47, s52, 2
    s_add_u32 s46, s46, s47
    v_and_b32 v1, 63, v0
    v_lshlrev_b32 v2, 4, v1
    s_and_b32 s101, s44, 3
    s_mov_b32 s10, 2097152
    s_mov_b32 s11, 0x00020000
    s_mov_b32 s15, 0x00020000
    s_mov_b32 s6, 268435456
    s_mov_b32 s7, 0x00020000
    v_mov_b32 v7, 133696
    v_mov_b32 v8, 1
    s_cmp_ge_u32 s44, 4
    s_cbranch_scc1 k_cons
    v_lshrrev_b32 v3, 3, v1
    v_and_b32 v4, 7, v1
    v_lshrrev_b32 v5, 4, v1
    v_xor_b32 v5, v5, v4
    s_lshl_b32 s47, s46, 7
    s_lshl_b32 s48, s101, 5
    s_add_u32 s47, s47, s48
    v_add_u32 v3, s47, v3
    v_lshlrev_b32 v3, 10, v3
    v_lshl_add_u32 v168, v5, 4, v3
    v_xor_b32 v5, 4, v5
    v_lshl_add_u32 v169, v5, 4, v3
    v_add_u32 v169, 0x2000, v169
    v_lshrrev_b32 v3, 2, v1
    s_lshl_b32 s47, s101, 4
    v_add_u32 v3, s47, v3
    v_and_b32 v4, 3, v1
    s_lshl_b32 s47, s45, 6
    v_lshl_add_u32 v4, v4, 4, s47
    v_mul_u32_u24 v170, 3072, v3
    v_add_u32 v170, v170, v4
    v_lshl_add_u32 v171, v3, 10, v4
    s_lshl_b32 s53, s52, 1
    s_lshr_b32 s49, s52, 2
    s_add_u32 s53, s53, s49
    s_and_b32 s53, s53, 7
    s_mul_i32 s54, s53, 196608
    s_lshl_b32 s53, s53, 7
    s_lshl_b32 s56, s101, 12
    s_lshl_b32 s57, s101, 10
    s_add_u32 s57, s57, 49152
    s_mov_b32 s14, 1572864
    s_waitcnt lgkmcnt(0)
    s_mov_b32 s8, s20
    s_mov_b32 s9, s21
    s_mov_b32 s12, s22
    s_mov_b32 s13, s23
    s_mov_b32 s55, 2
ld_pro:
    s_add_u32 s47, s53, 16384
    s_add_u32 m0, s56, 0
    s_nop 0
    buffer_load_dwordx4 v168, s[8:11], s53 offen lds
    s_add_u32 m0, s57, 0
    s_nop 0
    buffer_load_dwordx4 v170, s[12:15], s54 offen lds
    s_add_u32 m0, s56, 1024
    s_add_u32 s48, s54, 1024
    buffer_load_dwordx4 v169, s[8:11], s53 offen lds
    s_add_u32 m0, s57, 4096
    s_nop 0
    buffer_load_dwordx4 v170, s[12:15], s48 offen lds
    s_add_u32 m0, s56, 2048
    s_add_u32 s48, s54, 2048
    buffer_load_dwordx4 v168, s[8:11], s47 offen lds
    s_add_u32 m0, s57, 8192
    s_nop 0
    buffer_load_dwordx4 v170, s[12:15], s48 offen lds
    s_add_u32 m0, s56, 3072
    s_nop 0
    buffer_load_dwordx4 v169, s[8:11], s47 offen lds
    s_add_u32 s53, s53, 128
    s_add_u32 s54, s54, 196608
    s_cmp_eq_u32 s53, 1024
    s_cselect_b32 s53, 0, s53
    s_cselect_b32 s54, 0, s54
    s_add_u32 s56, s56, 16384
    s_add_u32 s57, s57, 12288
    s_cmp_ge_u32 s56, 49152
    s_cselect_b32 s47, 49152, 0
    s_cselect_b32 s48, 36864, 0
    s_sub_u32 s56, s56, s47
    s_sub_u32 s57, s57, s48
    s_sub_u32 s55, s55, 1
    s_cmp_lg_u32 s55, 0
    s_cbranch_scc1 ld_pro
    s_mov_b32 s4, s42
    s_mov_b32 s5, s43
    s_mov_b32 s16, s28
    s_mov_b32 s17, s29
    s_mov_b32 s18, 524288
    s_mov_b32 s19, 0x00020000
    s_lshr_b32 s47, s44, 1
    s_lshl_b32 s48, s47, 12
    s_add_u32 s48, s48, 139264
    v_add_u32 v12, s48, v2
    v_lshrrev_b32 v4, 5, v1
    v_and_b32 v5, 15, v1
    v_lshlrev_b32 v9, 8, v4
    v_lshl_add_u32 v9, v5, 4, v9
    v_mov_b32 v10, 0xdddd
    v_and_b32 v5, 31, v1
    v_cmp_eq_u32 vcc, 16, v5
    v_mov_b32 v6, 0x3f803f80
    s_and_b32 s49, s44, 1
    v_cndmask_b32 v6, 0, v6, vcc
    v_mov_b32 v148, v6
    v_mov_b32 v149, v6
    v_mov_b32 v150, v6
    v_mov_b32 v151, v6
    v_mov_b32 v152, v6
    v_mov_b32 v153, v6
    v_mov_b32 v154, v6
    v_mov_b32 v155, v6
    v_mov_b32 v160, v6
    v_mov_b32 v161, v6
    v_mov_b32 v162, v6
    v_mov_b32 v163, v6
    v_mov_b32 v164, v6
    v_mov_b32 v165, v6
    v_mov_b32 v166, v6
    v_mov_b32 v167, v6
    v_mov_b32 v172, v6
    v_mov_b32 v173, v6
    v_mov_b32 v174, v6
    v_mov_b32 v175, v6
    v_mov_b32 v176, v6
    v_mov_b32 v177, v6
    v_mov_b32 v178, v6
    v_mov_b32 v179, v6
    v_mov_b32 v184, v6
    v_mov_b32 v185, v6
    v_mov_b32 v186, v6
    v_mov_b32 v187, v6
    v_mov_b32 v188, v6
    v_mov_b32 v189, v6
    v_mov_b32 v190, v6
    v_mov_b32 v191, v6
    v_mov_b32 v196, v6
    v_mov_b32 v197, v6
    v_mov_b32 v198, v6
    v_mov_b32 v199, v6
    v_mov_b32 v200, v6
    v_mov_b32 v201, v6
    v_mov_b32 v202, v6
    v_mov_b32 v203, v6
    v_mov_b32 v208, v6
    v_mov_b32 v209, v6
    v_mov_b32 v210, v6
    v_mov_b32 v211, v6
    v_mov_b32 v212, v6
    v_mov_b32 v213, v6
    v_mov_b32 v214, v6
    v_mov_b32 v215, v6
    v_mov_b32 v220, v6
    v_mov_b32 v221, v6
    v_mov_b32 v222, v6
    v_mov_b32 v223, v6
    v_mov_b32 v224, v6
    v_mov_b32 v225, v6
    v_mov_b32 v226, v6
    v_mov_b32 v227, v6
    v_mov_b32 v232, v6
    v_mov_b32 v233, v6
    v_mov_b32 v234, v6
    v_mov_b32 v235, v6
    v_mov_b32 v236, v6
    v_mov_b32 v237, v6
    v_mov_b32 v238, v6
    v_mov_b32 v239, v6
    v_mov_b32 v248, 0x3e003e00
    v_mov_b32 v249, 0x3e003e00
    v_mov_b32 v250, 0
    v_mov_b32 v251, 0
    v_mov_b32 v254, 0
    v_mov_b32 v255, 0
    v_lshrrev_b32 v3, 1, v1
    v_and_b32 v3, 15, v3
    v_and_b32 v6, 1, v1
    v_lshl_add_u32 v3, v3, 2, v6
    v_lshlrev_b32 v3, 7, v3
    s_lshl_b32 s47, s45, 14
    s_lshl_b32 s48, s49, 8
    s_add_u32 s47, s47, s48
    s_add_u32 s47, s47, 18219008
    v_add_u32 v11, s47, v3
    s_lshl_b32 s47, s46, 7
    s_lshl_b32 s48, s49, 6
    s_add_u32 s47, s47, s48
    s_lshl_b32 s47, s47, 6
    s_add_u32 s47, s47, 18087936
    v_lshl_add_u32 v13, v5, 6, s47
    s_lshl_b32 s48, s44, 12
    s_add_u32 s48, s48, 147456
    v_add_u32 v14, s48, v2
    v_add_u32 v15, s48, v9
    v_bfe_u32 v3, v1, 4, 1
    v_lshlrev_b32 v204, 5, v3
    v_lshl_add_u32 v204, v4, 9, v204
    v_bfe_u32 v3, v1, 2, 2
    v_lshl_add_u32 v204, v3, 6, v204
    v_and_b32 v3, 3, v1
    v_lshl_add_u32 v204, v3, 3, v204
    s_lshl_b32 s47, s44, 10
    s_add_u32 s47, s47, 98304
    v_add_u32 v204, s47, v204
    v_lshlrev_b32 v205, 2, v1
    v_add_u32 v205, 133120, v205
    v_mov_b32 v206, 133632
    v_mov_b32 v124, 0x3f803f80
    v_mov_b32 v125, 0x3f803f80
    v_mov_b32 v126, 0x3f803f80
    v_mov_b32 v127, 0x3f803f80
    v_mov_b32 v40, 0
    v_mov_b32 v41, 0
    v_mov_b32 v42, 0
    v_mov_b32 v43, 0
    v_mov_b32 v44, 0
    v_mov_b32 v45, 0
    v_mov_b32 v46, 0
    v_mov_b32 v47, 0
    v_and_b32 v3, 31, v1
    s_lshl_b32 s47, s101, 5
    v_add_u32 v3, s47, v3
    v_bfe_u32 v4, v3, 1, 3
    v_lshrrev_b32 v5, 5, v1
    v_xor_b32 v4, v4, v5
    v_lshlrev_b32 v4, 4, v4
    v_lshl_add_u32 v192, v3, 7, v4
    v_xor_b32 v193, 32, v192
    v_xor_b32 v194, 64, v192
    v_xor_b32 v195, 96, v192
    v_mov_b32 v24, 0
    v_mov_b32 v25, 0
    v_mov_b32 v26, 0x3f803f80
    s_mov_b32 s58, 0
    s_mov_b32 s55, 8
ld_loop:
    v_add_u32 v180, s58, v192
    v_add_u32 v181, s58, v193
    v_add_u32 v182, s58, v194
    v_add_u32 v183, s58, v195
    s_add_u32 s58, s58, 16384
    s_cmp_ge_u32 s58, 49152
    s_cselect_b32 s58, 0, s58
    s_waitcnt vmcnt(7)
    s_barrier
    ds_read_b128 v[48:51], v180
    ds_read_b128 v[52:55], v181
    ds_read_b128 v[56:59], v182
    ds_read_b128 v[60:63], v183
    s_add_u32 s47, s53, 16384
    s_add_u32 m0, s56, 0
    s_nop 0
    buffer_load_dwordx4 v168, s[8:11], s53 offen lds
    s_add_u32 m0, s57, 0
    s_nop 0
    buffer_load_dwordx4 v170, s[12:15], s54 offen lds
    s_add_u32 m0, s56, 1024
    s_add_u32 s48, s54, 1024
    buffer_load_dwordx4 v169, s[8:11], s53 offen lds
    s_add_u32 m0, s57, 4096
    s_nop 0
    buffer_load_dwordx4 v170, s[12:15], s48 offen lds
    s_add_u32 m0, s56, 2048
    s_add_u32 s48, s54, 2048
    buffer_load_dwordx4 v168, s[8:11], s47 offen lds
    s_add_u32 m0, s57, 8192
    s_nop 0
    buffer_load_dwordx4 v170, s[12:15], s48 offen lds
    s_add_u32 m0, s56, 3072
    s_nop 0
    buffer_load_dwordx4 v169, s[8:11], s47 offen lds
    s_add_u32 s53, s53, 128
    s_add_u32 s54, s54, 196608
    s_cmp_eq_u32 s53, 1024
    s_cselect_b32 s53, 0, s53
    s_cselect_b32 s54, 0, s54
    s_add_u32 s56, s56, 16384
    s_add_u32 s57, s57, 12288
    s_cmp_ge_u32 s56, 49152
    s_cselect_b32 s47, 49152, 0
    s_cselect_b32 s48, 36864, 0
    s_sub_u32 s56, s56, s47
    s_sub_u32 s57, s57, s48
    s_waitcnt lgkmcnt(0)
    v_dot2c_f32_bf16 v24, v48, v26
    v_dot2c_f32_bf16 v25, v48, v48
    v_dot2c_f32_bf16 v24, v49, v26
    v_dot2c_f32_bf16 v25, v49, v49
    v_dot2c_f32_bf16 v24, v50, v26
    v_dot2c_f32_bf16 v25, v50, v50
    v_dot2c_f32_bf16 v24, v51, v26
    v_dot2c_f32_bf16 v25, v51, v51
    v_dot2c_f32_bf16 v24, v52, v26
    v_dot2c_f32_bf16 v25, v52, v52
    v_dot2c_f32_bf16 v24, v53, v26
    v_dot2c_f32_bf16 v25, v53, v53
    v_dot2c_f32_bf16 v24, v54, v26
    v_dot2c_f32_bf16 v25, v54, v54
    v_dot2c_f32_bf16 v24, v55, v26
    v_dot2c_f32_bf16 v25, v55, v55
    v_dot2c_f32_bf16 v24, v56, v26
    v_dot2c_f32_bf16 v25, v56, v56
    v_dot2c_f32_bf16 v24, v57, v26
    v_dot2c_f32_bf16 v25, v57, v57
    v_dot2c_f32_bf16 v24, v58, v26
    v_dot2c_f32_bf16 v25, v58, v58
    v_dot2c_f32_bf16 v24, v59, v26
    v_dot2c_f32_bf16 v25, v59, v59
    v_dot2c_f32_bf16 v24, v60, v26
    v_dot2c_f32_bf16 v25, v60, v60
    v_dot2c_f32_bf16 v24, v61, v26
    v_dot2c_f32_bf16 v25, v61, v61
    v_dot2c_f32_bf16 v24, v62, v26
    v_dot2c_f32_bf16 v25, v62, v62
    v_dot2c_f32_bf16 v24, v63, v26
    v_dot2c_f32_bf16 v25, v63, v63
    s_sub_u32 s55, s55, 1
    s_cmp_lg_u32 s55, 2
    s_cbranch_scc1 ld_loop
    s_lshl_b32 s57, s101, 10
    s_add_u32 s57, s57, 98304
    s_lshl_b32 s54, s53, 9
    s_mov_b32 m0, s57
    s_add_u32 s57, s57, 4096
    buffer_load_dwordx4 v171, s[16:19], s54 offen lds
    s_add_u32 s54, s54, 65536
    s_and_b32 s54, s54, 0x7ffff
    s_mov_b32 m0, s57
    s_add_u32 s57, s57, 4096
    buffer_load_dwordx4 v171, s[16:19], s54 offen lds
    s_add_u32 s54, s54, 65536
    s_and_b32 s54, s54, 0x7ffff
    s_mov_b32 m0, s57
    s_add_u32 s57, s57, 4096
    buffer_load_dwordx4 v171, s[16:19], s54 offen lds
    s_add_u32 s54, s54, 65536
    s_and_b32 s54, s54, 0x7ffff
    v_add_u32 v180, s58, v192
    v_add_u32 v181, s58, v193
    v_add_u32 v182, s58, v194
    v_add_u32 v183, s58, v195
    s_add_u32 s58, s58, 16384
    s_cmp_ge_u32 s58, 49152
    s_cselect_b32 s58, 0, s58
    s_waitcnt vmcnt(10)
    s_barrier
    ds_read_b128 v[48:51], v180
    ds_read_b128 v[52:55], v181
    ds_read_b128 v[56:59], v182
    ds_read_b128 v[60:63], v183
    s_mov_b32 m0, s57
    s_add_u32 s57, s57, 4096
    buffer_load_dwordx4 v171, s[16:19], s54 offen lds
    s_add_u32 s54, s54, 65536
    s_and_b32 s54, s54, 0x7ffff
    s_mov_b32 m0, s57
    s_add_u32 s57, s57, 4096
    buffer_load_dwordx4 v171, s[16:19], s54 offen lds
    s_add_u32 s54, s54, 65536
    s_and_b32 s54, s54, 0x7ffff
    s_mov_b32 m0, s57
    s_add_u32 s57, s57, 4096
    buffer_load_dwordx4 v171, s[16:19], s54 offen lds
    s_add_u32 s54, s54, 65536
    s_and_b32 s54, s54, 0x7ffff
    s_mov_b32 m0, s57
    s_add_u32 s57, s57, 4096
    buffer_load_dwordx4 v171, s[16:19], s54 offen lds
    s_add_u32 s54, s54, 65536
    s_and_b32 s54, s54, 0x7ffff
    s_mov_b32 m0, s57
    s_add_u32 s57, s57, 4096
    buffer_load_dwordx4 v171, s[16:19], s54 offen lds
    s_add_u32 s54, s54, 65536
    s_and_b32 s54, s54, 0x7ffff
    s_waitcnt lgkmcnt(0)
    v_dot2c_f32_bf16 v24, v48, v26
    v_dot2c_f32_bf16 v25, v48, v48
    v_dot2c_f32_bf16 v24, v49, v26
    v_dot2c_f32_bf16 v25, v49, v49
    v_dot2c_f32_bf16 v24, v50, v26
    v_dot2c_f32_bf16 v25, v50, v50
    v_dot2c_f32_bf16 v24, v51, v26
    v_dot2c_f32_bf16 v25, v51, v51
    v_dot2c_f32_bf16 v24, v52, v26
    v_dot2c_f32_bf16 v25, v52, v52
    v_dot2c_f32_bf16 v24, v53, v26
    v_dot2c_f32_bf16 v25, v53, v53
    v_dot2c_f32_bf16 v24, v54, v26
    v_dot2c_f32_bf16 v25, v54, v54
    v_dot2c_f32_bf16 v24, v55, v26
    v_dot2c_f32_bf16 v25, v55, v55
    v_dot2c_f32_bf16 v24, v56, v26
    v_dot2c_f32_bf16 v25, v56, v56
    v_dot2c_f32_bf16 v24, v57, v26
    v_dot2c_f32_bf16 v25, v57, v57
    v_dot2c_f32_bf16 v24, v58, v26
    v_dot2c_f32_bf16 v25, v58, v58
    v_dot2c_f32_bf16 v24, v59, v26
    v_dot2c_f32_bf16 v25, v59, v59
    v_dot2c_f32_bf16 v24, v60, v26
    v_dot2c_f32_bf16 v25, v60, v60
    v_dot2c_f32_bf16 v24, v61, v26
    v_dot2c_f32_bf16 v25, v61, v61
    v_dot2c_f32_bf16 v24, v62, v26
    v_dot2c_f32_bf16 v25, v62, v62
    v_dot2c_f32_bf16 v24, v63, v26
    v_dot2c_f32_bf16 v25, v63, v63
    s_sub_u32 s55, s55, 1
    v_add_u32 v180, s58, v192
    v_add_u32 v181, s58, v193
    v_add_u32 v182, s58, v194
    v_add_u32 v183, s58, v195
    s_add_u32 s58, s58, 16384
    s_cmp_ge_u32 s58, 49152
    s_cselect_b32 s58, 0, s58
    s_waitcnt vmcnt(8)
    s_barrier
    ds_read_b128 v[48:51], v180
    ds_read_b128 v[52:55], v181
    ds_read_b128 v[56:59], v182
    ds_read_b128 v[60:63], v183
    s_waitcnt lgkmcnt(0)
    v_dot2c_f32_bf16 v24, v48, v26
    v_dot2c_f32_bf16 v25, v48, v48
    v_dot2c_f32_bf16 v24, v49, v26
    v_dot2c_f32_bf16 v25, v49, v49
    v_dot2c_f32_bf16 v24, v50, v26
    v_dot2c_f32_bf16 v25, v50, v50
    v_dot2c_f32_bf16 v24, v51, v26
    v_dot2c_f32_bf16 v25, v51, v51
    v_dot2c_f32_bf16 v24, v52, v26
    v_dot2c_f32_bf16 v25, v52, v52
    v_dot2c_f32_bf16 v24, v53, v26
    v_dot2c_f32_bf16 v25, v53, v53
    v_dot2c_f32_bf16 v24, v54, v26
    v_dot2c_f32_bf16 v25, v54, v54
    v_dot2c_f32_bf16 v24, v55, v26
    v_dot2c_f32_bf16 v25, v55, v55
    v_dot2c_f32_bf16 v24, v56, v26
    v_dot2c_f32_bf16 v25, v56, v56
    v_dot2c_f32_bf16 v24, v57, v26
    v_dot2c_f32_bf16 v25, v57, v57
    v_dot2c_f32_bf16 v24, v58, v26
    v_dot2c_f32_bf16 v25, v58, v58
    v_dot2c_f32_bf16 v24, v59, v26
    v_dot2c_f32_bf16 v25, v59, v59
    v_dot2c_f32_bf16 v24, v60, v26
    v_dot2c_f32_bf16 v25, v60, v60
    v_dot2c_f32_bf16 v24, v61, v26
    v_dot2c_f32_bf16 v25, v61, v61
    v_dot2c_f32_bf16 v24, v62, v26
    v_dot2c_f32_bf16 v25, v62, v62
    v_dot2c_f32_bf16 v24, v63, v26
    v_dot2c_f32_bf16 v25, v63, v63
    s_sub_u32 s55, s55, 1
    s_lshl_b32 s47, s101, 8
    s_add_u32 s47, s47, 131072
    v_and_b32 v3, 31, v1
    v_lshl_add_u32 v4, v3, 3, s47
    v_mov_b32 v5, v24
    v_mov_b32 v6, v25
    s_nop 1
    v_permlane32_swap_b32 v5, v24
    v_permlane32_swap_b32 v6, v25
    s_nop 0
    v_add_f32 v24, v24, v5
    v_add_f32 v25, v25, v6
    ds_write_b64 v4, v[24:25]
    s_and_b32 s54, s44, 1
    s_lshr_b32 s47, s44, 1
    s_lshl_b32 s53, s45, 1
    s_add_u32 s53, s53, s47
    s_mov_b32 s60, 0xffff
    s_mov_b32 s61, 0xffff
    s_lshl_b32 s47, s53, 17
    s_lshl_b32 s48, s54, 16
    s_add_u32 s47, s47, s48
    s_add_u32 s12, s42, s47
    s_addc_u32 s13, s43, 0
    s_mov_b32 s14, 65536
    s_mov_b32 s15, 0x00020000
    s_lshl_b32 s55, s46, 12
    s_mov_b32 s56, 0
    s_waitcnt vmcnt(0)
    ds_read_b64_tr_b16 v[64:65], v204 offset:0
    ds_read_b64_tr_b16 v[66:67], v204 offset:256
    ds_read_b64_tr_b16 v[68:69], v204 offset:4096
    ds_read_b64_tr_b16 v[70:71], v204 offset:4352
    ds_read_b64_tr_b16 v[72:73], v204 offset:8192
    ds_read_b64_tr_b16 v[74:75], v204 offset:8448
    ds_read_b64_tr_b16 v[76:77], v204 offset:12288
    ds_read_b64_tr_b16 v[78:79], v204 offset:12544
    ds_read_b64_tr_b16 v[80:81], v204 offset:16384
    ds_read_b64_tr_b16 v[82:83], v204 offset:16640
    ds_read_b64_tr_b16 v[84:85], v204 offset:20480
    ds_read_b64_tr_b16 v[86:87], v204 offset:20736
    ds_read_b64_tr_b16 v[88:89], v204 offset:24576
    ds_read_b64_tr_b16 v[90:91], v204 offset:24832
    ds_read_b64_tr_b16 v[92:93], v204 offset:28672
    ds_read_b64_tr_b16 v[94:95], v204 offset:28928
    s_waitcnt lgkmcnt(14)
    v_mfma_f32_32x32x16_bf16 v[96:111], v[124:127], v[64:67], 0
    s_waitcnt lgkmcnt(12)
    v_mfma_f32_32x32x16_bf16 v[96:111], v[124:127], v[68:71], v[96:111]
    s_waitcnt lgkmcnt(10)
    v_mfma_f32_32x32x16_bf16 v[96:111], v[124:127], v[72:75], v[96:111]
    s_waitcnt lgkmcnt(8)
    v_mfma_f32_32x32x16_bf16 v[96:111], v[124:127], v[76:79], v[96:111]
    s_waitcnt lgkmcnt(6)
    v_mfma_f32_32x32x16_bf16 v[96:111], v[124:127], v[80:83], v[96:111]
    s_waitcnt lgkmcnt(4)
    v_mfma_f32_32x32x16_bf16 v[96:111], v[124:127], v[84:87], v[96:111]
    s_waitcnt lgkmcnt(2)
    v_mfma_f32_32x32x16_bf16 v[96:111], v[124:127], v[88:91], v[96:111]
    s_waitcnt lgkmcnt(0)
    v_mfma_f32_32x32x16_bf16 v[96:111], v[124:127], v[92:95], v[96:111]
    s_nop 10
    s_mov_b32 exec_hi, 0
    ds_add_f32 v205, v96
    s_mov_b32 exec_hi, -1
    s_waitcnt lgkmcnt(0)
    s_mov_b64 exec, 1
    ds_add_u32 v7, v8 offset:60
    s_mov_b64 exec, -1
    s_mov_b32 s49, 1600000
z_lw1:
    ds_read_b32 v3, v7 offset:56
    s_waitcnt lgkmcnt(0)
    v_readfirstlane_b32 s48, v3
    s_nop 1
    s_cmp_ge_u32 s48, 4
    s_cbranch_scc1 z_lwd2
    s_sleep 1
    s_sub_u32 s49, s49, 1
    s_cmp_lg_u32 s49, 0
    s_cbranch_scc1 z_lw1
z_lwd2:
    s_setprio 3
    ds_read_b128 v[144:147], v14
    ds_read_b128 v[128:131], v12 offset:0
    ds_read_b128 v[132:135], v12 offset:1024
    ds_read_b128 v[136:139], v12 offset:2048
    ds_read_b128 v[140:143], v12 offset:3072
    ds_read_b32 v6, v206
    ds_read_b128 v[156:159], v14 offset:2048
    s_mov_b64 exec, s[60:61]
    ds_read_b128 v[148:151], v15 offset:1024
    ds_read_b128 v[152:155], v15 offset:1536
    ds_read_b128 v[160:163], v15 offset:3072
    ds_read_b128 v[164:167], v15 offset:3584
    s_mov_b64 exec, -1
    s_waitcnt lgkmcnt(6)
    v_mfma_f32_32x32x16_bf16 v[48:63], v[144:147], v[128:131], 0
    v_mfma_f32_32x32x16_bf16 v[64:79], v[144:147], v[132:135], 0
    v_mfma_f32_32x32x16_bf16 v[80:95], v[144:147], v[136:139], 0
    v_mfma_f32_32x32x16_bf16 v[96:111], v[144:147], v[140:143], 0
    s_waitcnt lgkmcnt(0)
    s_mov_b64 exec, 1
    ds_add_u32 v7, v8 offset:40
    s_mov_b64 exec, -1
    v_readfirstlane_b32 s50, v6
    s_nop 3
    v_max3_f32 v240, v48, v49, v50
    v_max3_f32 v240, v240, v51, v52
    v_max3_f32 v240, v240, v53, v54
    v_max3_f32 v240, v240, v55, v56
    v_max3_f32 v240, v240, v57, v58
    v_max3_f32 v240, v240, v59, v60
    v_max3_f32 v240, v240, v61, v62
    v_max_f32 v240, v240, v63
    v_max3_f32 v241, v64, v65, v66
    v_max3_f32 v241, v241, v67, v68
    v_max3_f32 v241, v241, v69, v70
    v_max3_f32 v241, v241, v71, v72
    v_max3_f32 v241, v241, v73, v74
    v_max3_f32 v241, v241, v75, v76
    v_max3_f32 v241, v241, v77, v78
    v_max_f32 v241, v241, v79
    v_max3_f32 v242, v80, v81, v82
    v_max3_f32 v242, v242, v83, v84
    v_max3_f32 v242, v242, v85, v86
    v_max3_f32 v242, v242, v87, v88
    v_max3_f32 v242, v242, v89, v90
    v_max3_f32 v242, v242, v91, v92
    v_max3_f32 v242, v242, v93, v94
    v_max_f32 v242, v242, v95
    v_max3_f32 v243, v96, v97, v98
    v_max3_f32 v243, v243, v99, v100
    v_max3_f32 v243, v243, v101, v102
    v_max3_f32 v243, v243, v103, v104
    v_max3_f32 v243, v243, v105, v106
    v_max3_f32 v243, v243, v107, v108
    v_max3_f32 v243, v243, v109, v110
    v_max_f32 v243, v243, v111
    v_cvt_pk_bf16_f32 v252, -v240, -v241
    v_cvt_pk_bf16_f32 v253, -v242, -v243
    s_nop 1
    v_mfma_f32_32x32x16_bf16 v[112:127], v[248:251], v[252:255], 0
    v_mfma_f32_32x32x16_bf16 v[48:63], v[40:43], v[40:43], 0
    v_mfma_f32_32x32x16_bf16 v[64:79], v[40:43], v[40:43], 0
    v_mfma_f32_32x32x16_bf16 v[80:95], v[40:43], v[40:43], 0
    v_mfma_f32_32x32x16_bf16 v[96:111], v[40:43], v[40:43], 0
    s_nop 5
    v_mfma_f32_32x32x16_bf16 v[16:31], v[144:147], v[128:131], v[112:127]
    s_setprio 0
    s_nop 11
    v_exp_f32 v16, v16
    v_exp_f32 v17, v17
    v_smfmac_f32_32x32x32_bf16 v[96:111], v[236:239], v[40:47], v10
    v_exp_f32 v18, v18
    v_exp_f32 v19, v19
    v_exp_f32 v20, v20
    v_mfma_f32_32x32x16_bf16 v[32:47], v[144:147], v[132:135], v[112:127]
    v_exp_f32 v21, v21
    v_exp_f32 v22, v22
    v_exp_f32 v23, v23
    v_exp_f32 v24, v24
    v_exp_f32 v25, v25
    v_smfmac_f32_32x32x32_bf16 v[48:63], v[148:151], v[16:23], v10
    v_exp_f32 v26, v26
    v_exp_f32 v27, v27
    v_exp_f32 v28, v28
    v_exp_f32 v29, v29
    v_exp_f32 v30, v30
    v_exp_f32 v31, v31
    v_exp_f32 v32, v32
    v_exp_f32 v33, v33
    v_smfmac_f32_32x32x32_bf16 v[48:63], v[152:155], v[24:31], v10
    v_exp_f32 v34, v34
    v_exp_f32 v35, v35
    v_exp_f32 v36, v36
    v_mfma_f32_32x32x16_bf16 v[16:31], v[144:147], v[136:139], v[112:127]
    v_exp_f32 v37, v37
    v_exp_f32 v38, v38
    v_exp_f32 v39, v39
    v_exp_f32 v40, v40
    v_exp_f32 v41, v41
    v_smfmac_f32_32x32x32_bf16 v[64:79], v[148:151], v[32:39], v10
    v_exp_f32 v42, v42
    v_exp_f32 v43, v43
    v_exp_f32 v44, v44
    v_exp_f32 v45, v45
    v_exp_f32 v46, v46
    v_exp_f32 v47, v47
    s_mov_b32 s49, 200000
z_poll3:
    buffer_load_dword v12, v11, s[4:7], 0 offen sc1
z_pchk5:
    s_waitcnt vmcnt(0)
    v_cmp_ne_u32 vcc, s50, v12
    s_nop 1
    s_and_b32 vcc_lo, vcc_lo, vcc_lo
    s_cbranch_scc0 z_pdone4
    s_sleep 2
    s_sub_u32 s49, s49, 1
    s_cmp_lg_u32 s49, 0
    s_cbranch_scc1 z_poll3
z_pdone4:
    s_add_u32 s55, s55, 4096
    s_and_b32 s55, s55, 0xffff
    s_setprio 3
    buffer_load_dwordx4 v[168:171], v2, s[12:15], s55 offen sc1
    buffer_load_dwordx4 v[180:183], v2, s[12:15], s55 offen offset:2048 sc1
    s_mov_b64 exec, s[60:61]
    buffer_load_dwordx4 v[172:175], v9, s[12:15], s55 offen offset:1024 sc1
    buffer_load_dwordx4 v[176:179], v9, s[12:15], s55 offen offset:1536 sc1
    buffer_load_dwordx4 v[184:187], v9, s[12:15], s55 offen offset:3072 sc1
    buffer_load_dwordx4 v[188:191], v9, s[12:15], s55 offen offset:3584 sc1
    s_mov_b64 exec, -1
    s_setprio 0
    v_exp_f32 v16, v16
    v_exp_f32 v17, v17
    v_smfmac_f32_32x32x32_bf16 v[64:79], v[152:155], v[40:47], v10
    v_exp_f32 v18, v18
    v_exp_f32 v19, v19
    v_exp_f32 v20, v20
    v_mfma_f32_32x32x16_bf16 v[32:47], v[144:147], v[140:143], v[112:127]
    v_exp_f32 v21, v21
    v_exp_f32 v22, v22
    v_exp_f32 v23, v23
    v_exp_f32 v24, v24
    v_exp_f32 v25, v25
    v_smfmac_f32_32x32x32_bf16 v[80:95], v[148:151], v[16:23], v10
    v_exp_f32 v26, v26
    v_exp_f32 v27, v27
    v_exp_f32 v28, v28
    v_exp_f32 v29, v29
    v_exp_f32 v30, v30
    v_exp_f32 v31, v31
    v_exp_f32 v32, v32
    v_exp_f32 v33, v33
    v_smfmac_f32_32x32x32_bf16 v[80:95], v[152:155], v[24:31], v10
    v_exp_f32 v34, v34
    v_exp_f32 v35, v35
    v_exp_f32 v36, v36
    v_mfma_f32_32x32x16_bf16 v[16:31], v[156:159], v[128:131], v[112:127]
    v_exp_f32 v37, v37
    v_exp_f32 v38, v38
    v_exp_f32 v39, v39
    v_exp_f32 v40, v40
    v_exp_f32 v41, v41
    v_smfmac_f32_32x32x32_bf16 v[96:111], v[148:151], v[32:39], v10
    v_exp_f32 v42, v42
    v_exp_f32 v43, v43
    v_exp_f32 v44, v44
    v_exp_f32 v45, v45
    v_exp_f32 v46, v46
    v_exp_f32 v47, v47
    v_exp_f32 v16, v16
    v_exp_f32 v17, v17
    v_smfmac_f32_32x32x32_bf16 v[96:111], v[152:155], v[40:47], v10
    v_exp_f32 v18, v18
    v_exp_f32 v19, v19
    v_exp_f32 v20, v20
    v_mfma_f32_32x32x16_bf16 v[32:47], v[156:159], v[132:135], v[112:127]
    v_exp_f32 v21, v21
    v_exp_f32 v22, v22
    v_exp_f32 v23, v23
    v_exp_f32 v24, v24
    v_exp_f32 v25, v25
    v_smfmac_f32_32x32x32_bf16 v[48:63], v[160:163], v[16:23], v10
    v_exp_f32 v26, v26
    v_exp_f32 v27, v27
    v_exp_f32 v28, v28
    v_exp_f32 v29, v29
    v_exp_f32 v30, v30
    v_exp_f32 v31, v31
    v_exp_f32 v32, v32
    v_exp_f32 v33, v33
    v_smfmac_f32_32x32x32_bf16 v[48:63], v[164:167], v[24:31], v10
    v_exp_f32 v34, v34
    v_exp_f32 v35, v35
    v_exp_f32 v36, v36
    v_mfma_f32_32x32x16_bf16 v[16:31], v[156:159], v[136:139], v[112:127]
    v_exp_f32 v37, v37
    v_exp_f32 v38, v38
    v_exp_f32 v39, v39
    v_exp_f32 v40, v40
    v_exp_f32 v41, v41
    v_smfmac_f32_32x32x32_bf16 v[64:79], v[160:163], v[32:39], v10
    v_exp_f32 v42, v42
    v_exp_f32 v43, v43
    v_exp_f32 v44, v44
    s_add_u32 s55, s55, 4096
    s_and_b32 s55, s55, 0xffff
    s_setprio 3
    buffer_load_dwordx4 v[192:195], v2, s[12:15], s55 offen sc1
    buffer_load_dwordx4 v[204:207], v2, s[12:15], s55 offen offset:2048 sc1
    s_mov_b64 exec, s[60:61]
    buffer_load_dwordx4 v[196:199], v9, s[12:15], s55 offen offset:1024 sc1
    buffer_load_dwordx4 v[200:203], v9, s[12:15], s55 offen offset:1536 sc1
    buffer_load_dwordx4 v[208:211], v9, s[12:15], s55 offen offset:3072 sc1
    buffer_load_dwordx4 v[212:215], v9, s[12:15], s55 offen offset:3584 sc1
    s_mov_b64 exec, -1
    s_setprio 0
    v_exp_f32 v45, v45
    v_exp_f32 v46, v46
    v_exp_f32 v47, v47
    v_exp_f32 v16, v16
    v_exp_f32 v17, v17
    v_smfmac_f32_32x32x32_bf16 v[64:79], v[164:167], v[40:47], v10
    v_exp_f32 v18, v18
    v_exp_f32 v19, v19
    v_exp_f32 v20, v20
    v_mfma_f32_32x32x16_bf16 v[32:47], v[156:159], v[140:143], v[112:127]
    v_exp_f32 v21, v21
    v_exp_f32 v22, v22
    v_exp_f32 v23, v23
    v_exp_f32 v24, v24
    v_exp_f32 v25, v25
    v_smfmac_f32_32x32x32_bf16 v[80:95], v[160:163], v[16:23], v10
    v_exp_f32 v26, v26
    v_exp_f32 v27, v27
    v_exp_f32 v28, v28
    v_exp_f32 v29, v29
    v_exp_f32 v30, v30
    v_exp_f32 v31, v31
    v_exp_f32 v32, v32
    v_exp_f32 v33, v33
    v_smfmac_f32_32x32x32_bf16 v[80:95], v[164:167], v[24:31], v10
    v_exp_f32 v34, v34
    v_exp_f32 v35, v35
    v_exp_f32 v36, v36
    s_waitcnt vmcnt(6)
    v_mfma_f32_32x32x16_bf16 v[16:31], v[168:171], v[128:131], v[112:127]
    v_exp_f32 v37, v37
    v_exp_f32 v38, v38
    v_exp_f32 v39, v39
    v_exp_f32 v40, v40
    v_exp_f32 v41, v41
    v_smfmac_f32_32x32x32_bf16 v[96:111], v[160:163], v[32:39], v10
    v_exp_f32 v42, v42
    v_exp_f32 v43, v43
    v_exp_f32 v44, v44
    v_exp_f32 v45, v45
    v_exp_f32 v46, v46
    v_exp_f32 v47, v47
    v_exp_f32 v16, v16
    v_exp_f32 v17, v17
    v_smfmac_f32_32x32x32_bf16 v[96:111], v[164:167], v[40:47], v10
    v_exp_f32 v18, v18
    v_exp_f32 v19, v19
    v_exp_f32 v20, v20
    v_mfma_f32_32x32x16_bf16 v[32:47], v[168:171], v[132:135], v[112:127]
    v_exp_f32 v21, v21
    v_exp_f32 v22, v22
    v_exp_f32 v23, v23
    v_exp_f32 v24, v24
    v_exp_f32 v25, v25
    v_smfmac_f32_32x32x32_bf16 v[48:63], v[172:175], v[16:23], v10
    v_exp_f32 v26, v26
    v_exp_f32 v27, v27
    v_exp_f32 v28, v28
    v_exp_f32 v29, v29
    v_exp_f32 v30, v30
    v_exp_f32 v31, v31
    v_exp_f32 v32, v32
    v_exp_f32 v33, v33
    v_smfmac_f32_32x32x32_bf16 v[48:63], v[176:179], v[24:31], v10
    v_exp_f32 v34, v34
    v_exp_f32 v35, v35
    v_exp_f32 v36, v36
    v_mfma_f32_32x32x16_bf16 v[16:31], v[168:171], v[136:139], v[112:127]
    v_exp_f32 v37, v37
    v_exp_f32 v38, v38
    v_exp_f32 v39, v39
    v_exp_f32 v40, v40
    v_exp_f32 v41, v41
    v_smfmac_f32_32x32x32_bf16 v[64:79], v[172:175], v[32:39], v10
    v_exp_f32 v42, v42
    v_exp_f32 v43, v43
    v_exp_f32 v44, v44
    s_add_u32 s55, s55, 4096
    s_and_b32 s55, s55, 0xffff
    s_setprio 3
    buffer_load_dwordx4 v[216:219], v2, s[12:15], s55 offen sc1
    buffer_load_dwordx4 v[228:231], v2, s[12:15], s55 offen offset:2048 sc1
    s_mov_b64 exec, s[60:61]
    buffer_load_dwordx4 v[220:223], v9, s[12:15], s55 offen offset:1024 sc1
    buffer_load_dwordx4 v[224:227], v9, s[12:15], s55 offen offset:1536 sc1
    buffer_load_dwordx4 v[232:235], v9, s[12:15], s55 offen offset:3072 sc1
    buffer_load_dwordx4 v[236:239], v9, s[12:15], s55 offen offset:3584 sc1
    s_mov_b64 exec, -1
    s_setprio 0
    v_exp_f32 v45, v45
    v_exp_f32 v46, v46
    v_exp_f32 v47, v47
    v_exp_f32 v16, v16
    v_exp_f32 v17, v17
    v_smfmac_f32_32x32x32_bf16 v[64:79], v[176:179], v[40:47], v10
    v_exp_f32 v18, v18
    v_exp_f32 v19, v19
    v_exp_f32 v20, v20
    v_mfma_f32_32x32x16_bf16 v[32:47], v[168:171], v[140:143], v[112:127]
    v_exp_f32 v21, v21
    v_exp_f32 v22, v22
    v_exp_f32 v23, v23
    v_exp_f32 v24, v24
    v_exp_f32 v25, v25
    v_smfmac_f32_32x32x32_bf16 v[80:95], v[172:175], v[16:23], v10
    v_exp_f32 v26, v26
    v_exp_f32 v27, v27
    v_exp_f32 v28, v28
    v_exp_f32 v29, v29
    v_exp_f32 v30, v30
    v_exp_f32 v31, v31
    v_exp_f32 v32, v32
    v_exp_f32 v33, v33
    v_smfmac_f32_32x32x32_bf16 v[80:95], v[176:179], v[24:31], v10
    v_exp_f32 v34, v34
    v_exp_f32 v35, v35
    v_exp_f32 v36, v36
    v_mfma_f32_32x32x16_bf16 v[16:31], v[180:183], v[128:131], v[112:127]
    v_exp_f32 v37, v37
    v_exp_f32 v38, v38
    v_exp_f32 v39, v39
    v_exp_f32 v40, v40
    v_exp_f32 v41, v41
    v_smfmac_f32_32x32x32_bf16 v[96:111], v[172:175], v[32:39], v10
    v_exp_f32 v42, v42
    v_exp_f32 v43, v43
    v_exp_f32 v44, v44
    v_exp_f32 v45, v45
    v_exp_f32 v46, v46
    v_exp_f32 v47, v47
    v_exp_f32 v16, v16
    v_exp_f32 v17, v17
    v_smfmac_f32_32x32x32_bf16 v[96:111], v[176:179], v[40:47], v10
    v_exp_f32 v18, v18
    v_exp_f32 v19, v19
    v_exp_f32 v20, v20
    v_mfma_f32_32x32x16_bf16 v[32:47], v[180:183], v[132:135], v[112:127]
    v_exp_f32 v21, v21
    v_exp_f32 v22, v22
    v_exp_f32 v23, v23
    v_exp_f32 v24, v24
    v_exp_f32 v25, v25
    v_smfmac_f32_32x32x32_bf16 v[48:63], v[184:187], v[16:23], v10
    v_exp_f32 v26, v26
    v_exp_f32 v27, v27
    v_exp_f32 v28, v28
    v_exp_f32 v29, v29
    v_exp_f32 v30, v30
    v_exp_f32 v31, v31
    v_exp_f32 v32, v32
    v_exp_f32 v33, v33
    v_smfmac_f32_32x32x32_bf16 v[48:63], v[188:191], v[24:31], v10
    v_exp_f32 v34, v34
    v_exp_f32 v35, v35
    v_exp_f32 v36, v36
    v_mfma_f32_32x32x16_bf16 v[16:31], v[180:183], v[136:139], v[112:127]
    v_exp_f32 v37, v37
    v_exp_f32 v38, v38
    v_exp_f32 v39, v39
    v_exp_f32 v40, v40
    v_exp_f32 v41, v41
    v_smfmac_f32_32x32x32_bf16 v[64:79], v[184:187], v[32:39], v10
    v_exp_f32 v42, v42
    v_exp_f32 v43, v43
    v_exp_f32 v44, v44
    s_add_u32 s55, s55, 4096
    s_and_b32 s55, s55, 0xffff
    s_setprio 3
    buffer_load_dwordx4 v[144:147], v2, s[12:15], s55 offen sc1
    buffer_load_dwordx4 v[156:159], v2, s[12:15], s55 offen offset:2048 sc1
    s_mov_b64 exec, s[60:61]
    buffer_load_dwordx4 v[148:151], v9, s[12:15], s55 offen offset:1024 sc1
    buffer_load_dwordx4 v[152:155], v9, s[12:15], s55 offen offset:1536 sc1
    buffer_load_dwordx4 v[160:163], v9, s[12:15], s55 offen offset:3072 sc1
    buffer_load_dwordx4 v[164:167], v9, s[12:15], s55 offen offset:3584 sc1
    s_mov_b64 exec, -1
    s_setprio 0
    v_exp_f32 v45, v45
    v_exp_f32 v46, v46
    v_exp_f32 v47, v47
    v_exp_f32 v16, v16
    v_exp_f32 v17, v17
    v_smfmac_f32_32x32x32_bf16 v[64:79], v[188:191], v[40:47], v10
    v_exp_f32 v18, v18
    v_exp_f32 v19, v19
    v_exp_f32 v20, v20
    v_mfma_f32_32x32x16_bf16 v[32:47], v[180:183], v[140:143], v[112:127]
    v_exp_f32 v21, v21
    v_exp_f32 v22, v22
    v_exp_f32 v23, v23
    v_exp_f32 v24, v24
    v_exp_f32 v25, v25
    v_smfmac_f32_32x32x32_bf16 v[80:95], v[184:187], v[16:23], v10
    v_exp_f32 v26, v26
    v_exp_f32 v27, v27
    v_exp_f32 v28, v28
    v_exp_f32 v29, v29
    v_exp_f32 v30, v30
    v_exp_f32 v31, v31
    v_exp_f32 v32, v32
    v_exp_f32 v33, v33
    v_smfmac_f32_32x32x32_bf16 v[80:95], v[188:191], v[24:31], v10
    v_exp_f32 v34, v34
    v_exp_f32 v35, v35
    v_exp_f32 v36, v36
    s_waitcnt vmcnt(12)
    v_mfma_f32_32x32x16_bf16 v[16:31], v[192:195], v[128:131], v[112:127]
    v_exp_f32 v37, v37
    v_exp_f32 v38, v38
    v_exp_f32 v39, v39
    v_exp_f32 v40, v40
    v_exp_f32 v41, v41
    v_smfmac_f32_32x32x32_bf16 v[96:111], v[184:187], v[32:39], v10
    v_exp_f32 v42, v42
    v_exp_f32 v43, v43
    v_exp_f32 v44, v44
    v_exp_f32 v45, v45
    v_exp_f32 v46, v46
    v_exp_f32 v47, v47
    v_exp_f32 v16, v16
    v_exp_f32 v17, v17
    v_smfmac_f32_32x32x32_bf16 v[96:111], v[188:191], v[40:47], v10
    v_exp_f32 v18, v18
    v_exp_f32 v19, v19
    v_exp_f32 v20, v20
    v_mfma_f32_32x32x16_bf16 v[32:47], v[192:195], v[132:135], v[112:127]
    v_exp_f32 v21, v21
    v_exp_f32 v22, v22
    v_exp_f32 v23, v23
    v_exp_f32 v24, v24
    v_exp_f32 v25, v25
    v_smfmac_f32_32x32x32_bf16 v[48:63], v[196:199], v[16:23], v10
    v_exp_f32 v26, v26
    v_exp_f32 v27, v27
    v_exp_f32 v28, v28
    v_exp_f32 v29, v29
    v_exp_f32 v30, v30
    v_exp_f32 v31, v31
    v_exp_f32 v32, v32
    v_exp_f32 v33, v33
    v_smfmac_f32_32x32x32_bf16 v[48:63], v[200:203], v[24:31], v10
    v_exp_f32 v34, v34
    v_exp_f32 v35, v35
    v_exp_f32 v36, v36
    v_mfma_f32_32x32x16_bf16 v[16:31], v[192:195], v[136:139], v[112:127]
    v_exp_f32 v37, v37
    v_exp_f32 v38, v38
    v_exp_f32 v39, v39
    v_exp_f32 v40, v40
    v_exp_f32 v41, v41
    v_smfmac_f32_32x32x32_bf16 v[64:79], v[196:199], v[32:39], v10
    v_exp_f32 v42, v42
    v_exp_f32 v43, v43
    v_exp_f32 v44, v44
    s_add_u32 s55, s55, 4096
    s_and_b32 s55, s55, 0xffff
    s_setprio 3
    buffer_load_dwordx4 v[168:171], v2, s[12:15], s55 offen sc1
    buffer_load_dwordx4 v[180:183], v2, s[12:15], s55 offen offset:2048 sc1
    s_mov_b64 exec, s[60:61]
    buffer_load_dwordx4 v[172:175], v9, s[12:15], s55 offen offset:1024 sc1
    buffer_load_dwordx4 v[176:179], v9, s[12:15], s55 offen offset:1536 sc1
    buffer_load_dwordx4 v[184:187], v9, s[12:15], s55 offen offset:3072 sc1
    buffer_load_dwordx4 v[188:191], v9, s[12:15], s55 offen offset:3584 sc1
    s_mov_b64 exec, -1
    s_setprio 0
    v_exp_f32 v45, v45
    v_exp_f32 v46, v46
    v_exp_f32 v47, v47
    v_exp_f32 v16, v16
    v_exp_f32 v17, v17
    v_smfmac_f32_32x32x32_bf16 v[64:79], v[200:203], v[40:47], v10
    v_exp_f32 v18, v18
    v_exp_f32 v19, v19
    v_exp_f32 v20, v20
    v_mfma_f32_32x32x16_bf16 v[32:47], v[192:195], v[140:143], v[112:127]
    v_exp_f32 v21, v21
    v_exp_f32 v22, v22
    v_exp_f32 v23, v23
    v_exp_f32 v24, v24
    v_exp_f32 v25, v25
    v_smfmac_f32_32x32x32_bf16 v[80:95], v[196:199], v[16:23], v10
    v_exp_f32 v26, v26
    v_exp_f32 v27, v27
    v_exp_f32 v28, v28
    v_exp_f32 v29, v29
    v_exp_f32 v30, v30
    v_exp_f32 v31, v31
    v_exp_f32 v32, v32
    v_exp_f32 v33, v33
    v_smfmac_f32_32x32x32_bf16 v[80:95], v[200:203], v[24:31], v10
    v_exp_f32 v34, v34
    v_exp_f32 v35, v35
    v_exp_f32 v36, v36
    v_mfma_f32_32x32x16_bf16 v[16:31], v[204:207], v[128:131], v[112:127]
    v_exp_f32 v37, v37
    v_exp_f32 v38, v38
    v_exp_f32 v39, v39
    v_exp_f32 v40, v40
    v_exp_f32 v41, v41
    v_smfmac_f32_32x32x32_bf16 v[96:111], v[196:199], v[32:39], v10
    v_exp_f32 v42, v42
    v_exp_f32 v43, v43
    v_exp_f32 v44, v44
    v_exp_f32 v45, v45
    v_exp_f32 v46, v46
    v_exp_f32 v47, v47
    v_exp_f32 v16, v16
    v_exp_f32 v17, v17
    v_smfmac_f32_32x32x32_bf16 v[96:111], v[200:203], v[40:47], v10
    v_exp_f32 v18, v18
    v_exp_f32 v19, v19
    v_exp_f32 v20, v20
    v_mfma_f32_32x32x16_bf16 v[32:47], v[204:207], v[132:135], v[112:127]
    v_exp_f32 v21, v21
    v_exp_f32 v22, v22
    v_exp_f32 v23, v23
    v_exp_f32 v24, v24
    v_exp_f32 v25, v25
    v_smfmac_f32_32x32x32_bf16 v[48:63], v[208:211], v[16:23], v10
    v_exp_f32 v26, v26
    v_exp_f32 v27, v27
    v_exp_f32 v28, v28
    v_exp_f32 v29, v29
    v_exp_f32 v30, v30
    v_exp_f32 v31, v31
    v_exp_f32 v32, v32
    v_exp_f32 v33, v33
    v_smfmac_f32_32x32x32_bf16 v[48:63], v[212:215], v[24:31], v10
    v_exp_f32 v34, v34
    v_exp_f32 v35, v35
    v_exp_f32 v36, v36
    v_mfma_f32_32x32x16_bf16 v[16:31], v[204:207], v[136:139], v[112:127]
    v_exp_f32 v37, v37
    v_exp_f32 v38, v38
    v_exp_f32 v39, v39
    v_exp_f32 v40, v40
    v_exp_f32 v41, v41
    v_smfmac_f32_32x32x32_bf16 v[64:79], v[208:211], v[32:39], v10
    v_exp_f32 v42, v42
    v_exp_f32 v43, v43
    v_exp_f32 v44, v44
    v_exp_f32 v45, v45
    v_exp_f32 v46, v46
    v_exp_f32 v47, v47
    v_exp_f32 v16, v16
    v_exp_f32 v17, v17
    v_smfmac_f32_32x32x32_bf16 v[64:79], v[212:215], v[40:47], v10
    v_exp_f32 v18, v18
    v_exp_f32 v19, v19
    v_exp_f32 v20, v20
    v_mfma_f32_32x32x16_bf16 v[32:47], v[204:207], v[140:143], v[112:127]
    v_exp_f32 v21, v21
    v_exp_f32 v22, v22
    v_exp_f32 v23, v23
    v_exp_f32 v24, v24
    v_exp_f32 v25, v25
    v_smfmac_f32_32x32x32_bf16 v[80:95], v[208:211], v[16:23], v10
    v_exp_f32 v26, v26
    v_exp_f32 v27, v27
    v_exp_f32 v28, v28
    v_exp_f32 v29, v29
    v_exp_f32 v30, v30
    v_exp_f32 v31, v31
    v_exp_f32 v32, v32
    v_exp_f32 v33, v33
    v_smfmac_f32_32x32x32_bf16 v[80:95], v[212:215], v[24:31], v10
    v_exp_f32 v34, v34
    v_exp_f32 v35, v35
    v_exp_f32 v36, v36
    s_waitcnt vmcnt(12)
    v_mfma_f32_32x32x16_bf16 v[16:31], v[216:219], v[128:131], v[112:127]
    v_exp_f32 v37, v37
    v_exp_f32 v38, v38
    v_exp_f32 v39, v39
    v_exp_f32 v40, v40
    v_exp_f32 v41, v41
    v_smfmac_f32_32x32x32_bf16 v[96:111], v[208:211], v[32:39], v10
    v_exp_f32 v42, v42
    v_exp_f32 v43, v43
    v_exp_f32 v44, v44
    v_exp_f32 v45, v45
    v_exp_f32 v46, v46
    v_exp_f32 v47, v47
    v_exp_f32 v16, v16
    v_exp_f32 v17, v17
    v_smfmac_f32_32x32x32_bf16 v[96:111], v[212:215], v[40:47], v10
    v_exp_f32 v18, v18
    v_exp_f32 v19, v19
    v_exp_f32 v20, v20
    v_mfma_f32_32x32x16_bf16 v[32:47], v[216:219], v[132:135], v[112:127]
    v_exp_f32 v21, v21
    v_exp_f32 v22, v22
    v_exp_f32 v23, v23
    v_exp_f32 v24, v24
    v_exp_f32 v25, v25
    v_smfmac_f32_32x32x32_bf16 v[48:63], v[220:223], v[16:23], v10
    v_exp_f32 v26, v26
    v_exp_f32 v27, v27
    v_exp_f32 v28, v28
    v_exp_f32 v29, v29
    v_exp_f32 v30, v30
    v_exp_f32 v31, v31
    v_exp_f32 v32, v32
    v_exp_f32 v33, v33
    v_smfmac_f32_32x32x32_bf16 v[48:63], v[224:227], v[24:31], v10
    v_exp_f32 v34, v34
    v_exp_f32 v35, v35
    v_exp_f32 v36, v36
    v_mfma_f32_32x32x16_bf16 v[16:31], v[216:219], v[136:139], v[112:127]
    v_exp_f32 v37, v37
    v_exp_f32 v38, v38
    v_exp_f32 v39, v39
    v_exp_f32 v40, v40
    v_exp_f32 v41, v41
    v_smfmac_f32_32x32x32_bf16 v[64:79], v[220:223], v[32:39], v10
    v_exp_f32 v42, v42
    v_exp_f32 v43, v43
    v_exp_f32 v44, v44
    s_add_u32 s55, s55, 4096
    s_and_b32 s55, s55, 0xffff
    s_setprio 3
    buffer_load_dwordx4 v[192:195], v2, s[12:15], s55 offen sc1
    buffer_load_dwordx4 v[204:207], v2, s[12:15], s55 offen offset:2048 sc1
    s_mov_b64 exec, s[60:61]
    buffer_load_dwordx4 v[196:199], v9, s[12:15], s55 offen offset:1024 sc1
    buffer_load_dwordx4 v[200:203], v9, s[12:15], s55 offen offset:1536 sc1
    buffer_load_dwordx4 v[208:211], v9, s[12:15], s55 offen offset:3072 sc1
    buffer_load_dwordx4 v[212:215], v9, s[12:15], s55 offen offset:3584 sc1
    s_mov_b64 exec, -1
    s_setprio 0
    v_exp_f32 v45, v45
    v_exp_f32 v46, v46
    v_exp_f32 v47, v47
    v_exp_f32 v16, v16
    v_exp_f32 v17, v17
    v_smfmac_f32_32x32x32_bf16 v[64:79], v[224:227], v[40:47], v10
    v_exp_f32 v18, v18
    v_exp_f32 v19, v19
    v_exp_f32 v20, v20
    v_mfma_f32_32x32x16_bf16 v[32:47], v[216:219], v[140:143], v[112:127]
    v_exp_f32 v21, v21
    v_exp_f32 v22, v22
    v_exp_f32 v23, v23
    v_exp_f32 v24, v24
    v_exp_f32 v25, v25
    v_smfmac_f32_32x32x32_bf16 v[80:95], v[220:223], v[16:23], v10
    v_exp_f32 v26, v26
    v_exp_f32 v27, v27
    v_exp_f32 v28, v28
    v_exp_f32 v29, v29
    v_exp_f32 v30, v30
    v_exp_f32 v31, v31
    v_exp_f32 v32, v32
    v_exp_f32 v33, v33
    v_smfmac_f32_32x32x32_bf16 v[80:95], v[224:227], v[24:31], v10
    v_exp_f32 v34, v34
    v_exp_f32 v35, v35
    v_exp_f32 v36, v36
    v_mfma_f32_32x32x16_bf16 v[16:31], v[228:231], v[128:131], v[112:127]
    v_exp_f32 v37, v37
    v_exp_f32 v38, v38
    v_exp_f32 v39, v39
    v_exp_f32 v40, v40
    v_exp_f32 v41, v41
    v_smfmac_f32_32x32x32_bf16 v[96:111], v[220:223], v[32:39], v10
    v_exp_f32 v42, v42
    v_exp_f32 v43, v43
    v_exp_f32 v44, v44
    v_exp_f32 v45, v45
    v_exp_f32 v46, v46
    v_exp_f32 v47, v47
    v_exp_f32 v16, v16
    v_exp_f32 v17, v17
    v_smfmac_f32_32x32x32_bf16 v[96:111], v[224:227], v[40:47], v10
    v_exp_f32 v18, v18
    v_exp_f32 v19, v19
    v_exp_f32 v20, v20
    v_mfma_f32_32x32x16_bf16 v[32:47], v[228:231], v[132:135], v[112:127]
    v_exp_f32 v21, v21
    v_exp_f32 v22, v22
    v_exp_f32 v23, v23
    v_exp_f32 v24, v24
    v_exp_f32 v25, v25
    v_smfmac_f32_32x32x32_bf16 v[48:63], v[232:235], v[16:23], v10
    v_exp_f32 v26, v26
    v_exp_f32 v27, v27
    v_exp_f32 v28, v28
    v_exp_f32 v29, v29
    v_exp_f32 v30, v30
    v_exp_f32 v31, v31
    v_exp_f32 v32, v32
    v_exp_f32 v33, v33
    v_smfmac_f32_32x32x32_bf16 v[48:63], v[236:239], v[24:31], v10
    v_exp_f32 v34, v34
    v_exp_f32 v35, v35
    v_exp_f32 v36, v36
    v_mfma_f32_32x32x16_bf16 v[16:31], v[228:231], v[136:139], v[112:127]
    v_exp_f32 v37, v37
    v_exp_f32 v38, v38
    v_exp_f32 v39, v39
    v_exp_f32 v40, v40
    v_exp_f32 v41, v41
    v_smfmac_f32_32x32x32_bf16 v[64:79], v[232:235], v[32:39], v10
    v_exp_f32 v42, v42
    v_exp_f32 v43, v43
    v_exp_f32 v44, v44
    v_exp_f32 v45, v45
    v_exp_f32 v46, v46
    v_exp_f32 v47, v47
    v_exp_f32 v16, v16
    v_exp_f32 v17, v17
    v_smfmac_f32_32x32x32_bf16 v[64:79], v[236:239], v[40:47], v10
    v_exp_f32 v18, v18
    v_exp_f32 v19, v19
    v_exp_f32 v20, v20
    v_mfma_f32_32x32x16_bf16 v[32:47], v[228:231], v[140:143], v[112:127]
    v_exp_f32 v21, v21
    v_exp_f32 v22, v22
    v_exp_f32 v23, v23
    v_exp_f32 v24, v24
    v_exp_f32 v25, v25
    v_smfmac_f32_32x32x32_bf16 v[80:95], v[232:235], v[16:23], v10
    v_exp_f32 v26, v26
    v_exp_f32 v27, v27
    v_exp_f32 v28, v28
    v_exp_f32 v29, v29
    v_exp_f32 v30, v30
    v_exp_f32 v31, v31
    v_exp_f32 v32, v32
    v_exp_f32 v33, v33
    v_smfmac_f32_32x32x32_bf16 v[80:95], v[236:239], v[24:31], v10
    v_exp_f32 v34, v34
    v_exp_f32 v35, v35
    v_exp_f32 v36, v36
    s_waitcnt vmcnt(12)
    v_mfma_f32_32x32x16_bf16 v[16:31], v[144:147], v[128:131], v[112:127]
    v_exp_f32 v37, v37
    v_exp_f32 v38, v38
    v_exp_f32 v39, v39
    v_exp_f32 v40, v40
    v_exp_f32 v41, v41
    v_smfmac_f32_32x32x32_bf16 v[96:111], v[232:235], v[32:39], v10
    v_exp_f32 v42, v42
    v_exp_f32 v43, v43
    v_exp_f32 v44, v44
    v_exp_f32 v45, v45
    v_exp_f32 v46, v46
    v_exp_f32 v47, v47
    s_mov_b32 s57, 3
    .p2align 6
att_loop:
    v_exp_f32 v16, v16
    v_exp_f32 v17, v17
    v_smfmac_f32_32x32x32_bf16 v[96:111], v[236:239], v[40:47], v10
    v_exp_f32 v18, v18
    v_exp_f32 v19, v19
    v_exp_f32 v20, v20
    v_mfma_f32_32x32x16_bf16 v[32:47], v[144:147], v[132:135], v[112:127]
    v_exp_f32 v21, v21
    v_exp_f32 v22, v22
    v_exp_f32 v23, v23
    v_exp_f32 v24, v24
    v_exp_f32 v25, v25
    v_smfmac_f32_32x32x32_bf16 v[48:63], v[148:151], v[16:23], v10
    v_exp_f32 v26, v26
    v_exp_f32 v27, v27
    v_exp_f32 v28, v28
    v_exp_f32 v29, v29
    v_exp_f32 v30, v30
    v_exp_f32 v31, v31
    v_exp_f32 v32, v32
    v_exp_f32 v33, v33
    v_smfmac_f32_32x32x32_bf16 v[48:63], v[152:155], v[24:31], v10
    v_exp_f32 v34, v34
    v_exp_f32 v35, v35
    v_exp_f32 v36, v36
    v_mfma_f32_32x32x16_bf16 v[16:31], v[144:147], v[136:139], v[112:127]
    v_exp_f32 v37, v37
    v_exp_f32 v38, v38
    v_exp_f32 v39, v39
    v_exp_f32 v40, v40
    v_exp_f32 v41, v41
    v_smfmac_f32_32x32x32_bf16 v[64:79], v[148:151], v[32:39], v10
    v_exp_f32 v42, v42
    v_exp_f32 v43, v43
    v_exp_f32 v44, v44
    s_add_u32 s55, s55, 4096
    s_and_b32 s55, s55, 0xffff
    s_setprio 3
    buffer_load_dwordx4 v[216:219], v2, s[12:15], s55 offen sc1
    buffer_load_dwordx4 v[228:231], v2, s[12:15], s55 offen offset:2048 sc1
    s_mov_b64 exec, s[60:61]
    buffer_load_dwordx4 v[220:223], v9, s[12:15], s55 offen offset:1024 sc1
    buffer_load_dwordx4 v[224:227], v9, s[12:15], s55 offen offset:1536 sc1
    buffer_load_dwordx4 v[232:235], v9, s[12:15], s55 offen offset:3072 sc1
    buffer_load_dwordx4 v[236:239], v9, s[12:15], s55 offen offset:3584 sc1
    s_mov_b64 exec, -1
    s_setprio 0
    v_exp_f32 v45, v45
    v_exp_f32 v46, v46
    v_exp_f32 v47, v47
    v_exp_f32 v16, v16
    v_exp_f32 v17, v17
    v_smfmac_f32_32x32x32_bf16 v[64:79], v[152:155], v[40:47], v10
    v_exp_f32 v18, v18
    v_exp_f32 v19, v19
    v_exp_f32 v20, v20
    v_mfma_f32_32x32x16_bf16 v[32:47], v[144:147], v[140:143], v[112:127]
    v_exp_f32 v21, v21
    v_exp_f32 v22, v22
    v_exp_f32 v23, v23
    v_exp_f32 v24, v24
    v_exp_f32 v25, v25
    v_smfmac_f32_32x32x32_bf16 v[80:95], v[148:151], v[16:23], v10
    v_exp_f32 v26, v26
    v_exp_f32 v27, v27
    v_exp_f32 v28, v28
    v_exp_f32 v29, v29
    v_exp_f32 v30, v30
    v_exp_f32 v31, v31
    v_exp_f32 v32, v32
    v_exp_f32 v33, v33
    v_smfmac_f32_32x32x32_bf16 v[80:95], v[152:155], v[24:31], v10
    v_exp_f32 v34, v34
    v_exp_f32 v35, v35
    v_exp_f32 v36, v36
    v_mfma_f32_32x32x16_bf16 v[16:31], v[156:159], v[128:131], v[112:127]
    v_exp_f32 v37, v37
    v_exp_f32 v38, v38
    v_exp_f32 v39, v39
    v_exp_f32 v40, v40
    v_exp_f32 v41, v41
    v_smfmac_f32_32x32x32_bf16 v[96:111], v[148:151], v[32:39], v10
    v_exp_f32 v42, v42
    v_exp_f32 v43, v43
    v_exp_f32 v44, v44
    v_exp_f32 v45, v45
    v_exp_f32 v46, v46
    v_exp_f32 v47, v47
    v_exp_f32 v16, v16
    v_exp_f32 v17, v17
    v_smfmac_f32_32x32x32_bf16 v[96:111], v[152:155], v[40:47], v10
    v_exp_f32 v18, v18
    v_exp_f32 v19, v19
    v_exp_f32 v20, v20
    v_mfma_f32_32x32x16_bf16 v[32:47], v[156:159], v[132:135], v[112:127]
    v_exp_f32 v21, v21
    v_exp_f32 v22, v22
    v_exp_f32 v23, v23
    v_exp_f32 v24, v24
    v_exp_f32 v25, v25
    v_smfmac_f32_32x32x32_bf16 v[48:63], v[160:163], v[16:23], v10
    v_exp_f32 v26, v26
    v_exp_f32 v27, v27
    v_exp_f32 v28, v28
    v_exp_f32 v29, v29
    v_exp_f32 v30, v30
    v_exp_f32 v31, v31
    v_exp_f32 v32, v32
    v_exp_f32 v33, v33
    v_smfmac_f32_32x32x32_bf16 v[48:63], v[164:167], v[24:31], v10
    v_exp_f32 v34, v34
    v_exp_f32 v35, v35
    v_exp_f32 v36, v36
    v_mfma_f32_32x32x16_bf16 v[16:31], v[156:159], v[136:139], v[112:127]
    v_exp_f32 v37, v37
    v_exp_f32 v38, v38
    v_exp_f32 v39, v39
    v_exp_f32 v40, v40
    v_exp_f32 v41, v41
    v_smfmac_f32_32x32x32_bf16 v[64:79], v[160:163], v[32:39], v10
    v_exp_f32 v42, v42
    v_exp_f32 v43, v43
    v_exp_f32 v44, v44
    v_exp_f32 v45, v45
    v_exp_f32 v46, v46
    v_exp_f32 v47, v47
    v_exp_f32 v16, v16
    v_exp_f32 v17, v17
    v_smfmac_f32_32x32x32_bf16 v[64:79], v[164:167], v[40:47], v10
    v_exp_f32 v18, v18
    v_exp_f32 v19, v19
    v_exp_f32 v20, v20
    v_mfma_f32_32x32x16_bf16 v[32:47], v[156:159], v[140:143], v[112:127]
    v_exp_f32 v21, v21
    v_exp_f32 v22, v22
    v_exp_f32 v23, v23
    v_exp_f32 v24, v24
    v_exp_f32 v25, v25
    v_smfmac_f32_32x32x32_bf16 v[80:95], v[160:163], v[16:23], v10
    v_exp_f32 v26, v26
    v_exp_f32 v27, v27
    v_exp_f32 v28, v28
    v_exp_f32 v29, v29
    v_exp_f32 v30, v30
    v_exp_f32 v31, v31
    v_exp_f32 v32, v32
    v_exp_f32 v33, v33
    v_smfmac_f32_32x32x32_bf16 v[80:95], v[164:167], v[24:31], v10
    v_exp_f32 v34, v34
    v_exp_f32 v35, v35
    v_exp_f32 v36, v36
    s_waitcnt vmcnt(12)
    v_mfma_f32_32x32x16_bf16 v[16:31], v[168:171], v[128:131], v[112:127]
    v_exp_f32 v37, v37
    v_exp_f32 v38, v38
    v_exp_f32 v39, v39
    v_exp_f32 v40, v40
    v_exp_f32 v41, v41
    v_smfmac_f32_32x32x32_bf16 v[96:111], v[160:163], v[32:39], v10
    v_exp_f32 v42, v42
    v_exp_f32 v43, v43
    v_exp_f32 v44, v44
    v_exp_f32 v45, v45
    v_exp_f32 v46, v46
    v_exp_f32 v47, v47
    v_exp_f32 v16, v16
    v_exp_f32 v17, v17
    v_smfmac_f32_32x32x32_bf16 v[96:111], v[164:167], v[40:47], v10
    v_exp_f32 v18, v18
    v_exp_f32 v19, v19
    v_exp_f32 v20, v20
    v_mfma_f32_32x32x16_bf16 v[32:47], v[168:171], v[132:135], v[112:127]
    v_exp_f32 v21, v21
    v_exp_f32 v22, v22
    v_exp_f32 v23, v23
    v_exp_f32 v24, v24
    v_exp_f32 v25, v25
    v_smfmac_f32_32x32x32_bf16 v[48:63], v[172:175], v[16:23], v10
    v_exp_f32 v26, v26
    v_exp_f32 v27, v27
    v_exp_f32 v28, v28
    v_exp_f32 v29, v29
    v_exp_f32 v30, v30
    v_exp_f32 v31, v31
    v_exp_f32 v32, v32
    v_exp_f32 v33, v33
    v_smfmac_f32_32x32x32_bf16 v[48:63], v[176:179], v[24:31], v10
    v_exp_f32 v34, v34
    v_exp_f32 v35, v35
    v_exp_f32 v36, v36
    v_mfma_f32_32x32x16_bf16 v[16:31], v[168:171], v[136:139], v[112:127]
    v_exp_f32 v37, v37
    v_exp_f32 v38, v38
    v_exp_f32 v39, v39
    v_exp_f32 v40, v40
    v_exp_f32 v41, v41
    v_smfmac_f32_32x32x32_bf16 v[64:79], v[172:175], v[32:39], v10
    v_exp_f32 v42, v42
    v_exp_f32 v43, v43
    v_exp_f32 v44, v44
    s_cmp_eq_u32 s57, 1
    s_cselect_b32 s14, 0, s14
    s_cbranch_scc0 z_gl6
    buffer_load_dwordx2 v[244:245], v13, s[4:7], 0 offen offset:0 sc1
    buffer_load_dwordx2 v[246:247], v13, s[4:7], 0 offen offset:2048 sc1
z_gl6:
    s_add_u32 s55, s55, 4096
    s_and_b32 s55, s55, 0xffff
    s_setprio 3
    buffer_load_dwordx4 v[144:147], v2, s[12:15], s55 offen sc1
    buffer_load_dwordx4 v[156:159], v2, s[12:15], s55 offen offset:2048 sc1
    s_mov_b64 exec, s[60:61]
    buffer_load_dwordx4 v[148:151], v9, s[12:15], s55 offen offset:1024 sc1
    buffer_load_dwordx4 v[152:155], v9, s[12:15], s55 offen offset:1536 sc1
    buffer_load_dwordx4 v[160:163], v9, s[12:15], s55 offen offset:3072 sc1
    buffer_load_dwordx4 v[164:167], v9, s[12:15], s55 offen offset:3584 sc1
    s_mov_b64 exec, -1
    s_setprio 0
    v_exp_f32 v45, v45
    v_exp_f32 v46, v46
    v_exp_f32 v47, v47
    v_exp_f32 v16, v16
    v_exp_f32 v17, v17
    v_smfmac_f32_32x32x32_bf16 v[64:79], v[176:179], v[40:47], v10
    v_exp_f32 v18, v18
    v_exp_f32 v19, v19
    v_exp_f32 v20, v20
    v_mfma_f32_32x32x16_bf16 v[32:47], v[168:171], v[140:143], v[112:127]
    v_exp_f32 v21, v21
    v_exp_f32 v22, v22
    v_exp_f32 v23, v23
    v_exp_f32 v24, v24
    v_exp_f32 v25, v25
    v_smfmac_f32_32x32x32_bf16 v[80:95], v[172:175], v[16:23], v10
    v_exp_f32 v26, v26
    v_exp_f32 v27, v27
    v_exp_f32 v28, v28
    v_exp_f32 v29, v29
    v_exp_f32 v30, v30
    v_exp_f32 v31, v31
    v_exp_f32 v32, v32
    v_exp_f32 v33, v33
    v_smfmac_f32_32x32x32_bf16 v[80:95], v[176:179], v[24:31], v10
    v_exp_f32 v34, v34
    v_exp_f32 v35, v35
    v_exp_f32 v36, v36
    v_mfma_f32_32x32x16_bf16 v[16:31], v[180:183], v[128:131], v[112:127]
    v_exp_f32 v37, v37
    v_exp_f32 v38, v38
    v_exp_f32 v39, v39
    v_exp_f32 v40, v40
    v_exp_f32 v41, v41
    v_smfmac_f32_32x32x32_bf16 v[96:111], v[172:175], v[32:39], v10
    v_exp_f32 v42, v42
    v_exp_f32 v43, v43
    v_exp_f32 v44, v44
    v_exp_f32 v45, v45
    v_exp_f32 v46, v46
    v_exp_f32 v47, v47
    v_exp_f32 v16, v16
    v_exp_f32 v17, v17
    v_smfmac_f32_32x32x32_bf16 v[96:111], v[176:179], v[40:47], v10
    v_exp_f32 v18, v18
    v_exp_f32 v19, v19
    v_exp_f32 v20, v20
    v_mfma_f32_32x32x16_bf16 v[32:47], v[180:183], v[132:135], v[112:127]
    v_exp_f32 v21, v21
    v_exp_f32 v22, v22
    v_exp_f32 v23, v23
    v_exp_f32 v24, v24
    v_exp_f32 v25, v25
    v_smfmac_f32_32x32x32_bf16 v[48:63], v[184:187], v[16:23], v10
    v_exp_f32 v26, v26
    v_exp_f32 v27, v27
    v_exp_f32 v28, v28
    v_exp_f32 v29, v29
    v_exp_f32 v30, v30
    v_exp_f32 v31, v31
    v_exp_f32 v32, v32
    v_exp_f32 v33, v33
    v_smfmac_f32_32x32x32_bf16 v[48:63], v[188:191], v[24:31], v10
    v_exp_f32 v34, v34
    v_exp_f32 v35, v35
    v_exp_f32 v36, v36
    v_mfma_f32_32x32x16_bf16 v[16:31], v[180:183], v[136:139], v[112:127]
    v_exp_f32 v37, v37
    v_exp_f32 v38, v38
    v_exp_f32 v39, v39
    v_exp_f32 v40, v40
    v_exp_f32 v41, v41
    v_smfmac_f32_32x32x32_bf16 v[64:79], v[184:187], v[32:39], v10
    v_exp_f32 v42, v42
    v_exp_f32 v43, v43
    v_exp_f32 v44, v44
    v_exp_f32 v45, v45
    v_exp_f32 v46, v46
    v_exp_f32 v47, v47
    v_exp_f32 v16, v16
    v_exp_f32 v17, v17
    v_smfmac_f32_32x32x32_bf16 v[64:79], v[188:191], v[40:47], v10
    v_exp_f32 v18, v18
    v_exp_f32 v19, v19
    v_exp_f32 v20, v20
    v_mfma_f32_32x32x16_bf16 v[32:47], v[180:183], v[140:143], v[112:127]
    v_exp_f32 v21, v21
    v_exp_f32 v22, v22
    v_exp_f32 v23, v23
    v_exp_f32 v24, v24
    v_exp_f32 v25, v25
    v_smfmac_f32_32x32x32_bf16 v[80:95], v[184:187], v[16:23], v10
    v_exp_f32 v26, v26
    v_exp_f32 v27, v27
    v_exp_f32 v28, v28
    v_exp_f32 v29, v29
    v_exp_f32 v30, v30
    v_exp_f32 v31, v31
    v_exp_f32 v32, v32
    v_exp_f32 v33, v33
    v_smfmac_f32_32x32x32_bf16 v[80:95], v[188:191], v[24:31], v10
    v_exp_f32 v34, v34
    v_exp_f32 v35, v35
    v_exp_f32 v36, v36
    s_waitcnt vmcnt(12)
    v_mfma_f32_32x32x16_bf16 v[16:31], v[192:195], v[128:131], v[112:127]
    v_exp_f32 v37, v37
    v_exp_f32 v38, v38
    v_exp_f32 v39, v39
    v_exp_f32 v40, v40
    v_exp_f32 v41, v41
    v_smfmac_f32_32x32x32_bf16 v[96:111], v[184:187], v[32:39], v10
    v_exp_f32 v42, v42
    v_exp_f32 v43, v43
    v_exp_f32 v44, v44
    v_exp_f32 v45, v45
    v_exp_f32 v46, v46
    v_exp_f32 v47, v47
    v_exp_f32 v16, v16
    v_exp_f32 v17, v17
    v_smfmac_f32_32x32x32_bf16 v[96:111], v[188:191], v[40:47], v10
    v_exp_f32 v18, v18
    v_exp_f32 v19, v19
    v_exp_f32 v20, v20
    v_mfma_f32_32x32x16_bf16 v[32:47], v[192:195], v[132:135], v[112:127]
    v_exp_f32 v21, v21
    v_exp_f32 v22, v22
    v_exp_f32 v23, v23
    v_exp_f32 v24, v24
    v_exp_f32 v25, v25
    v_smfmac_f32_32x32x32_bf16 v[48:63], v[196:199], v[16:23], v10
    v_exp_f32 v26, v26
    v_exp_f32 v27, v27
    v_exp_f32 v28, v28
    v_exp_f32 v29, v29
    v_exp_f32 v30, v30
    v_exp_f32 v31, v31
    v_exp_f32 v32, v32
    v_exp_f32 v33, v33
    v_smfmac_f32_32x32x32_bf16 v[48:63], v[200:203], v[24:31], v10
    v_exp_f32 v34, v34
    v_exp_f32 v35, v35
    v_exp_f32 v36, v36
    v_mfma_f32_32x32x16_bf16 v[16:31], v[192:195], v[136:139], v[112:127]
    v_exp_f32 v37, v37
    v_exp_f32 v38, v38
    v_exp_f32 v39, v39
    v_exp_f32 v40, v40
    v_exp_f32 v41, v41
    v_smfmac_f32_32x32x32_bf16 v[64:79], v[196:199], v[32:39], v10
    v_exp_f32 v42, v42
    v_exp_f32 v43, v43
    v_exp_f32 v44, v44
    s_add_u32 s55, s55, 4096
    s_and_b32 s55, s55, 0xffff
    s_setprio 3
    buffer_load_dwordx4 v[168:171], v2, s[12:15], s55 offen sc1
    buffer_load_dwordx4 v[180:183], v2, s[12:15], s55 offen offset:2048 sc1
    s_mov_b64 exec, s[60:61]
    buffer_load_dwordx4 v[172:175], v9, s[12:15], s55 offen offset:1024 sc1
    buffer_load_dwordx4 v[176:179], v9, s[12:15], s55 offen offset:1536 sc1
    buffer_load_dwordx4 v[184:187], v9, s[12:15], s55 offen offset:3072 sc1
    buffer_load_dwordx4 v[188:191], v9, s[12:15], s55 offen offset:3584 sc1
    s_mov_b64 exec, -1
    s_setprio 0
    v_exp_f32 v45, v45
    v_exp_f32 v46, v46
    v_exp_f32 v47, v47
    v_exp_f32 v16, v16
    v_exp_f32 v17, v17
    v_smfmac_f32_32x32x32_bf16 v[64:79], v[200:203], v[40:47], v10
    v_exp_f32 v18, v18
    v_exp_f32 v19, v19
    v_exp_f32 v20, v20
    v_mfma_f32_32x32x16_bf16 v[32:47], v[192:195], v[140:143], v[112:127]
    v_exp_f32 v21, v21
    v_exp_f32 v22, v22
    v_exp_f32 v23, v23
    v_exp_f32 v24, v24
    v_exp_f32 v25, v25
    v_smfmac_f32_32x32x32_bf16 v[80:95], v[196:199], v[16:23], v10
    v_exp_f32 v26, v26
    v_exp_f32 v27, v27
    v_exp_f32 v28, v28
    v_exp_f32 v29, v29
    v_exp_f32 v30, v30
    v_exp_f32 v31, v31
    v_exp_f32 v32, v32
    v_exp_f32 v33, v33
    v_smfmac_f32_32x32x32_bf16 v[80:95], v[200:203], v[24:31], v10
    v_exp_f32 v34, v34
    v_exp_f32 v35, v35
    v_exp_f32 v36, v36
    v_mfma_f32_32x32x16_bf16 v[16:31], v[204:207], v[128:131], v[112:127]
    v_exp_f32 v37, v37
    v_exp_f32 v38, v38
    v_exp_f32 v39, v39
    v_exp_f32 v40, v40
    v_exp_f32 v41, v41
    v_smfmac_f32_32x32x32_bf16 v[96:111], v[196:199], v[32:39], v10
    v_exp_f32 v42, v42
    v_exp_f32 v43, v43
    v_exp_f32 v44, v44
    v_exp_f32 v45, v45
    v_exp_f32 v46, v46
    v_exp_f32 v47, v47
    v_exp_f32 v16, v16
    v_exp_f32 v17, v17
    v_smfmac_f32_32x32x32_bf16 v[96:111], v[200:203], v[40:47], v10
    v_exp_f32 v18, v18
    v_exp_f32 v19, v19
    v_exp_f32 v20, v20
    v_mfma_f32_32x32x16_bf16 v[32:47], v[204:207], v[132:135], v[112:127]
    v_exp_f32 v21, v21
    v_exp_f32 v22, v22
    v_exp_f32 v23, v23
    v_exp_f32 v24, v24
    v_exp_f32 v25, v25
    v_smfmac_f32_32x32x32_bf16 v[48:63], v[208:211], v[16:23], v10
    v_exp_f32 v26, v26
    v_exp_f32 v27, v27
    v_exp_f32 v28, v28
    v_exp_f32 v29, v29
    v_exp_f32 v30, v30
    v_exp_f32 v31, v31
    v_exp_f32 v32, v32
    v_exp_f32 v33, v33
    v_smfmac_f32_32x32x32_bf16 v[48:63], v[212:215], v[24:31], v10
    v_exp_f32 v34, v34
    v_exp_f32 v35, v35
    v_exp_f32 v36, v36
    v_mfma_f32_32x32x16_bf16 v[16:31], v[204:207], v[136:139], v[112:127]
    v_exp_f32 v37, v37
    v_exp_f32 v38, v38
    v_exp_f32 v39, v39
    v_exp_f32 v40, v40
    v_exp_f32 v41, v41
    v_smfmac_f32_32x32x32_bf16 v[64:79], v[208:211], v[32:39], v10
    v_exp_f32 v42, v42
    v_exp_f32 v43, v43
    v_exp_f32 v44, v44
    v_exp_f32 v45, v45
    v_exp_f32 v46, v46
    v_exp_f32 v47, v47
    v_exp_f32 v16, v16
    v_exp_f32 v17, v17
    v_smfmac_f32_32x32x32_bf16 v[64:79], v[212:215], v[40:47], v10
    v_exp_f32 v18, v18
    v_exp_f32 v19, v19
    v_exp_f32 v20, v20
    v_mfma_f32_32x32x16_bf16 v[32:47], v[204:207], v[140:143], v[112:127]
    v_exp_f32 v21, v21
    v_exp_f32 v22, v22
    v_exp_f32 v23, v23
    v_exp_f32 v24, v24
    v_exp_f32 v25, v25
    v_smfmac_f32_32x32x32_bf16 v[80:95], v[208:211], v[16:23], v10
    v_exp_f32 v26, v26
    v_exp_f32 v27, v27
    v_exp_f32 v28, v28
    v_exp_f32 v29, v29
    v_exp_f32 v30, v30
    v_exp_f32 v31, v31
    v_exp_f32 v32, v32
    v_exp_f32 v33, v33
    v_smfmac_f32_32x32x32_bf16 v[80:95], v[212:215], v[24:31], v10
    v_exp_f32 v34, v34
    v_exp_f32 v35, v35
    v_exp_f32 v36, v36
    s_waitcnt vmcnt(12)
    v_mfma_f32_32x32x16_bf16 v[16:31], v[216:219], v[128:131], v[112:127]
    v_exp_f32 v37, v37
    v_exp_f32 v38, v38
    v_exp_f32 v39, v39
    v_exp_f32 v40, v40
    v_exp_f32 v41, v41
    v_smfmac_f32_32x32x32_bf16 v[96:111], v[208:211], v[32:39], v10
    v_exp_f32 v42, v42
    v_exp_f32 v43, v43
    v_exp_f32 v44, v44
    v_exp_f32 v45, v45
    v_exp_f32 v46, v46
    v_exp_f32 v47, v47
    v_exp_f32 v16, v16
    v_exp_f32 v17, v17
    v_smfmac_f32_32x32x32_bf16 v[96:111], v[212:215], v[40:47], v10
    v_exp_f32 v18, v18
    v_exp_f32 v19, v19
    v_exp_f32 v20, v20
    v_mfma_f32_32x32x16_bf16 v[32:47], v[216:219], v[132:135], v[112:127]
    v_exp_f32 v21, v21
    v_exp_f32 v22, v22
    v_exp_f32 v23, v23
    v_exp_f32 v24, v24
    v_exp_f32 v25, v25
    v_smfmac_f32_32x32x32_bf16 v[48:63], v[220:223], v[16:23], v10
    v_exp_f32 v26, v26
    v_exp_f32 v27, v27
    v_exp_f32 v28, v28
    v_exp_f32 v29, v29
    v_exp_f32 v30, v30
    v_exp_f32 v31, v31
    v_exp_f32 v32, v32
    v_exp_f32 v33, v33
    v_smfmac_f32_32x32x32_bf16 v[48:63], v[224:227], v[24:31], v10
    v_exp_f32 v34, v34
    v_exp_f32 v35, v35
    v_exp_f32 v36, v36
    v_mfma_f32_32x32x16_bf16 v[16:31], v[216:219], v[136:139], v[112:127]
    v_exp_f32 v37, v37
    v_exp_f32 v38, v38
    v_exp_f32 v39, v39
    v_exp_f32 v40, v40
    v_exp_f32 v41, v41
    v_smfmac_f32_32x32x32_bf16 v[64:79], v[220:223], v[32:39], v10
    v_exp_f32 v42, v42
    v_exp_f32 v43, v43
    v_exp_f32 v44, v44
    s_add_u32 s55, s55, 4096
    s_and_b32 s55, s55, 0xffff
    s_setprio 3
    buffer_load_dwordx4 v[192:195], v2, s[12:15], s55 offen sc1
    buffer_load_dwordx4 v[204:207], v2, s[12:15], s55 offen offset:2048 sc1
    s_mov_b64 exec, s[60:61]
    buffer_load_dwordx4 v[196:199], v9, s[12:15], s55 offen offset:1024 sc1
    buffer_load_dwordx4 v[200:203], v9, s[12:15], s55 offen offset:1536 sc1
    buffer_load_dwordx4 v[208:211], v9, s[12:15], s55 offen offset:3072 sc1
    buffer_load_dwordx4 v[212:215], v9, s[12:15], s55 offen offset:3584 sc1
    s_mov_b64 exec, -1
    s_setprio 0
    v_exp_f32 v45, v45
    v_exp_f32 v46, v46
    v_exp_f32 v47, v47
    v_exp_f32 v16, v16
    v_exp_f32 v17, v17
    v_smfmac_f32_32x32x32_bf16 v[64:79], v[224:227], v[40:47], v10
    v_exp_f32 v18, v18
    v_exp_f32 v19, v19
    v_exp_f32 v20, v20
    v_mfma_f32_32x32x16_bf16 v[32:47], v[216:219], v[140:143], v[112:127]
    v_exp_f32 v21, v21
    v_exp_f32 v22, v22
    v_exp_f32 v23, v23
    v_exp_f32 v24, v24
    v_exp_f32 v25, v25
    v_smfmac_f32_32x32x32_bf16 v[80:95], v[220:223], v[16:23], v10
    v_exp_f32 v26, v26
    v_exp_f32 v27, v27
    v_exp_f32 v28, v28
    v_exp_f32 v29, v29
    v_exp_f32 v30, v30
    v_exp_f32 v31, v31
    v_exp_f32 v32, v32
    v_exp_f32 v33, v33
    v_smfmac_f32_32x32x32_bf16 v[80:95], v[224:227], v[24:31], v10
    v_exp_f32 v34, v34
    v_exp_f32 v35, v35
    v_exp_f32 v36, v36
    v_mfma_f32_32x32x16_bf16 v[16:31], v[228:231], v[128:131], v[112:127]
    v_exp_f32 v37, v37
    v_exp_f32 v38, v38
    v_exp_f32 v39, v39
    v_exp_f32 v40, v40
    v_exp_f32 v41, v41
    v_smfmac_f32_32x32x32_bf16 v[96:111], v[220:223], v[32:39], v10
    v_exp_f32 v42, v42
    v_exp_f32 v43, v43
    v_exp_f32 v44, v44
    v_exp_f32 v45, v45
    v_exp_f32 v46, v46
    v_exp_f32 v47, v47
    v_exp_f32 v16, v16
    v_exp_f32 v17, v17
    v_smfmac_f32_32x32x32_bf16 v[96:111], v[224:227], v[40:47], v10
    v_exp_f32 v18, v18
    v_exp_f32 v19, v19
    v_exp_f32 v20, v20
    v_mfma_f32_32x32x16_bf16 v[32:47], v[228:231], v[132:135], v[112:127]
    v_exp_f32 v21, v21
    v_exp_f32 v22, v22
    v_exp_f32 v23, v23
    v_exp_f32 v24, v24
    v_exp_f32 v25, v25
    v_smfmac_f32_32x32x32_bf16 v[48:63], v[232:235], v[16:23], v10
    v_exp_f32 v26, v26
    v_exp_f32 v27, v27
    v_exp_f32 v28, v28
    v_exp_f32 v29, v29
    v_exp_f32 v30, v30
    v_exp_f32 v31, v31
    v_exp_f32 v32, v32
    v_exp_f32 v33, v33
    v_smfmac_f32_32x32x32_bf16 v[48:63], v[236:239], v[24:31], v10
    v_exp_f32 v34, v34
    v_exp_f32 v35, v35
    v_exp_f32 v36, v36
    v_mfma_f32_32x32x16_bf16 v[16:31], v[228:231], v[136:139], v[112:127]
    v_exp_f32 v37, v37
    v_exp_f32 v38, v38
    v_exp_f32 v39, v39
    v_exp_f32 v40, v40
    v_exp_f32 v41, v41
    v_smfmac_f32_32x32x32_bf16 v[64:79], v[232:235], v[32:39], v10
    v_exp_f32 v42, v42
    v_exp_f32 v43, v43
    v_exp_f32 v44, v44
    v_exp_f32 v45, v45
    v_exp_f32 v46, v46
    v_exp_f32 v47, v47
    v_exp_f32 v16, v16
    v_exp_f32 v17, v17
    v_smfmac_f32_32x32x32_bf16 v[64:79], v[236:239], v[40:47], v10
    v_exp_f32 v18, v18
    v_exp_f32 v19, v19
    v_exp_f32 v20, v20
    v_mfma_f32_32x32x16_bf16 v[32:47], v[228:231], v[140:143], v[112:127]
    v_exp_f32 v21, v21
    v_exp_f32 v22, v22
    v_exp_f32 v23, v23
    v_exp_f32 v24, v24
    v_exp_f32 v25, v25
    v_smfmac_f32_32x32x32_bf16 v[80:95], v[232:235], v[16:23], v10
    v_exp_f32 v26, v26
    v_exp_f32 v27, v27
    v_exp_f32 v28, v28
    v_exp_f32 v29, v29
    v_exp_f32 v30, v30
    v_exp_f32 v31, v31
    v_exp_f32 v32, v32
    v_exp_f32 v33, v33
    v_smfmac_f32_32x32x32_bf16 v[80:95], v[236:239], v[24:31], v10
    v_exp_f32 v34, v34
    v_exp_f32 v35, v35
    v_exp_f32 v36, v36
    s_waitcnt vmcnt(12)
    v_mfma_f32_32x32x16_bf16 v[16:31], v[144:147], v[128:131], v[112:127]
    v_exp_f32 v37, v37
    v_exp_f32 v38, v38
    v_exp_f32 v39, v39
    v_exp_f32 v40, v40
    v_exp_f32 v41, v41
    v_smfmac_f32_32x32x32_bf16 v[96:111], v[232:235], v[32:39], v10
    v_exp_f32 v42, v42
    v_exp_f32 v43, v43
    v_exp_f32 v44, v44
    v_exp_f32 v45, v45
    v_exp_f32 v46, v46
    v_exp_f32 v47, v47
    s_sub_u32 s57, s57, 1
    s_cmp_lg_u32 s57, 0
    s_cbranch_scc1 att_loop
    s_setprio 3
    v_smfmac_f32_32x32x32_bf16 v[96:111], v[236:239], v[40:47], v10
    v_cmp_ne_u32 vcc, s50, v245
    v_cmp_ne_u32 s[96:97], s50, v247
    s_nop 1
    s_or_b64 vcc, vcc, s[96:97]
    s_cbranch_scc0 att_gok
    v_add_u32 v12, 2048, v13
    s_mov_b32 s49, 200000
z_poll7:
    buffer_load_dwordx2 v[244:245], v13, s[4:7], 0 offen sc1
z_pchk9:
    s_waitcnt vmcnt(0)
    v_cmp_ne_u32 vcc, s50, v245
    s_nop 1
    s_and_b32 vcc_lo, vcc_lo, vcc_lo
    s_cbranch_scc0 z_pdone8
    s_sleep 2
    s_sub_u32 s49, s49, 1
    s_cmp_lg_u32 s49, 0
    s_cbranch_scc1 z_poll7
z_pdone8:
    s_mov_b32 s49, 200000
z_poll10:
    buffer_load_dwordx2 v[246:247], v12, s[4:7], 0 offen sc1
z_pchk12:
    s_waitcnt vmcnt(0)
    v_cmp_ne_u32 vcc, s50, v247
    s_nop 1
    s_and_b32 vcc_lo, vcc_lo, vcc_lo
    s_cbranch_scc0 z_pdone11
    s_sleep 2
    s_sub_u32 s49, s49, 1
    s_cmp_lg_u32 s49, 0
    s_cbranch_scc1 z_poll10
z_pdone11:
att_gok:
    s_nop 7
    v_mov_b32 v57, v56
    v_mov_b32 v73, v72
    v_mov_b32 v89, v88
    v_mov_b32 v105, v104
    s_nop 0
    v_permlane32_swap_b32 v56, v57
    v_permlane32_swap_b32 v72, v73
    v_permlane32_swap_b32 v88, v89
    v_permlane32_swap_b32 v104, v105
    s_cmp_lg_u32 s56, 0
    s_cbranch_scc1 att_fbnext
    v_min3_f32 v3, v56, v72, v88
    v_min_f32 v3, v3, v104
    v_add_f32 v4, v56, v72
    v_add_f32 v5, v88, v104
    v_add_f32 v4, v4, v5
    s_mov_b32 s47, 0x13800000
    s_mov_b32 s48, 0x5d800000
    v_cmp_le_f32 vcc, s47, v3
    v_cmp_ge_f32 s[96:97], s48, v4
    s_nop 1
    s_and_b64 vcc, vcc, s[96:97]
    s_cmp_eq_u64 vcc, -1
    s_cbranch_scc0 att_fallback
    v_mov_b32 v57, v112
    v_mov_b32 v73, v112
    v_mov_b32 v89, v112
    v_mov_b32 v105, v112
att_ok:
    s_mov_b32 s49, 1600000
z_lw13:
    ds_read_b32 v12, v7 offset:44
    s_waitcnt lgkmcnt(0)
    v_readfirstlane_b32 s48, v12
    s_nop 1
    s_cmp_ge_u32 s48, 4
    s_cbranch_scc1 z_lwd14
    s_sleep 1
    s_sub_u32 s49, s49, 1
    s_cmp_lg_u32 s49, 0
    s_cbranch_scc1 z_lw13
z_lwd14:
    s_mul_i32 s47, s44, 5120
    s_add_u32 s47, s47, 139264
    v_add_u32 v3, s47, v2
    v_lshl_add_u32 v5, v1, 3, s47
    s_xor_b32 s48, s44, 1
    s_mul_i32 s48, s48, 5120
    s_add_u32 s48, s48, 139264
    v_add_u32 v4, s48, v2
    v_lshl_add_u32 v6, v1, 3, s48
    s_lshr_b32 s47, s44, 1
    s_lshl_b32 s47, s47, 2
    v_add_u32 v7, s47, v7
    s_cmp_lg_u32 s54, 0
    s_cbranch_scc1 att_kh1
    ds_write_b128 v3, v[80:83] offset:0
    ds_write_b128 v3, v[84:87] offset:1024
    ds_write_b64 v5, v[88:89] offset:2048
    ds_write_b128 v3, v[96:99] offset:2560
    ds_write_b128 v3, v[100:103] offset:3584
    ds_write_b64 v5, v[104:105] offset:4608
    s_waitcnt lgkmcnt(0)
    s_mov_b64 exec, 1
    ds_add_u32 v7, v8 offset:32
    s_mov_b64 exec, -1
    s_mov_b32 s49, 1600000
z_lw15:
    ds_read_b32 v12, v7 offset:32
    s_waitcnt lgkmcnt(0)
    v_readfirstlane_b32 s48, v12
    s_nop 1
    s_cmp_ge_u32 s48, 2
    s_cbranch_scc1 z_lwd16
    s_sleep 1
    s_sub_u32 s49, s49, 1
    s_cmp_lg_u32 s49, 0
    s_cbranch_scc1 z_lw15
z_lwd16:
    ds_read_b128 v[16:19], v4 offset:0
    ds_read_b128 v[20:23], v4 offset:1024
    ds_read_b64 v[24:25], v6 offset:2048
    ds_read_b128 v[32:35], v4 offset:2560
    ds_read_b128 v[36:39], v4 offset:3584
    ds_read_b64 v[40:41], v6 offset:4608
    s_lshl_b32 s47, s46, 2
    s_add_u32 s47, s47, 0
    s_lshl_b32 s47, s47, 5
    s_add_u32 s47, s47, s53
    s_lshl_b32 s47, s47, 10
    s_add_u32 s47, s47, 8388608
    s_add_u32 s48, s47, 32768
    s_waitcnt lgkmcnt(0)
    v_min_f32 v12, v57, v25
    v_sub_f32 v58, v12, v57
    v_sub_f32 v26, v12, v25
    v_exp_f32 v58, v58
    v_exp_f32 v26, v26
    s_nop 0
    v_mul_f32 v12, v56, v58
    v_fma_f32 v12, v24, v26, v12
    v_rcp_f32 v12, v12
    s_nop 0
    v_mul_f32 v12, v12, v244
    v_mul_f32 v58, v58, v12
    v_mul_f32 v26, v26, v12
    v_mul_f32 v48, v48, v58
    v_mul_f32 v49, v49, v58
    v_mul_f32 v50, v50, v58
    v_mul_f32 v51, v51, v58
    v_mul_f32 v52, v52, v58
    v_mul_f32 v53, v53, v58
    v_mul_f32 v54, v54, v58
    v_mul_f32 v55, v55, v58
    v_fma_f32 v48, v16, v26, v48
    v_fma_f32 v49, v17, v26, v49
    v_fma_f32 v50, v18, v26, v50
    v_fma_f32 v51, v19, v26, v51
    v_fma_f32 v52, v20, v26, v52
    v_fma_f32 v53, v21, v26, v53
    v_fma_f32 v54, v22, v26, v54
    v_fma_f32 v55, v23, v26, v55
    v_cvt_pk_bf16_f32 v60, v48, v49
    v_cvt_pk_bf16_f32 v61, v50, v51
    v_cvt_pk_bf16_f32 v62, v52, v53
    v_cvt_pk_bf16_f32 v63, v54, v55
    buffer_store_dwordx4 v[60:63], v2, s[4:7], s47 offen sc1
    v_min_f32 v12, v73, v41
    v_sub_f32 v74, v12, v73
    v_sub_f32 v42, v12, v41
    v_exp_f32 v74, v74
    v_exp_f32 v42, v42
    s_nop 0
    v_mul_f32 v12, v72, v74
    v_fma_f32 v12, v40, v42, v12
    v_rcp_f32 v12, v12
    s_nop 0
    v_mul_f32 v12, v12, v246
    v_mul_f32 v74, v74, v12
    v_mul_f32 v42, v42, v12
    v_mul_f32 v64, v64, v74
    v_mul_f32 v65, v65, v74
    v_mul_f32 v66, v66, v74
    v_mul_f32 v67, v67, v74
    v_mul_f32 v68, v68, v74
    v_mul_f32 v69, v69, v74
    v_mul_f32 v70, v70, v74
    v_mul_f32 v71, v71, v74
    v_fma_f32 v64, v32, v42, v64
    v_fma_f32 v65, v33, v42, v65
    v_fma_f32 v66, v34, v42, v66
    v_fma_f32 v67, v35, v42, v67
    v_fma_f32 v68, v36, v42, v68
    v_fma_f32 v69, v37, v42, v69
    v_fma_f32 v70, v38, v42, v70
    v_fma_f32 v71, v39, v42, v71
    v_cvt_pk_bf16_f32 v76, v64, v65
    v_cvt_pk_bf16_f32 v77, v66, v67
    v_cvt_pk_bf16_f32 v78, v68, v69
    v_cvt_pk_bf16_f32 v79, v70, v71
    buffer_store_dwordx4 v[76:79], v2, s[4:7], s48 offen sc1
    s_branch att_pub
att_kh1:
    ds_write_b128 v3, v[48:51] offset:0
    ds_write_b128 v3, v[52:55] offset:1024
    ds_write_b64 v5, v[56:57] offset:2048
    ds_write_b128 v3, v[64:67] offset:2560
    ds_write_b128 v3, v[68:71] offset:3584
    ds_write_b64 v5, v[72:73] offset:4608
    s_waitcnt lgkmcnt(0)
    s_mov_b64 exec, 1
    ds_add_u32 v7, v8 offset:32
    s_mov_b64 exec, -1
    s_mov_b32 s49, 1600000
z_lw17:
    ds_read_b32 v12, v7 offset:32
    s_waitcnt lgkmcnt(0)
    v_readfirstlane_b32 s48, v12
    s_nop 1
    s_cmp_ge_u32 s48, 2
    s_cbranch_scc1 z_lwd18
    s_sleep 1
    s_sub_u32 s49, s49, 1
    s_cmp_lg_u32 s49, 0
    s_cbranch_scc1 z_lw17
z_lwd18:
    ds_read_b128 v[16:19], v4 offset:0
    ds_read_b128 v[20:23], v4 offset:1024
    ds_read_b64 v[24:25], v6 offset:2048
    ds_read_b128 v[32:35], v4 offset:2560
    ds_read_b128 v[36:39], v4 offset:3584
    ds_read_b64 v[40:41], v6 offset:4608
    s_lshl_b32 s47, s46, 2
    s_add_u32 s47, s47, 2
    s_lshl_b32 s47, s47, 5
    s_add_u32 s47, s47, s53
    s_lshl_b32 s47, s47, 10
    s_add_u32 s47, s47, 8388608
    s_add_u32 s48, s47, 32768
    s_waitcnt lgkmcnt(0)
    v_min_f32 v12, v89, v25
    v_sub_f32 v90, v12, v89
    v_sub_f32 v26, v12, v25
    v_exp_f32 v90, v90
    v_exp_f32 v26, v26
    s_nop 0
    v_mul_f32 v12, v88, v90
    v_fma_f32 v12, v24, v26, v12
    v_rcp_f32 v12, v12
    s_nop 0
    v_mul_f32 v12, v12, v244
    v_mul_f32 v90, v90, v12
    v_mul_f32 v26, v26, v12
    v_mul_f32 v80, v80, v90
    v_mul_f32 v81, v81, v90
    v_mul_f32 v82, v82, v90
    v_mul_f32 v83, v83, v90
    v_mul_f32 v84, v84, v90
    v_mul_f32 v85, v85, v90
    v_mul_f32 v86, v86, v90
    v_mul_f32 v87, v87, v90
    v_fma_f32 v80, v16, v26, v80
    v_fma_f32 v81, v17, v26, v81
    v_fma_f32 v82, v18, v26, v82
    v_fma_f32 v83, v19, v26, v83
    v_fma_f32 v84, v20, v26, v84
    v_fma_f32 v85, v21, v26, v85
    v_fma_f32 v86, v22, v26, v86
    v_fma_f32 v87, v23, v26, v87
    v_cvt_pk_bf16_f32 v92, v80, v81
    v_cvt_pk_bf16_f32 v93, v82, v83
    v_cvt_pk_bf16_f32 v94, v84, v85
    v_cvt_pk_bf16_f32 v95, v86, v87
    buffer_store_dwordx4 v[92:95], v2, s[4:7], s47 offen sc1
    v_min_f32 v12, v105, v41
    v_sub_f32 v106, v12, v105
    v_sub_f32 v42, v12, v41
    v_exp_f32 v106, v106
    v_exp_f32 v42, v42
    s_nop 0
    v_mul_f32 v12, v104, v106
    v_fma_f32 v12, v40, v42, v12
    v_rcp_f32 v12, v12
    s_nop 0
    v_mul_f32 v12, v12, v246
    v_mul_f32 v106, v106, v12
    v_mul_f32 v42, v42, v12
    v_mul_f32 v96, v96, v106
    v_mul_f32 v97, v97, v106
    v_mul_f32 v98, v98, v106
    v_mul_f32 v99, v99, v106
    v_mul_f32 v100, v100, v106
    v_mul_f32 v101, v101, v106
    v_mul_f32 v102, v102, v106
    v_mul_f32 v103, v103, v106
    v_fma_f32 v96, v32, v42, v96
    v_fma_f32 v97, v33, v42, v97
    v_fma_f32 v98, v34, v42, v98
    v_fma_f32 v99, v35, v42, v99
    v_fma_f32 v100, v36, v42, v100
    v_fma_f32 v101, v37, v42, v101
    v_fma_f32 v102, v38, v42, v102
    v_fma_f32 v103, v39, v42, v103
    v_cvt_pk_bf16_f32 v108, v96, v97
    v_cvt_pk_bf16_f32 v109, v98, v99
    v_cvt_pk_bf16_f32 v110, v100, v101
    v_cvt_pk_bf16_f32 v111, v102, v103
    buffer_store_dwordx4 v[108:111], v2, s[4:7], s48 offen sc1
att_pub:
    s_lshl_b32 s47, s46, 1
    s_add_u32 s47, s47, s54
    s_lshl_b32 s47, s47, 5
    s_add_u32 s47, s47, s53
    s_lshl_b32 s47, s47, 7
    s_add_u32 s47, s47, 18874368
    s_waitcnt vmcnt(0)
    v_mov_b32 v3, s50
    s_mov_b64 exec, 1
    buffer_store_dword v3, v2, s[4:7], s47 offen sc1
    s_mov_b64 exec, -1
    s_endpgm
att_fallback:
    s_waitcnt vmcnt(0)
    s_mov_b32 s14, 65536
    s_mov_b32 s55, 0
    v_mov_b32 v240, 0xff800000
    v_mov_b32 v241, 0xff800000
    v_mov_b32 v242, 0xff800000
    v_mov_b32 v243, 0xff800000
att_fb:
    buffer_load_dwordx4 v[144:147], v2, s[12:15], s55 offen sc1
    s_waitcnt vmcnt(0)
    v_mfma_f32_32x32x16_bf16 v[48:63], v[144:147], v[128:131], 0
    v_mfma_f32_32x32x16_bf16 v[64:79], v[144:147], v[132:135], 0
    v_mfma_f32_32x32x16_bf16 v[80:95], v[144:147], v[136:139], 0
    v_mfma_f32_32x32x16_bf16 v[96:111], v[144:147], v[140:143], 0
    s_nop 11
    v_max3_f32 v240, v240, v48, v49
    v_max3_f32 v240, v240, v50, v51
    v_max3_f32 v240, v240, v52, v53
    v_max3_f32 v240, v240, v54, v55
    v_max3_f32 v240, v240, v56, v57
    v_max3_f32 v240, v240, v58, v59
    v_max3_f32 v240, v240, v60, v61
    v_max3_f32 v240, v240, v62, v63
    v_max3_f32 v241, v241, v64, v65
    v_max3_f32 v241, v241, v66, v67
    v_max3_f32 v241, v241, v68, v69
    v_max3_f32 v241, v241, v70, v71
    v_max3_f32 v241, v241, v72, v73
    v_max3_f32 v241, v241, v74, v75
    v_max3_f32 v241, v241, v76, v77
    v_max3_f32 v241, v241, v78, v79
    v_max3_f32 v242, v242, v80, v81
    v_max3_f32 v242, v242, v82, v83
    v_max3_f32 v242, v242, v84, v85
    v_max3_f32 v242, v242, v86, v87
    v_max3_f32 v242, v242, v88, v89
    v_max3_f32 v242, v242, v90, v91
    v_max3_f32 v242, v242, v92, v93
    v_max3_f32 v242, v242, v94, v95
    v_max3_f32 v243, v243, v96, v97
    v_max3_f32 v243, v243, v98, v99
    v_max3_f32 v243, v243, v100, v101
    v_max3_f32 v243, v243, v102, v103
    v_max3_f32 v243, v243, v104, v105
    v_max3_f32 v243, v243, v106, v107
    v_max3_f32 v243, v243, v108, v109
    v_max3_f32 v243, v243, v110, v111
    s_add_u32 s55, s55, 2048
    s_cmp_lt_u32 s55, 65536
    s_cbranch_scc1 att_fb
    v_mov_b32 v3, v240
    s_nop 1
    v_permlane32_swap_b32 v3, v240
    s_nop 1
    v_max_f32 v240, v3, v240
    v_mov_b32 v3, v241
    s_nop 1
    v_permlane32_swap_b32 v3, v241
    s_nop 1
    v_max_f32 v241, v3, v241
    v_mov_b32 v3, v242
    s_nop 1
    v_permlane32_swap_b32 v3, v242
    s_nop 1
    v_max_f32 v242, v3, v242
    v_mov_b32 v3, v243
    s_nop 1
    v_permlane32_swap_b32 v3, v243
    s_nop 1
    v_max_f32 v243, v3, v243
    s_lshl_b32 s59, s2, 2
    s_add_u32 s59, s59, s44
    s_mul_i32 s59, s59, 12288
    s_add_u32 s59, s59, 33554432
    s_branch att_fbrun
att_fbnext:
    s_waitcnt vmcnt(0)
    s_cmp_lg_u32 s56, 1
    s_cbranch_scc1 z_fbs19
    v_mov_b32 v57, v112
    s_add_u32 s47, s59, 0
    buffer_store_dwordx4 v[48:51], v2, s[4:7], s47 offen offset:0 sc1
    buffer_store_dwordx4 v[52:55], v2, s[4:7], s47 offen offset:1024 sc1
    buffer_store_dwordx4 v[56:59], v2, s[4:7], s47 offen offset:2048 sc1
z_fbs19:
    s_cmp_lg_u32 s56, 2
    s_cbranch_scc1 z_fbs20
    v_mov_b32 v73, v112
    s_add_u32 s47, s59, 3072
    buffer_store_dwordx4 v[64:67], v2, s[4:7], s47 offen offset:0 sc1
    buffer_store_dwordx4 v[68:71], v2, s[4:7], s47 offen offset:1024 sc1
    buffer_store_dwordx4 v[72:75], v2, s[4:7], s47 offen offset:2048 sc1
z_fbs20:
    s_cmp_lg_u32 s56, 3
    s_cbranch_scc1 z_fbs21
    v_mov_b32 v89, v112
    s_add_u32 s47, s59, 6144
    buffer_store_dwordx4 v[80:83], v2, s[4:7], s47 offen offset:0 sc1
    buffer_store_dwordx4 v[84:87], v2, s[4:7], s47 offen offset:1024 sc1
    buffer_store_dwordx4 v[88:91], v2, s[4:7], s47 offen offset:2048 sc1
z_fbs21:
    s_cmp_lg_u32 s56, 4
    s_cbranch_scc1 z_fbs22
    v_mov_b32 v105, v112
    s_add_u32 s47, s59, 9216
    buffer_store_dwordx4 v[96:99], v2, s[4:7], s47 offen offset:0 sc1
    buffer_store_dwordx4 v[100:103], v2, s[4:7], s47 offen offset:1024 sc1
    buffer_store_dwordx4 v[104:107], v2, s[4:7], s47 offen offset:2048 sc1
z_fbs22:
    s_waitcnt vmcnt(0)
    s_cmp_lt_u32 s56, 4
    s_cbranch_scc1 att_fbrun
    s_add_u32 s47, s59, 0
    buffer_load_dwordx4 v[48:51], v2, s[4:7], s47 offen offset:0 sc1
    buffer_load_dwordx4 v[52:55], v2, s[4:7], s47 offen offset:1024 sc1
    buffer_load_dwordx4 v[56:59], v2, s[4:7], s47 offen offset:2048 sc1
    s_add_u32 s47, s59, 3072
    buffer_load_dwordx4 v[64:67], v2, s[4:7], s47 offen offset:0 sc1
    buffer_load_dwordx4 v[68:71], v2, s[4:7], s47 offen offset:1024 sc1
    buffer_load_dwordx4 v[72:75], v2, s[4:7], s47 offen offset:2048 sc1
    s_add_u32 s47, s59, 6144
    buffer_load_dwordx4 v[80:83], v2, s[4:7], s47 offen offset:0 sc1
    buffer_load_dwordx4 v[84:87], v2, s[4:7], s47 offen offset:1024 sc1
    buffer_load_dwordx4 v[88:91], v2, s[4:7], s47 offen offset:2048 sc1
    s_add_u32 s47, s59, 9216
    buffer_load_dwordx4 v[96:99], v2, s[4:7], s47 offen offset:0 sc1
    buffer_load_dwordx4 v[100:103], v2, s[4:7], s47 offen offset:1024 sc1
    buffer_load_dwordx4 v[104:107], v2, s[4:7], s47 offen offset:2048 sc1
    s_waitcnt vmcnt(0)
    s_branch att_ok
att_fbrun:
    s_mov_b32 s14, 65536
    s_setprio 0
    s_add_u32 s56, s56, 1
    v_sub_f32 v112, 0, v240
    v_sub_f32 v113, 0, v240
    v_sub_f32 v114, 0, v240
    v_sub_f32 v115, 0, v240
    v_sub_f32 v116, 0, v240
    v_sub_f32 v117, 0, v240
    v_sub_f32 v118, 0, v240
    v_sub_f32 v119, 0, v240
    v_sub_f32 v120, 0, v240
    v_sub_f32 v121, 0, v240
    v_sub_f32 v122, 0, v240
    v_sub_f32 v123, 0, v240
    v_sub_f32 v124, 0, v240
    v_sub_f32 v125, 0, v240
    v_sub_f32 v126, 0, v240
    v_sub_f32 v127, 0, v240
    v_mov_b32 v240, v241
    v_mov_b32 v241, v242
    v_mov_b32 v242, v243
    v_mov_b32 v48, 0
    v_mov_b32 v49, 0
    v_mov_b32 v50, 0
    v_mov_b32 v51, 0
    v_mov_b32 v52, 0
    v_mov_b32 v53, 0
    v_mov_b32 v54, 0
    v_mov_b32 v55, 0
    v_mov_b32 v56, 0
    v_mov_b32 v57, 0
    v_mov_b32 v58, 0
    v_mov_b32 v59, 0
    v_mov_b32 v60, 0
    v_mov_b32 v61, 0
    v_mov_b32 v62, 0
    v_mov_b32 v63, 0
    v_mov_b32 v64, 0
    v_mov_b32 v65, 0
    v_mov_b32 v66, 0
    v_mov_b32 v67, 0
    v_mov_b32 v68, 0
    v_mov_b32 v69, 0
    v_mov_b32 v70, 0
    v_mov_b32 v71, 0
    v_mov_b32 v72, 0
    v_mov_b32 v73, 0
    v_mov_b32 v74, 0
    v_mov_b32 v75, 0
    v_mov_b32 v76, 0
    v_mov_b32 v77, 0
    v_mov_b32 v78, 0
    v_mov_b32 v79, 0
    v_mov_b32 v80, 0
    v_mov_b32 v81, 0
    v_mov_b32 v82, 0
    v_mov_b32 v83, 0
    v_mov_b32 v84, 0
    v_mov_b32 v85, 0
    v_mov_b32 v86, 0
    v_mov_b32 v87, 0
    v_mov_b32 v88, 0
    v_mov_b32 v89, 0
    v_mov_b32 v90, 0
    v_mov_b32 v91, 0
    v_mov_b32 v92, 0
    v_mov_b32 v93, 0
    v_mov_b32 v94, 0
    v_mov_b32 v95, 0
    v_mov_b32 v96, 0
    v_mov_b32 v97, 0
    v_mov_b32 v98, 0
    v_mov_b32 v99, 0
    v_mov_b32 v100, 0
    v_mov_b32 v101, 0
    v_mov_b32 v102, 0
    v_mov_b32 v103, 0
    v_mov_b32 v104, 0
    v_mov_b32 v105, 0
    v_mov_b32 v106, 0
    v_mov_b32 v107, 0
    v_mov_b32 v108, 0
    v_mov_b32 v109, 0
    v_mov_b32 v110, 0
    v_mov_b32 v111, 0
    v_mov_b32 v40, 0
    v_mov_b32 v41, 0
    v_mov_b32 v42, 0
    v_mov_b32 v43, 0
    v_mov_b32 v44, 0
    v_mov_b32 v45, 0
    v_mov_b32 v46, 0
    v_mov_b32 v47, 0
    s_mov_b32 s55, 0
    s_add_u32 s55, s55, 4096
    s_and_b32 s55, s55, 0xffff
    s_setprio 3
    buffer_load_dwordx4 v[144:147], v2, s[12:15], s55 offen sc1
    buffer_load_dwordx4 v[156:159], v2, s[12:15], s55 offen offset:2048 sc1
    s_mov_b64 exec, s[60:61]
    buffer_load_dwordx4 v[148:151], v9, s[12:15], s55 offen offset:1024 sc1
    buffer_load_dwordx4 v[152:155], v9, s[12:15], s55 offen offset:1536 sc1
    buffer_load_dwordx4 v[160:163], v9, s[12:15], s55 offen offset:3072 sc1
    buffer_load_dwordx4 v[164:167], v9, s[12:15], s55 offen offset:3584 sc1
    s_mov_b64 exec, -1
    s_setprio 0
    s_add_u32 s55, s55, 4096
    s_and_b32 s55, s55, 0xffff
    s_setprio 3
    buffer_load_dwordx4 v[168:171], v2, s[12:15], s55 offen sc1
    buffer_load_dwordx4 v[180:183], v2, s[12:15], s55 offen offset:2048 sc1
    s_mov_b64 exec, s[60:61]
    buffer_load_dwordx4 v[172:175], v9, s[12:15], s55 offen offset:1024 sc1
    buffer_load_dwordx4 v[176:179], v9, s[12:15], s55 offen offset:1536 sc1
    buffer_load_dwordx4 v[184:187], v9, s[12:15], s55 offen offset:3072 sc1
    buffer_load_dwordx4 v[188:191], v9, s[12:15], s55 offen offset:3584 sc1
    s_mov_b64 exec, -1
    s_setprio 0
    s_add_u32 s55, s55, 4096
    s_and_b32 s55, s55, 0xffff
    s_setprio 3
    buffer_load_dwordx4 v[192:195], v2, s[12:15], s55 offen sc1
    buffer_load_dwordx4 v[204:207], v2, s[12:15], s55 offen offset:2048 sc1
    s_mov_b64 exec, s[60:61]
    buffer_load_dwordx4 v[196:199], v9, s[12:15], s55 offen offset:1024 sc1
    buffer_load_dwordx4 v[200:203], v9, s[12:15], s55 offen offset:1536 sc1
    buffer_load_dwordx4 v[208:211], v9, s[12:15], s55 offen offset:3072 sc1
    buffer_load_dwordx4 v[212:215], v9, s[12:15], s55 offen offset:3584 sc1
    s_mov_b64 exec, -1
    s_setprio 0
    s_mov_b32 s57, 4
    s_waitcnt vmcnt(0)
    v_mfma_f32_32x32x16_bf16 v[16:31], v[144:147], v[128:131], v[112:127]
    s_nop 11
    s_branch att_loop
k_cons:
    s_setprio 2
    s_waitcnt lgkmcnt(0)
    v_lshlrev_b32 v3, 18, v1
    s_cmp_lg_u32 s101, 0
    s_cbranch_scc1 z_tw23
    v_min_u32 v4, 524284, v3
    global_load_dword v252, v4, s[30:31]
    v_min_u32 v4, 1835004, v3
    global_load_dword v252, v4, s[32:33]
z_tw23:
    s_cmp_lg_u32 s101, 1
    s_cbranch_scc1 z_tw24
    v_min_u32 v4, 1835004, v3
    global_load_dword v252, v4, s[34:35]
    v_min_u32 v4, 524284, v3
    global_load_dword v252, v4, s[24:25]
z_tw24:
    s_cmp_lg_u32 s101, 2
    s_cbranch_scc1 z_tw25
    v_min_u32 v4, 524284, v3
    global_load_dword v252, v4, s[28:29]
    v_min_u32 v4, 2097148, v3
    global_load_dword v252, v4, s[38:39]
z_tw25:
    s_cmp_lg_u32 s101, 3
    s_cbranch_scc1 z_tw26
z_tw26:
    s_lshl_b32 s47, s52, 2
    s_add_u32 s47, s47, s101
    s_cmp_ge_u32 s47, 2
    s_cbranch_scc1 k_notw
    s_lshl_b32 s47, s47, 24
    v_add_u32 v4, s47, v3
    v_min_u32 v4, 19005436, v4
    global_load_dword v252, v4, s[42:43] sc1
k_notw:
    v_mov_b32 v3, 0
    v_lshl_add_u32 v4, v1, 2, v7
    ds_write_b32 v4, v3
    ds_write_b32 v4, v3 offset:448
    ds_write_b32 v4, v3 offset:704
    v_add_u32 v4, -576, v4
    ds_write_b32 v4, v3
    v_and_b32 v3, 31, v1
    s_lshl_b32 s47, s101, 5
    v_add_u32 v3, s47, v3
    v_bfe_u32 v4, v3, 1, 3
    v_lshrrev_b32 v5, 5, v1
    v_xor_b32 v4, v4, v5
    v_lshlrev_b32 v4, 4, v4
    v_lshl_add_u32 v12, v3, 7, v4
    v_xor_b32 v13, 32, v12
    v_xor_b32 v14, 64, v12
    v_xor_b32 v15, 96, v12
    v_bfe_u32 v3, v1, 4, 1
    v_lshlrev_b32 v6, 5, v3
    v_lshl_add_u32 v6, v5, 9, v6
    v_bfe_u32 v3, v1, 2, 2
    v_lshl_add_u32 v6, v3, 6, v6
    v_and_b32 v3, 3, v1
    v_lshl_add_u32 v6, v3, 3, v6
    v_add_u32 v16, 49152, v6
    s_lshl_b32 s47, s46, 7
    s_lshl_b32 s48, s45, 3
    s_add_u32 s47, s47, s48
    s_lshl_b32 s48, s101, 1
    s_add_u32 s55, s47, s48
    s_lshl_b32 s47, s46, 2
    s_add_u32 s53, s47, s101
    s_lshl_b32 s47, s45, 18
    s_lshr_b32 s49, s101, 1
    s_lshl_b32 s49, s49, 16
    s_add_u32 s47, s47, s49
    s_lshl_b32 s49, s46, 12
    s_add_u32 s47, s47, s49
    s_and_b32 s49, s101, 1
    s_lshl_b32 s49, s49, 11
    s_add_u32 s54, s47, s49
    s_add_u32 s56, s54, 131072
    s_lshl_b32 s57, s51, 2
    s_and_b32 s47, s52, 3
    s_add_u32 s57, s57, s47
    s_lshr_b32 s58, s52, 2
    s_and_b32 s59, s101, 1
    s_lshr_b32 s60, s101, 1
    v_lshrrev_b32 v3, 3, v1
    v_bfe_u32 v4, v1, 4, 1
    v_lshlrev_b32 v4, 2, v4
    v_and_b32 v5, 7, v1
    v_xor_b32 v4, v4, v5
    v_lshlrev_b32 v9, 10, v3
    v_lshl_add_u32 v9, v4, 4, v9
    s_lshl_b32 s47, s58, 7
    v_add_u32 v9, s47, v9
    s_waitcnt lgkmcnt(0)
    s_mov_b32 s8, s20
    s_mov_b32 s9, s21
    s_mov_b32 s4, s42
    s_mov_b32 s5, s43
    s_mov_b32 s16, s40
    s_mov_b32 s17, s41
    s_mov_b32 s18, 256
    s_mov_b32 s19, 0x00020000
    s_mov_b32 s12, s30
    s_mov_b32 s13, s31
    s_mov_b32 s14, 524288
    s_mov_b32 s15, 0x00020000
    s_or_b32 s47, s2, s101
    s_cmp_lg_u32 s47, 0
    s_cbranch_scc1 k_nononce
    s_memrealtime s[96:97]
    s_waitcnt lgkmcnt(0)
    s_or_b32 s96, s96, 1
    v_mov_b32 v3, s96
    s_mov_b64 exec, 1
    buffer_store_dword v3, v2, s[16:19], 0 offen sc1
    s_mov_b64 exec, -1
k_nononce:
    s_lshl_b32 s96, s57, 1
    s_add_u32 s96, s96, s59
    s_lshr_b32 s47, s51, 1
    s_lshl_b32 s98, s47, 2
    s_and_b32 s47, s52, 3
    s_add_u32 s98, s98, s47
    s_lshl_b32 s98, s98, 2
    s_add_u32 s98, s98, s101
    s_and_b32 s48, s51, 1
    s_mul_i32 s99, s48, 7
    s_add_u32 s99, s99, s58
    s_cmp_lt_u32 s58, 7
    s_cselect_b32 s97, 1, 0
    s_lshl_b32 s100, s47, 1
    s_add_u32 s100, s100, s58
    s_and_b32 s100, s100, 15
    s_lshl_b32 s47, s55, 10
    buffer_load_dwordx4 v[20:23], v2, s[8:11], s47 offen
    buffer_load_dwordx4 v[24:27], v2, s[8:11], s47 offen offset:1024
    global_load_dwordx4 v[28:31], v2, s[36:37]
    s_waitcnt lgkmcnt(0)
    s_barrier
    ds_read_b128 v[128:131], v12 offset:0
    ds_read_b64_tr_b16 v[80:81], v16 offset:0
    ds_read_b64_tr_b16 v[82:83], v16 offset:256
    ds_read_b64_tr_b16 v[84:85], v16 offset:4096
    ds_read_b64_tr_b16 v[86:87], v16 offset:4352
    ds_read_b64_tr_b16 v[88:89], v16 offset:8192
    ds_read_b64_tr_b16 v[90:91], v16 offset:8448
    ds_read_b128 v[132:135], v13 offset:0
    ds_read_b64_tr_b16 v[92:93], v16 offset:1024
    ds_read_b64_tr_b16 v[94:95], v16 offset:1280
    ds_read_b64_tr_b16 v[96:97], v16 offset:5120
    ds_read_b64_tr_b16 v[98:99], v16 offset:5376
    ds_read_b64_tr_b16 v[100:101], v16 offset:9216
    ds_read_b64_tr_b16 v[102:103], v16 offset:9472
    s_waitcnt lgkmcnt(7)
    v_mfma_f32_32x32x16_bf16 v[32:47], v[80:83], v[128:131], 0
    ds_read_b128 v[136:139], v14 offset:0
    ds_read_b64_tr_b16 v[104:105], v16 offset:2048
    ds_read_b64_tr_b16 v[106:107], v16 offset:2304
    ds_read_b64_tr_b16 v[108:109], v16 offset:6144
    v_mfma_f32_32x32x16_bf16 v[48:63], v[84:87], v[128:131], 0
    ds_read_b64_tr_b16 v[110:111], v16 offset:6400
    ds_read_b64_tr_b16 v[112:113], v16 offset:10240
    ds_read_b64_tr_b16 v[114:115], v16 offset:10496
    v_mfma_f32_32x32x16_bf16 v[64:79], v[88:91], v[128:131], 0
    s_waitcnt lgkmcnt(7)
    v_mfma_f32_32x32x16_bf16 v[32:47], v[92:95], v[132:135], v[32:47]
    ds_read_b128 v[140:143], v15 offset:0
    ds_read_b64_tr_b16 v[116:117], v16 offset:3072
    ds_read_b64_tr_b16 v[118:119], v16 offset:3328
    ds_read_b64_tr_b16 v[120:121], v16 offset:7168
    v_mfma_f32_32x32x16_bf16 v[48:63], v[96:99], v[132:135], v[48:63]
    ds_read_b64_tr_b16 v[122:123], v16 offset:7424
    ds_read_b64_tr_b16 v[124:125], v16 offset:11264
    ds_read_b64_tr_b16 v[126:127], v16 offset:11520
    v_mfma_f32_32x32x16_bf16 v[64:79], v[100:103], v[132:135], v[64:79]
    s_waitcnt lgkmcnt(0)
    s_barrier
    v_mfma_f32_32x32x16_bf16 v[32:47], v[104:107], v[136:139], v[32:47]
    ds_read_b128 v[144:147], v12 offset:16384
    ds_read_b64_tr_b16 v[80:81], v16 offset:12288
    ds_read_b64_tr_b16 v[82:83], v16 offset:12544
    ds_read_b64_tr_b16 v[84:85], v16 offset:16384
    v_mfma_f32_32x32x16_bf16 v[48:63], v[108:111], v[136:139], v[48:63]
    ds_read_b64_tr_b16 v[86:87], v16 offset:16640
    ds_read_b64_tr_b16 v[88:89], v16 offset:20480
    ds_read_b64_tr_b16 v[90:91], v16 offset:20736
    v_mfma_f32_32x32x16_bf16 v[64:79], v[112:115], v[136:139], v[64:79]
    v_mfma_f32_32x32x16_bf16 v[32:47], v[116:119], v[140:143], v[32:47]
    ds_read_b128 v[148:151], v13 offset:16384
    ds_read_b64_tr_b16 v[92:93], v16 offset:13312
    ds_read_b64_tr_b16 v[94:95], v16 offset:13568
    ds_read_b64_tr_b16 v[96:97], v16 offset:17408
    v_mfma_f32_32x32x16_bf16 v[48:63], v[120:123], v[140:143], v[48:63]
    ds_read_b64_tr_b16 v[98:99], v16 offset:17664
    ds_read_b64_tr_b16 v[100:101], v16 offset:21504
    ds_read_b64_tr_b16 v[102:103], v16 offset:21760
    v_mfma_f32_32x32x16_bf16 v[64:79], v[124:127], v[140:143], v[64:79]
    s_waitcnt lgkmcnt(7)
    v_mfma_f32_32x32x16_bf16 v[32:47], v[80:83], v[144:147], v[32:47]
    ds_read_b128 v[152:155], v14 offset:16384
    ds_read_b64_tr_b16 v[104:105], v16 offset:14336
    ds_read_b64_tr_b16 v[106:107], v16 offset:14592
    ds_read_b64_tr_b16 v[108:109], v16 offset:18432
    v_mfma_f32_32x32x16_bf16 v[48:63], v[84:87], v[144:147], v[48:63]
    ds_read_b64_tr_b16 v[110:111], v16 offset:18688
    ds_read_b64_tr_b16 v[112:113], v16 offset:22528
    ds_read_b64_tr_b16 v[114:115], v16 offset:22784
    v_mfma_f32_32x32x16_bf16 v[64:79], v[88:91], v[144:147], v[64:79]
    s_waitcnt lgkmcnt(7)
    v_mfma_f32_32x32x16_bf16 v[32:47], v[92:95], v[148:151], v[32:47]
    ds_read_b128 v[156:159], v15 offset:16384
    ds_read_b64_tr_b16 v[116:117], v16 offset:15360
    ds_read_b64_tr_b16 v[118:119], v16 offset:15616
    ds_read_b64_tr_b16 v[120:121], v16 offset:19456
    v_mfma_f32_32x32x16_bf16 v[48:63], v[96:99], v[148:151], v[48:63]
    ds_read_b64_tr_b16 v[122:123], v16 offset:19712
    ds_read_b64_tr_b16 v[124:125], v16 offset:23552
    ds_read_b64_tr_b16 v[126:127], v16 offset:23808
    v_mfma_f32_32x32x16_bf16 v[64:79], v[100:103], v[148:151], v[64:79]
    s_waitcnt lgkmcnt(0)
    s_barrier
    v_mfma_f32_32x32x16_bf16 v[32:47], v[104:107], v[152:155], v[32:47]
    ds_read_b128 v[160:163], v12 offset:32768
    ds_read_b64_tr_b16 v[80:81], v16 offset:24576
    ds_read_b64_tr_b16 v[82:83], v16 offset:24832
    ds_read_b64_tr_b16 v[84:85], v16 offset:28672
    v_mfma_f32_32x32x16_bf16 v[48:63], v[108:111], v[152:155], v[48:63]
    ds_read_b64_tr_b16 v[86:87], v16 offset:28928
    ds_read_b64_tr_b16 v[88:89], v16 offset:32768
    ds_read_b64_tr_b16 v[90:91], v16 offset:33024
    v_mfma_f32_32x32x16_bf16 v[64:79], v[112:115], v[152:155], v[64:79]
    v_mfma_f32_32x32x16_bf16 v[32:47], v[116:119], v[156:159], v[32:47]
    ds_read_b128 v[164:167], v13 offset:32768
    ds_read_b64_tr_b16 v[92:93], v16 offset:25600
    ds_read_b64_tr_b16 v[94:95], v16 offset:25856
    ds_read_b64_tr_b16 v[96:97], v16 offset:29696
    v_mfma_f32_32x32x16_bf16 v[48:63], v[120:123], v[156:159], v[48:63]
    ds_read_b64_tr_b16 v[98:99], v16 offset:29952
    ds_read_b64_tr_b16 v[100:101], v16 offset:33792
    ds_read_b64_tr_b16 v[102:103], v16 offset:34048
    v_mfma_f32_32x32x16_bf16 v[64:79], v[124:127], v[156:159], v[64:79]
    s_waitcnt lgkmcnt(7)
    v_mfma_f32_32x32x16_bf16 v[32:47], v[80:83], v[160:163], v[32:47]
    ds_read_b128 v[168:171], v14 offset:32768
    ds_read_b64_tr_b16 v[104:105], v16 offset:26624
    ds_read_b64_tr_b16 v[106:107], v16 offset:26880
    ds_read_b64_tr_b16 v[108:109], v16 offset:30720
    v_mfma_f32_32x32x16_bf16 v[48:63], v[84:87], v[160:163], v[48:63]
    ds_read_b64_tr_b16 v[110:111], v16 offset:30976
    ds_read_b64_tr_b16 v[112:113], v16 offset:34816
    ds_read_b64_tr_b16 v[114:115], v16 offset:35072
    v_mfma_f32_32x32x16_bf16 v[64:79], v[88:91], v[160:163], v[64:79]
    s_waitcnt lgkmcnt(7)
    v_mfma_f32_32x32x16_bf16 v[32:47], v[92:95], v[164:167], v[32:47]
    ds_read_b128 v[172:175], v15 offset:32768
    ds_read_b64_tr_b16 v[116:117], v16 offset:27648
    ds_read_b64_tr_b16 v[118:119], v16 offset:27904
    ds_read_b64_tr_b16 v[120:121], v16 offset:31744
    v_mfma_f32_32x32x16_bf16 v[48:63], v[96:99], v[164:167], v[48:63]
    ds_read_b64_tr_b16 v[122:123], v16 offset:32000
    ds_read_b64_tr_b16 v[124:125], v16 offset:35840
    ds_read_b64_tr_b16 v[126:127], v16 offset:36096
    v_mfma_f32_32x32x16_bf16 v[64:79], v[100:103], v[164:167], v[64:79]
    s_waitcnt lgkmcnt(0)
    s_barrier
    v_mfma_f32_32x32x16_bf16 v[32:47], v[104:107], v[168:171], v[32:47]
    ds_read_b128 v[176:179], v12 offset:0
    ds_read_b64_tr_b16 v[80:81], v16 offset:0
    ds_read_b64_tr_b16 v[82:83], v16 offset:256
    ds_read_b64_tr_b16 v[84:85], v16 offset:4096
    v_mfma_f32_32x32x16_bf16 v[48:63], v[108:111], v[168:171], v[48:63]
    ds_read_b64_tr_b16 v[86:87], v16 offset:4352
    ds_read_b64_tr_b16 v[88:89], v16 offset:8192
    ds_read_b64_tr_b16 v[90:91], v16 offset:8448
    v_mfma_f32_32x32x16_bf16 v[64:79], v[112:115], v[168:171], v[64:79]
    v_mfma_f32_32x32x16_bf16 v[32:47], v[116:119], v[172:175], v[32:47]
    ds_read_b128 v[180:183], v13 offset:0
    ds_read_b64_tr_b16 v[92:93], v16 offset:1024
    ds_read_b64_tr_b16 v[94:95], v16 offset:1280
    ds_read_b64_tr_b16 v[96:97], v16 offset:5120
    v_mfma_f32_32x32x16_bf16 v[48:63], v[120:123], v[172:175], v[48:63]
    ds_read_b64_tr_b16 v[98:99], v16 offset:5376
    ds_read_b64_tr_b16 v[100:101], v16 offset:9216
    ds_read_b64_tr_b16 v[102:103], v16 offset:9472
    v_mfma_f32_32x32x16_bf16 v[64:79], v[124:127], v[172:175], v[64:79]
    s_waitcnt lgkmcnt(7)
    v_mfma_f32_32x32x16_bf16 v[32:47], v[80:83], v[176:179], v[32:47]
    ds_read_b128 v[184:187], v14 offset:0
    ds_read_b64_tr_b16 v[104:105], v16 offset:2048
    ds_read_b64_tr_b16 v[106:107], v16 offset:2304
    ds_read_b64_tr_b16 v[108:109], v16 offset:6144
    v_mfma_f32_32x32x16_bf16 v[48:63], v[84:87], v[176:179], v[48:63]
    ds_read_b64_tr_b16 v[110:111], v16 offset:6400
    ds_read_b64_tr_b16 v[112:113], v16 offset:10240
    ds_read_b64_tr_b16 v[114:115], v16 offset:10496
    v_mfma_f32_32x32x16_bf16 v[64:79], v[88:91], v[176:179], v[64:79]
    s_waitcnt lgkmcnt(7)
    v_mfma_f32_32x32x16_bf16 v[32:47], v[92:95], v[180:183], v[32:47]
    ds_read_b128 v[188:191], v15 offset:0
    ds_read_b64_tr_b16 v[116:117], v16 offset:3072
    ds_read_b64_tr_b16 v[118:119], v16 offset:3328
    ds_read_b64_tr_b16 v[120:121], v16 offset:7168
    v_mfma_f32_32x32x16_bf16 v[48:63], v[96:99], v[180:183], v[48:63]
    ds_read_b64_tr_b16 v[122:123], v16 offset:7424
    ds_read_b64_tr_b16 v[124:125], v16 offset:11264
    ds_read_b64_tr_b16 v[126:127], v16 offset:11520
    v_mfma_f32_32x32x16_bf16 v[64:79], v[100:103], v[180:183], v[64:79]
    s_waitcnt lgkmcnt(0)
    s_barrier
    v_mfma_f32_32x32x16_bf16 v[32:47], v[104:107], v[184:187], v[32:47]
    ds_read_b128 v[192:195], v12 offset:16384
    ds_read_b64_tr_b16 v[80:81], v16 offset:12288
    ds_read_b64_tr_b16 v[82:83], v16 offset:12544
    ds_read_b64_tr_b16 v[84:85], v16 offset:16384
    v_mfma_f32_32x32x16_bf16 v[48:63], v[108:111], v[184:187], v[48:63]
    ds_read_b64_tr_b16 v[86:87], v16 offset:16640
    ds_read_b64_tr_b16 v[88:89], v16 offset:20480
    ds_read_b64_tr_b16 v[90:91], v16 offset:20736
    v_mfma_f32_32x32x16_bf16 v[64:79], v[112:115], v[184:187], v[64:79]
    v_mfma_f32_32x32x16_bf16 v[32:47], v[116:119], v[188:191], v[32:47]
    ds_read_b128 v[196:199], v13 offset:16384
    ds_read_b64_tr_b16 v[92:93], v16 offset:13312
    ds_read_b64_tr_b16 v[94:95], v16 offset:13568
    ds_read_b64_tr_b16 v[96:97], v16 offset:17408
    v_mfma_f32_32x32x16_bf16 v[48:63], v[120:123], v[188:191], v[48:63]
    ds_read_b64_tr_b16 v[98:99], v16 offset:17664
    ds_read_b64_tr_b16 v[100:101], v16 offset:21504
    ds_read_b64_tr_b16 v[102:103], v16 offset:21760
    v_mfma_f32_32x32x16_bf16 v[64:79], v[124:127], v[188:191], v[64:79]
    s_waitcnt lgkmcnt(7)
    v_mfma_f32_32x32x16_bf16 v[32:47], v[80:83], v[192:195], v[32:47]
    ds_read_b128 v[200:203], v14 offset:16384
    ds_read_b64_tr_b16 v[104:105], v16 offset:14336
    ds_read_b64_tr_b16 v[106:107], v16 offset:14592
    ds_read_b64_tr_b16 v[108:109], v16 offset:18432
    v_mfma_f32_32x32x16_bf16 v[48:63], v[84:87], v[192:195], v[48:63]
    ds_read_b64_tr_b16 v[110:111], v16 offset:18688
    ds_read_b64_tr_b16 v[112:113], v16 offset:22528
    ds_read_b64_tr_b16 v[114:115], v16 offset:22784
    v_mfma_f32_32x32x16_bf16 v[64:79], v[88:91], v[192:195], v[64:79]
    s_waitcnt lgkmcnt(7)
    v_mfma_f32_32x32x16_bf16 v[32:47], v[92:95], v[196:199], v[32:47]
    ds_read_b128 v[204:207], v15 offset:16384
    ds_read_b64_tr_b16 v[116:117], v16 offset:15360
    ds_read_b64_tr_b16 v[118:119], v16 offset:15616
    ds_read_b64_tr_b16 v[120:121], v16 offset:19456
    v_mfma_f32_32x32x16_bf16 v[48:63], v[96:99], v[196:199], v[48:63]
    ds_read_b64_tr_b16 v[122:123], v16 offset:19712
    ds_read_b64_tr_b16 v[124:125], v16 offset:23552
    ds_read_b64_tr_b16 v[126:127], v16 offset:23808
    v_mfma_f32_32x32x16_bf16 v[64:79], v[100:103], v[196:199], v[64:79]
    s_waitcnt lgkmcnt(0)
    s_barrier
    v_mfma_f32_32x32x16_bf16 v[32:47], v[104:107], v[200:203], v[32:47]
    ds_read_b128 v[208:211], v12 offset:32768
    ds_read_b64_tr_b16 v[80:81], v16 offset:24576
    ds_read_b64_tr_b16 v[82:83], v16 offset:24832
    ds_read_b64_tr_b16 v[84:85], v16 offset:28672
    v_mfma_f32_32x32x16_bf16 v[48:63], v[108:111], v[200:203], v[48:63]
    ds_read_b64_tr_b16 v[86:87], v16 offset:28928
    ds_read_b64_tr_b16 v[88:89], v16 offset:32768
    ds_read_b64_tr_b16 v[90:91], v16 offset:33024
    v_mfma_f32_32x32x16_bf16 v[64:79], v[112:115], v[200:203], v[64:79]
    v_mfma_f32_32x32x16_bf16 v[32:47], v[116:119], v[204:207], v[32:47]
    ds_read_b128 v[212:215], v13 offset:32768
    ds_read_b64_tr_b16 v[92:93], v16 offset:25600
    ds_read_b64_tr_b16 v[94:95], v16 offset:25856
    ds_read_b64_tr_b16 v[96:97], v16 offset:29696
    v_mfma_f32_32x32x16_bf16 v[48:63], v[120:123], v[204:207], v[48:63]
    ds_read_b64_tr_b16 v[98:99], v16 offset:29952
    ds_read_b64_tr_b16 v[100:101], v16 offset:33792
    ds_read_b64_tr_b16 v[102:103], v16 offset:34048
    v_mfma_f32_32x32x16_bf16 v[64:79], v[124:127], v[204:207], v[64:79]
    s_waitcnt lgkmcnt(7)
    v_mfma_f32_32x32x16_bf16 v[32:47], v[80:83], v[208:211], v[32:47]
    ds_read_b128 v[216:219], v14 offset:32768
    ds_read_b64_tr_b16 v[104:105], v16 offset:26624
    ds_read_b64_tr_b16 v[106:107], v16 offset:26880
    ds_read_b64_tr_b16 v[108:109], v16 offset:30720
    v_mfma_f32_32x32x16_bf16 v[48:63], v[84:87], v[208:211], v[48:63]
    ds_read_b64_tr_b16 v[110:111], v16 offset:30976
    ds_read_b64_tr_b16 v[112:113], v16 offset:34816
    ds_read_b64_tr_b16 v[114:115], v16 offset:35072
    v_mfma_f32_32x32x16_bf16 v[64:79], v[88:91], v[208:211], v[64:79]
    s_waitcnt lgkmcnt(7)
    v_mfma_f32_32x32x16_bf16 v[32:47], v[92:95], v[212:215], v[32:47]
    ds_read_b128 v[220:223], v15 offset:32768
    ds_read_b64_tr_b16 v[116:117], v16 offset:27648
    ds_read_b64_tr_b16 v[118:119], v16 offset:27904
    ds_read_b64_tr_b16 v[120:121], v16 offset:31744
    v_mfma_f32_32x32x16_bf16 v[48:63], v[96:99], v[212:215], v[48:63]
    ds_read_b64_tr_b16 v[122:123], v16 offset:32000
    ds_read_b64_tr_b16 v[124:125], v16 offset:35840
    ds_read_b64_tr_b16 v[126:127], v16 offset:36096
    v_mfma_f32_32x32x16_bf16 v[64:79], v[100:103], v[212:215], v[64:79]
    s_waitcnt vmcnt(0)
    s_waitcnt lgkmcnt(0)
    s_barrier
    v_mfma_f32_32x32x16_bf16 v[32:47], v[104:107], v[216:219], v[32:47]
    ds_read_b128 v[224:227], v12 offset:0
    ds_read_b64_tr_b16 v[80:81], v16 offset:0
    ds_read_b64_tr_b16 v[82:83], v16 offset:256
    ds_read_b64_tr_b16 v[84:85], v16 offset:4096
    v_mfma_f32_32x32x16_bf16 v[48:63], v[108:111], v[216:219], v[48:63]
    ds_read_b64_tr_b16 v[86:87], v16 offset:4352
    ds_read_b64_tr_b16 v[88:89], v16 offset:8192
    ds_read_b64_tr_b16 v[90:91], v16 offset:8448
    v_mfma_f32_32x32x16_bf16 v[64:79], v[112:115], v[216:219], v[64:79]
    v_mfma_f32_32x32x16_bf16 v[32:47], v[116:119], v[220:223], v[32:47]
    ds_read_b128 v[228:231], v13 offset:0
    ds_read_b64_tr_b16 v[92:93], v16 offset:1024
    ds_read_b64_tr_b16 v[94:95], v16 offset:1280
    ds_read_b64_tr_b16 v[96:97], v16 offset:5120
    v_mfma_f32_32x32x16_bf16 v[48:63], v[120:123], v[220:223], v[48:63]
    ds_read_b64_tr_b16 v[98:99], v16 offset:5376
    ds_read_b64_tr_b16 v[100:101], v16 offset:9216
    ds_read_b64_tr_b16 v[102:103], v16 offset:9472
    v_mfma_f32_32x32x16_bf16 v[64:79], v[124:127], v[220:223], v[64:79]
    s_waitcnt lgkmcnt(7)
    v_mfma_f32_32x32x16_bf16 v[32:47], v[80:83], v[224:227], v[32:47]
    ds_read_b128 v[232:235], v14 offset:0
    ds_read_b64_tr_b16 v[104:105], v16 offset:2048
    ds_read_b64_tr_b16 v[106:107], v16 offset:2304
    ds_read_b64_tr_b16 v[108:109], v16 offset:6144
    v_mfma_f32_32x32x16_bf16 v[48:63], v[84:87], v[224:227], v[48:63]
    ds_read_b64_tr_b16 v[110:111], v16 offset:6400
    ds_read_b64_tr_b16 v[112:113], v16 offset:10240
    ds_read_b64_tr_b16 v[114:115], v16 offset:10496
    v_mfma_f32_32x32x16_bf16 v[64:79], v[88:91], v[224:227], v[64:79]
    s_waitcnt lgkmcnt(7)
    v_mfma_f32_32x32x16_bf16 v[32:47], v[92:95], v[228:231], v[32:47]
    ds_read_b128 v[236:239], v15 offset:0
    ds_read_b64_tr_b16 v[116:117], v16 offset:3072
    ds_read_b64_tr_b16 v[118:119], v16 offset:3328
    ds_read_b64_tr_b16 v[120:121], v16 offset:7168
    v_mfma_f32_32x32x16_bf16 v[48:63], v[96:99], v[228:231], v[48:63]
    ds_read_b64_tr_b16 v[122:123], v16 offset:7424
    ds_read_b64_tr_b16 v[124:125], v16 offset:11264
    ds_read_b64_tr_b16 v[126:127], v16 offset:11520
    v_mfma_f32_32x32x16_bf16 v[64:79], v[100:103], v[228:231], v[64:79]
    v_mov_b32 v3, 0
    buffer_load_dword v19, v3, s[16:19], 0 offen sc1
    s_waitcnt lgkmcnt(0)
    s_barrier
    v_mfma_f32_32x32x16_bf16 v[32:47], v[104:107], v[232:235], v[32:47]
    ds_read_b128 v[240:243], v12 offset:16384
    ds_read_b64_tr_b16 v[80:81], v16 offset:12288
    ds_read_b64_tr_b16 v[82:83], v16 offset:12544
    ds_read_b64_tr_b16 v[84:85], v16 offset:16384
    v_mfma_f32_32x32x16_bf16 v[48:63], v[108:111], v[232:235], v[48:63]
    ds_read_b64_tr_b16 v[86:87], v16 offset:16640
    ds_read_b64_tr_b16 v[88:89], v16 offset:20480
    ds_read_b64_tr_b16 v[90:91], v16 offset:20736
    v_mfma_f32_32x32x16_bf16 v[64:79], v[112:115], v[232:235], v[64:79]
    v_mfma_f32_32x32x16_bf16 v[32:47], v[116:119], v[236:239], v[32:47]
    ds_read_b128 v[244:247], v13 offset:16384
    ds_read_b64_tr_b16 v[92:93], v16 offset:13312
    ds_read_b64_tr_b16 v[94:95], v16 offset:13568
    ds_read_b64_tr_b16 v[96:97], v16 offset:17408
    v_mfma_f32_32x32x16_bf16 v[48:63], v[120:123], v[236:239], v[48:63]
    ds_read_b64_tr_b16 v[98:99], v16 offset:17664
    ds_read_b64_tr_b16 v[100:101], v16 offset:21504
    ds_read_b64_tr_b16 v[102:103], v16 offset:21760
    v_mfma_f32_32x32x16_bf16 v[64:79], v[124:127], v[236:239], v[64:79]
    s_waitcnt lgkmcnt(7)
    v_mfma_f32_32x32x16_bf16 v[32:47], v[80:83], v[240:243], v[32:47]
    ds_read_b128 v[248:251], v14 offset:16384
    ds_read_b64_tr_b16 v[104:105], v16 offset:14336
    ds_read_b64_tr_b16 v[106:107], v16 offset:14592
    ds_read_b64_tr_b16 v[108:109], v16 offset:18432
    v_mfma_f32_32x32x16_bf16 v[48:63], v[84:87], v[240:243], v[48:63]
    ds_read_b64_tr_b16 v[110:111], v16 offset:18688
    ds_read_b64_tr_b16 v[112:113], v16 offset:22528
    ds_read_b64_tr_b16 v[114:115], v16 offset:22784
    v_mfma_f32_32x32x16_bf16 v[64:79], v[88:91], v[240:243], v[64:79]
    s_waitcnt lgkmcnt(7)
    v_mfma_f32_32x32x16_bf16 v[32:47], v[92:95], v[244:247], v[32:47]
    ds_read_b128 v[252:255], v15 offset:16384
    ds_read_b64_tr_b16 v[116:117], v16 offset:15360
    ds_read_b64_tr_b16 v[118:119], v16 offset:15616
    ds_read_b64_tr_b16 v[120:121], v16 offset:19456
    v_mfma_f32_32x32x16_bf16 v[48:63], v[96:99], v[244:247], v[48:63]
    ds_read_b64_tr_b16 v[122:123], v16 offset:19712
    ds_read_b64_tr_b16 v[124:125], v16 offset:23552
    ds_read_b64_tr_b16 v[126:127], v16 offset:23808
    v_mfma_f32_32x32x16_bf16 v[64:79], v[100:103], v[244:247], v[64:79]
    s_waitcnt lgkmcnt(0)
    v_mfma_f32_32x32x16_bf16 v[32:47], v[104:107], v[248:251], v[32:47]
    v_mfma_f32_32x32x16_bf16 v[48:63], v[108:111], v[248:251], v[48:63]
    v_mfma_f32_32x32x16_bf16 v[64:79], v[112:115], v[248:251], v[64:79]
    v_mfma_f32_32x32x16_bf16 v[32:47], v[116:119], v[252:255], v[32:47]
    v_mfma_f32_32x32x16_bf16 v[48:63], v[120:123], v[252:255], v[48:63]
    v_mfma_f32_32x32x16_bf16 v[64:79], v[124:127], v[252:255], v[64:79]
    s_lshl_b32 s48, s101, 11
    s_add_u32 s48, s48, 147456
    v_and_b32 v3, 31, v1
    v_lshlrev_b32 v3, 5, v3
    v_lshrrev_b32 v5, 5, v1
    v_lshl_add_u32 v3, v5, 3, v3
    v_add_u32 v3, s48, v3
    v_add_u32 v6, s48, v2
    v_lshrrev_b32 v17, 4, v1
    v_lshlrev_b32 v17, 8, v17
    v_bfe_u32 v4, v1, 2, 2
    v_lshl_add_u32 v17, v4, 5, v17
    v_and_b32 v4, 3, v1
    v_lshl_add_u32 v17, v4, 3, v17
    v_add_u32 v17, s48, v17
    v_cvt_pk_bf16_f32 v96, v64, v65
    v_cvt_pk_bf16_f32 v97, v66, v67
    v_cvt_pk_bf16_f32 v98, v68, v69
    v_cvt_pk_bf16_f32 v99, v70, v71
    v_cvt_pk_bf16_f32 v100, v72, v73
    v_cvt_pk_bf16_f32 v101, v74, v75
    v_cvt_pk_bf16_f32 v102, v76, v77
    v_cvt_pk_bf16_f32 v103, v78, v79
    ds_write_b64 v3, v[96:97] offset:1024
    ds_write_b64 v3, v[98:99] offset:1040
    ds_write_b64 v3, v[100:101] offset:9216
    ds_write_b64 v3, v[102:103] offset:9232
    v_cvt_pk_bf16_f32 v88, v48, v49
    v_cvt_pk_bf16_f32 v89, v50, v51
    v_cvt_pk_bf16_f32 v90, v52, v53
    v_cvt_pk_bf16_f32 v91, v54, v55
    v_cvt_pk_bf16_f32 v92, v56, v57
    v_cvt_pk_bf16_f32 v93, v58, v59
    v_cvt_pk_bf16_f32 v94, v60, v61
    v_cvt_pk_bf16_f32 v95, v62, v63
    buffer_store_dwordx4 v[88:91], v2, s[4:7], s54 offen sc1
    buffer_store_dwordx4 v[92:95], v2, s[4:7], s56 offen sc1
    s_waitcnt lgkmcnt(0)
    ds_read_b64_tr_b16 v[96:97], v17 offset:1024
    ds_read_b64_tr_b16 v[98:99], v17 offset:1152
    ds_read_b64_tr_b16 v[100:101], v17 offset:9216
    ds_read_b64_tr_b16 v[102:103], v17 offset:9344
    ds_write_b128 v6, v[88:91] offset:0
    ds_write_b128 v6, v[92:95] offset:8192
    s_mov_b32 s47, 0x3eb8aa3b
    v_mul_f32 v32, s47, v32
    v_mul_f32 v33, s47, v33
    v_mul_f32 v34, s47, v34
    v_mul_f32 v35, s47, v35
    v_mul_f32 v36, s47, v36
    v_mul_f32 v37, s47, v37
    v_mul_f32 v38, s47, v38
    v_mul_f32 v39, s47, v39
    v_mul_f32 v40, s47, v40
    v_mul_f32 v41, s47, v41
    v_mul_f32 v42, s47, v42
    v_mul_f32 v43, s47, v43
    v_mul_f32 v44, s47, v44
    v_mul_f32 v45, s47, v45
    v_mul_f32 v46, s47, v46
    v_mul_f32 v47, s47, v47
    s_waitcnt lgkmcnt(2)
    buffer_store_dwordx4 v[96:99], v2, s[4:7], s54 offen offset:1024 sc1
    buffer_store_dwordx4 v[100:103], v2, s[4:7], s56 offen offset:1024 sc1
    ds_write_b128 v6, v[96:99] offset:1024
    ds_write_b128 v6, v[100:103] offset:9216
    v_cvt_pk_bf16_f32 v80, v32, v33
    v_cvt_pk_bf16_f32 v81, v34, v35
    v_cvt_pk_bf16_f32 v82, v36, v37
    v_cvt_pk_bf16_f32 v83, v38, v39
    v_cvt_pk_bf16_f32 v84, v40, v41
    v_cvt_pk_bf16_f32 v85, v42, v43
    v_cvt_pk_bf16_f32 v86, v44, v45
    v_cvt_pk_bf16_f32 v87, v46, v47
    s_lshl_b32 s47, s101, 10
    s_add_u32 s47, s47, 139264
    v_add_u32 v3, s47, v2
    ds_write_b128 v3, v[80:83]
    ds_write_b128 v3, v[84:87] offset:4096
    s_waitcnt vmcnt(4)
    s_mov_b32 s49, 200000
k_tagchk:
    v_readfirstlane_b32 s50, v19
    s_nop 1
    s_cmp_lg_u32 s50, 0
    s_cbranch_scc1 k_tagok
    v_mov_b32 v3, 0
    buffer_load_dword v19, v3, s[16:19], 0 offen sc1
    s_waitcnt vmcnt(0)
    s_sub_u32 s49, s49, 1
    s_cmp_lg_u32 s49, 0
    s_cbranch_scc1 k_tagchk
k_tagok:
    v_mov_b32 v3, 133632
    ds_write_b32 v3, v19
    v_add_u32 v16, 49152, v16
    s_lshl_b32 s47, s101, 13
    v_add_u32 v11, s47, v16
    s_lshl_b32 s61, s101, 14
    s_and_b32 s47, s100, 7
    s_lshl_b32 s47, s47, 14
    s_lshl_b32 s63, s101, 17
    s_xor_b32 s63, s63, s47
    s_lshl_b32 s47, s45, 7
    s_add_u32 s47, s47, s53
    s_lshl_b32 s47, s47, 7
    s_add_u32 s3, s47, 18219008
    s_waitcnt lgkmcnt(0)
    s_mov_b64 exec, 1
    ds_add_u32 v7, v8 offset:56
    s_mov_b64 exec, -1
    s_setprio 3
    s_waitcnt vmcnt(0)
    v_mov_b32 v17, s50
    s_mov_b64 exec, 1
    buffer_store_dword v17, v2, s[4:7], s3 offen sc1
    s_mov_b64 exec, -1
    s_mov_b32 s49, 1600000
z_lw27:
    ds_read_b32 v17, v7 offset:60
    s_waitcnt lgkmcnt(0)
    v_readfirstlane_b32 s48, v17
    s_nop 1
    s_cmp_ge_u32 s48, 4
    s_cbranch_scc1 z_lwd28
    s_sleep 1
    s_sub_u32 s49, s49, 1
    s_cmp_lg_u32 s49, 0
    s_cbranch_scc1 z_lw27
z_lwd28:
    s_mov_b32 s49, 1600000
z_lw29:
    ds_read_b32 v17, v7 offset:56
    s_waitcnt lgkmcnt(0)
    v_readfirstlane_b32 s48, v17
    s_nop 1
    s_cmp_ge_u32 s48, 4
    s_cbranch_scc1 z_lwd30
    s_sleep 1
    s_sub_u32 s49, s49, 1
    s_cmp_lg_u32 s49, 0
    s_cbranch_scc1 z_lw29
z_lwd30:
    s_lshl_b32 s47, s101, 8
    s_add_u32 s47, s47, 131072
    v_and_b32 v3, 31, v1
    v_lshl_add_u32 v4, v3, 3, s47
    ds_read_b64 v[68:69], v4
    v_mov_b32 v11, v16
    ds_read_b64_tr_b16 v[104:105], v11 offset:0
    ds_read_b64_tr_b16 v[106:107], v11 offset:256
    ds_read_b64_tr_b16 v[108:109], v11 offset:1024
    ds_read_b64_tr_b16 v[110:111], v11 offset:1280
    ds_read_b64_tr_b16 v[112:113], v11 offset:2048
    ds_read_b64_tr_b16 v[114:115], v11 offset:2304
    ds_read_b64_tr_b16 v[116:117], v11 offset:3072
    ds_read_b64_tr_b16 v[118:119], v11 offset:3328
    ds_read_b64_tr_b16 v[120:121], v11 offset:4096
    ds_read_b64_tr_b16 v[122:123], v11 offset:4352
    ds_read_b64_tr_b16 v[124:125], v11 offset:5120
    ds_read_b64_tr_b16 v[126:127], v11 offset:5376
    s_waitcnt lgkmcnt(10)
    v_mfma_f32_32x32x16_bf16 v[32:47], v[104:107], v[128:131], 0
    v_mul_f32 v13, 0x3b000000, v68
    v_mul_f32 v3, v13, v13
    ds_read_b64_tr_b16 v[104:105], v11 offset:6144
    ds_read_b64_tr_b16 v[106:107], v11 offset:6400
    s_waitcnt lgkmcnt(10)
    v_mfma_f32_32x32x16_bf16 v[32:47], v[108:111], v[132:135], v[32:47]
    v_mov_b32 v4, 0x3b000000
    v_fma_f32 v3, v69, v4, -v3
    ds_read_b64_tr_b16 v[108:109], v11 offset:7168
    ds_read_b64_tr_b16 v[110:111], v11 offset:7424
    s_waitcnt lgkmcnt(10)
    v_mfma_f32_32x32x16_bf16 v[32:47], v[112:115], v[136:139], v[32:47]
    v_max_f32 v3, 0, v3
    v_add_f32 v3, 0x3727c5ac, v3
    ds_read_b64_tr_b16 v[112:113], v11 offset:8192
    ds_read_b64_tr_b16 v[114:115], v11 offset:8448
    s_waitcnt lgkmcnt(10)
    v_mfma_f32_32x32x16_bf16 v[32:47], v[116:119], v[140:143], v[32:47]
    v_rsq_f32 v4, v3
    s_nop 0
    ds_read_b64_tr_b16 v[116:117], v11 offset:9216
    ds_read_b64_tr_b16 v[118:119], v11 offset:9472
    s_waitcnt lgkmcnt(10)
    v_mfma_f32_32x32x16_bf16 v[32:47], v[120:123], v[144:147], v[32:47]
    v_mul_f32 v16, v3, v4
    v_mul_f32 v12, 0xc0135761, v4
    ds_read_b64_tr_b16 v[120:121], v11 offset:10240
    ds_read_b64_tr_b16 v[122:123], v11 offset:10496
    s_waitcnt lgkmcnt(10)
    v_mfma_f32_32x32x16_bf16 v[32:47], v[124:127], v[148:151], v[32:47]
    v_mul_f32 v14, v4, v4
    v_mul_f32 v14, v14, v4
    ds_read_b64_tr_b16 v[124:125], v11 offset:11264
    ds_read_b64_tr_b16 v[126:127], v11 offset:11520
    s_waitcnt lgkmcnt(10)
    v_mfma_f32_32x32x16_bf16 v[32:47], v[104:107], v[152:155], v[32:47]
    v_mul_f32 v14, 0xbdd2d3e8, v14
    v_cvt_pk_bf16_f32 v48, -v13, -v13
    v_and_b32 v3, 0xffff0000, v48
    v_add_f32 v3, v3, v13
    v_cvt_pk_bf16_f32 v49, -v3, 0
    v_mov_b32 v50, 0
    v_mov_b32 v51, 0
    s_mov_b32 exec_lo, 0
    v_mov_b32 v48, 0
    v_mov_b32 v49, 0
    s_mov_b32 exec_lo, -1
    ds_read_b64_tr_b16 v[104:105], v11 offset:12288
    ds_read_b64_tr_b16 v[106:107], v11 offset:12544
    s_waitcnt lgkmcnt(10)
    v_mfma_f32_32x32x16_bf16 v[32:47], v[108:111], v[156:159], v[32:47]
    v_mov_b32 v54, 0
    v_mov_b32 v55, 0
    ds_read_b64_tr_b16 v[108:109], v11 offset:13312
    ds_read_b64_tr_b16 v[110:111], v11 offset:13568
    s_waitcnt lgkmcnt(10)
    v_mfma_f32_32x32x16_bf16 v[32:47], v[112:115], v[160:163], v[32:47]
    s_lshr_b32 s47, s45, 2
    s_lshr_b32 s48, s47, 1
    ds_read_b64_tr_b16 v[112:113], v11 offset:14336
    ds_read_b64_tr_b16 v[114:115], v11 offset:14592
    s_waitcnt lgkmcnt(10)
    v_mfma_f32_32x32x16_bf16 v[32:47], v[116:119], v[164:167], v[32:47]
    s_add_u32 s48, s48, 1
    s_sub_u32 s49, 0, s48
    s_add_u32 m0, s61, 0
    s_xor_b32 s30, s63, 0
    s_waitcnt vmcnt(8)
    buffer_load_dwordx4 v9, s[12:15], s30 offen lds
    ds_read_b64_tr_b16 v[116:117], v11 offset:15360
    ds_read_b64_tr_b16 v[118:119], v11 offset:15616
    s_waitcnt lgkmcnt(10)
    v_mfma_f32_32x32x16_bf16 v[32:47], v[120:123], v[168:171], v[32:47]
    s_bitcmp1_b32 s47, 0
    s_cselect_b32 s48, s49, s48
    s_add_u32 m0, s61, 1024
    s_xor_b32 s30, s63, 8192
    s_waitcnt vmcnt(8)
    buffer_load_dwordx4 v9, s[12:15], s30 offen lds
    ds_read_b64_tr_b16 v[120:121], v11 offset:16384
    ds_read_b64_tr_b16 v[122:123], v11 offset:16640
    s_waitcnt lgkmcnt(10)
    v_mfma_f32_32x32x16_bf16 v[32:47], v[124:127], v[172:175], v[32:47]
    s_lshl_b32 s47, s53, 5
    s_add_u32 s47, s47, s48
    s_add_u32 m0, s61, 2048
    s_xor_b32 s30, s63, 16384
    s_waitcnt vmcnt(8)
    buffer_load_dwordx4 v9, s[12:15], s30 offen lds
    ds_read_b64_tr_b16 v[124:125], v11 offset:17408
    ds_read_b64_tr_b16 v[126:127], v11 offset:17664
    s_waitcnt lgkmcnt(10)
    v_mfma_f32_32x32x16_bf16 v[32:47], v[104:107], v[176:179], v[32:47]
    v_and_b32 v3, 31, v1
    v_lshlrev_b32 v4, 2, v3
    s_add_u32 m0, s61, 3072
    s_xor_b32 s30, s63, 24576
    s_waitcnt vmcnt(8)
    buffer_load_dwordx4 v9, s[12:15], s30 offen lds
    ds_read_b64_tr_b16 v[104:105], v11 offset:18432
    ds_read_b64_tr_b16 v[106:107], v11 offset:18688
    s_waitcnt lgkmcnt(10)
    v_mfma_f32_32x32x16_bf16 v[32:47], v[108:111], v[180:183], v[32:47]
    v_add_u32 v3, s47, v3
    s_movk_i32 s48, 2048
    s_add_u32 m0, s61, 4096
    s_xor_b32 s30, s63, 32768
    s_waitcnt vmcnt(8)
    buffer_load_dwordx4 v9, s[12:15], s30 offen lds
    ds_read_b64_tr_b16 v[108:109], v11 offset:19456
    ds_read_b64_tr_b16 v[110:111], v11 offset:19712
    s_waitcnt lgkmcnt(10)
    v_mfma_f32_32x32x16_bf16 v[32:47], v[112:115], v[184:187], v[32:47]
    v_cmp_gt_u32 vcc, s48, v3
    v_and_b32 v3, 2047, v3
    s_add_u32 m0, s61, 5120
    s_xor_b32 s30, s63, 40960
    s_waitcnt vmcnt(8)
    buffer_load_dwordx4 v9, s[12:15], s30 offen lds
    ds_read_b64_tr_b16 v[112:113], v11 offset:20480
    ds_read_b64_tr_b16 v[114:115], v11 offset:20736
    s_waitcnt lgkmcnt(10)
    v_mfma_f32_32x32x16_bf16 v[32:47], v[116:119], v[188:191], v[32:47]
    v_lshrrev_b32 v6, 5, v3
    v_lshlrev_b32 v6, 15, v6
    s_add_u32 m0, s61, 6144
    s_xor_b32 s30, s63, 49152
    s_waitcnt vmcnt(8)
    buffer_load_dwordx4 v9, s[12:15], s30 offen lds
    ds_read_b64_tr_b16 v[116:117], v11 offset:21504
    ds_read_b64_tr_b16 v[118:119], v11 offset:21760
    s_waitcnt lgkmcnt(10)
    v_mfma_f32_32x32x16_bf16 v[32:47], v[120:123], v[192:195], v[32:47]
    v_and_b32 v3, 31, v3
    v_lshl_add_u32 v6, v3, 4, v6
    s_add_u32 m0, s61, 7168
    s_xor_b32 s30, s63, 57344
    s_waitcnt vmcnt(8)
    buffer_load_dwordx4 v9, s[12:15], s30 offen lds
    ds_read_b64_tr_b16 v[120:121], v11 offset:22528
    ds_read_b64_tr_b16 v[122:123], v11 offset:22784
    s_waitcnt lgkmcnt(10)
    v_mfma_f32_32x32x16_bf16 v[32:47], v[124:127], v[196:199], v[32:47]
    v_lshl_add_u32 v6, v5, 9, v6
    v_add_u32 v4, 133120, v4
    s_add_u32 m0, s61, 8192
    s_xor_b32 s30, s63, 65536
    s_waitcnt vmcnt(8)
    buffer_load_dwordx4 v9, s[12:15], s30 offen lds
    ds_read_b64_tr_b16 v[124:125], v11 offset:23552
    ds_read_b64_tr_b16 v[126:127], v11 offset:23808
    s_waitcnt lgkmcnt(10)
    v_mfma_f32_32x32x16_bf16 v[32:47], v[104:107], v[200:203], v[32:47]
    s_add_u32 m0, s61, 9216
    s_xor_b32 s30, s63, 73728
    s_waitcnt vmcnt(8)
    buffer_load_dwordx4 v9, s[12:15], s30 offen lds
    ds_read_b64_tr_b16 v[104:105], v11 offset:24576
    ds_read_b64_tr_b16 v[106:107], v11 offset:24832
    s_waitcnt lgkmcnt(10)
    v_mfma_f32_32x32x16_bf16 v[32:47], v[108:111], v[204:207], v[32:47]
    s_add_u32 m0, s61, 10240
    s_xor_b32 s30, s63, 81920
    s_waitcnt vmcnt(8)
    buffer_load_dwordx4 v9, s[12:15], s30 offen lds
    ds_read_b64_tr_b16 v[108:109], v11 offset:25600
    ds_read_b64_tr_b16 v[110:111], v11 offset:25856
    s_waitcnt lgkmcnt(10)
    v_mfma_f32_32x32x16_bf16 v[32:47], v[112:115], v[208:211], v[32:47]
    s_add_u32 m0, s61, 11264
    s_xor_b32 s30, s63, 90112
    s_waitcnt vmcnt(8)
    buffer_load_dwordx4 v9, s[12:15], s30 offen lds
    ds_read_b64_tr_b16 v[112:113], v11 offset:26624
    ds_read_b64_tr_b16 v[114:115], v11 offset:26880
    s_waitcnt lgkmcnt(10)
    v_mfma_f32_32x32x16_bf16 v[32:47], v[116:119], v[212:215], v[32:47]
    s_add_u32 m0, s61, 12288
    s_xor_b32 s30, s63, 98304
    s_waitcnt vmcnt(8)
    buffer_load_dwordx4 v9, s[12:15], s30 offen lds
    ds_read_b64_tr_b16 v[116:117], v11 offset:27648
    ds_read_b64_tr_b16 v[118:119], v11 offset:27904
    s_waitcnt lgkmcnt(10)
    v_mfma_f32_32x32x16_bf16 v[32:47], v[120:123], v[216:219], v[32:47]
    s_add_u32 m0, s61, 13312
    s_xor_b32 s30, s63, 106496
    s_waitcnt vmcnt(8)
    buffer_load_dwordx4 v9, s[12:15], s30 offen lds
    ds_read_b64_tr_b16 v[120:121], v11 offset:28672
    ds_read_b64_tr_b16 v[122:123], v11 offset:28928
    s_waitcnt lgkmcnt(10)
    v_mfma_f32_32x32x16_bf16 v[32:47], v[124:127], v[220:223], v[32:47]
    s_add_u32 m0, s61, 14336
    s_xor_b32 s30, s63, 114688
    s_waitcnt vmcnt(8)
    buffer_load_dwordx4 v9, s[12:15], s30 offen lds
    ds_read_b64_tr_b16 v[124:125], v11 offset:29696
    ds_read_b64_tr_b16 v[126:127], v11 offset:29952
    s_waitcnt lgkmcnt(10)
    v_mfma_f32_32x32x16_bf16 v[32:47], v[104:107], v[224:227], v[32:47]
    s_add_u32 m0, s61, 15360
    s_xor_b32 s30, s63, 122880
    s_waitcnt vmcnt(8)
    buffer_load_dwordx4 v9, s[12:15], s30 offen lds
    ds_read_b64_tr_b16 v[104:105], v11 offset:30720
    ds_read_b64_tr_b16 v[106:107], v11 offset:30976
    s_waitcnt lgkmcnt(10)
    v_mfma_f32_32x32x16_bf16 v[32:47], v[108:111], v[228:231], v[32:47]
    ds_read_b64_tr_b16 v[108:109], v11 offset:31744
    ds_read_b64_tr_b16 v[110:111], v11 offset:32000
    s_waitcnt lgkmcnt(10)
    v_mfma_f32_32x32x16_bf16 v[32:47], v[112:115], v[232:235], v[32:47]
    s_waitcnt lgkmcnt(8)
    v_mfma_f32_32x32x16_bf16 v[32:47], v[116:119], v[236:239], v[32:47]
    s_waitcnt lgkmcnt(6)
    v_mfma_f32_32x32x16_bf16 v[32:47], v[120:123], v[240:243], v[32:47]
    s_waitcnt lgkmcnt(4)
    v_mfma_f32_32x32x16_bf16 v[32:47], v[124:127], v[244:247], v[32:47]
    s_waitcnt lgkmcnt(2)
    v_mfma_f32_32x32x16_bf16 v[32:47], v[104:107], v[248:251], v[32:47]
    s_waitcnt lgkmcnt(0)
    v_mfma_f32_32x32x16_bf16 v[32:47], v[108:111], v[252:255], v[32:47]
    s_mov_b64 exec, 1
    ds_add_u32 v7, v8 offset:20
    s_mov_b64 exec, -1
    ds_read_b32 v17, v4
    s_waitcnt lgkmcnt(0)
    v_cvt_pk_bf16_f32 v53, v17, 0
    v_lshlrev_b32 v3, 16, v53
    v_sub_f32 v3, v17, v3
    v_cvt_pk_bf16_f32 v52, v17, v3
    s_nop 1
    v_mfma_f32_32x32x16_bf16 v[32:47], v[52:55], v[48:51], v[32:47]
    s_lshl_b32 s47, s45, 11
    s_add_u32 s47, s47, 4194304
    s_nop 9
    v_pk_mul_f32 v[144:145], v[32:33], v[32:33]
    v_pk_mul_f32 v[146:147], v[34:35], v[34:35]
    v_pk_mul_f32 v[148:149], v[36:37], v[36:37]
    v_pk_mul_f32 v[150:151], v[38:39], v[38:39]
    v_pk_mul_f32 v[152:153], v[40:41], v[40:41]
    v_pk_mul_f32 v[154:155], v[42:43], v[42:43]
    v_pk_mul_f32 v[156:157], v[44:45], v[44:45]
    v_pk_mul_f32 v[158:159], v[46:47], v[46:47]
    v_pk_fma_f32 v[144:145], v[144:145], v[14:15], v[12:13] op_sel_hi:[1,0,0]
    v_pk_fma_f32 v[146:147], v[146:147], v[14:15], v[12:13] op_sel_hi:[1,0,0]
    v_pk_fma_f32 v[148:149], v[148:149], v[14:15], v[12:13] op_sel_hi:[1,0,0]
    v_pk_fma_f32 v[150:151], v[150:151], v[14:15], v[12:13] op_sel_hi:[1,0,0]
    v_pk_fma_f32 v[152:153], v[152:153], v[14:15], v[12:13] op_sel_hi:[1,0,0]
    v_pk_fma_f32 v[154:155], v[154:155], v[14:15], v[12:13] op_sel_hi:[1,0,0]
    v_pk_fma_f32 v[156:157], v[156:157], v[14:15], v[12:13] op_sel_hi:[1,0,0]
    v_pk_fma_f32 v[158:159], v[158:159], v[14:15], v[12:13] op_sel_hi:[1,0,0]
    v_pk_mul_f32 v[144:145], v[144:145], v[32:33]
    v_pk_mul_f32 v[146:147], v[146:147], v[34:35]
    v_pk_mul_f32 v[148:149], v[148:149], v[36:37]
    v_pk_mul_f32 v[150:151], v[150:151], v[38:39]
    v_pk_mul_f32 v[152:153], v[152:153], v[40:41]
    v_pk_mul_f32 v[154:155], v[154:155], v[42:43]
    v_pk_mul_f32 v[156:157], v[156:157], v[44:45]
    v_pk_mul_f32 v[158:159], v[158:159], v[46:47]
    v_exp_f32 v144, v144
    v_exp_f32 v145, v145
    v_exp_f32 v146, v146
    v_exp_f32 v147, v147
    v_exp_f32 v148, v148
    v_exp_f32 v149, v149
    v_exp_f32 v150, v150
    v_exp_f32 v151, v151
    v_exp_f32 v152, v152
    v_exp_f32 v153, v153
    v_exp_f32 v154, v154
    v_exp_f32 v155, v155
    v_exp_f32 v156, v156
    v_exp_f32 v157, v157
    v_exp_f32 v158, v158
    v_exp_f32 v159, v159
    v_pk_fma_f32 v[144:145], v[144:145], v[16:17], v[16:17] op_sel_hi:[1,0,0]
    v_pk_fma_f32 v[146:147], v[146:147], v[16:17], v[16:17] op_sel_hi:[1,0,0]
    v_pk_fma_f32 v[148:149], v[148:149], v[16:17], v[16:17] op_sel_hi:[1,0,0]
    v_pk_fma_f32 v[150:151], v[150:151], v[16:17], v[16:17] op_sel_hi:[1,0,0]
    v_pk_fma_f32 v[152:153], v[152:153], v[16:17], v[16:17] op_sel_hi:[1,0,0]
    v_pk_fma_f32 v[154:155], v[154:155], v[16:17], v[16:17] op_sel_hi:[1,0,0]
    v_pk_fma_f32 v[156:157], v[156:157], v[16:17], v[16:17] op_sel_hi:[1,0,0]
    v_pk_fma_f32 v[158:159], v[158:159], v[16:17], v[16:17] op_sel_hi:[1,0,0]
    v_rcp_f32 v144, v144
    v_rcp_f32 v145, v145
    v_rcp_f32 v146, v146
    v_rcp_f32 v147, v147
    v_rcp_f32 v148, v148
    v_rcp_f32 v149, v149
    v_rcp_f32 v150, v150
    v_rcp_f32 v151, v151
    v_rcp_f32 v152, v152
    v_rcp_f32 v153, v153
    v_rcp_f32 v154, v154
    v_rcp_f32 v155, v155
    v_rcp_f32 v156, v156
    v_rcp_f32 v157, v157
    v_rcp_f32 v158, v158
    v_rcp_f32 v159, v159
    v_pk_mul_f32 v[32:33], v[32:33], v[144:145]
    v_pk_mul_f32 v[34:35], v[34:35], v[146:147]
    v_pk_mul_f32 v[36:37], v[36:37], v[148:149]
    v_pk_mul_f32 v[38:39], v[38:39], v[150:151]
    v_pk_mul_f32 v[40:41], v[40:41], v[152:153]
    v_pk_mul_f32 v[42:43], v[42:43], v[154:155]
    v_pk_mul_f32 v[44:45], v[44:45], v[156:157]
    v_pk_mul_f32 v[46:47], v[46:47], v[158:159]
    v_cvt_pk_bf16_f32 v160, v32, v33
    v_cvt_pk_bf16_f32 v161, v34, v35
    v_cvt_pk_bf16_f32 v162, v36, v37
    v_cvt_pk_bf16_f32 v163, v38, v39
    v_cvt_pk_bf16_f32 v164, v40, v41
    v_cvt_pk_bf16_f32 v165, v42, v43
    v_cvt_pk_bf16_f32 v166, v44, v45
    v_cvt_pk_bf16_f32 v167, v46, v47
    v_cndmask_b32 v160, 0, v160, vcc
    v_cndmask_b32 v161, 0, v161, vcc
    v_cndmask_b32 v162, 0, v162, vcc
    v_cndmask_b32 v163, 0, v163, vcc
    v_cndmask_b32 v164, 0, v164, vcc
    v_cndmask_b32 v165, 0, v165, vcc
    v_cndmask_b32 v166, 0, v166, vcc
    v_cndmask_b32 v167, 0, v167, vcc
    buffer_store_dwordx4 v[160:163], v6, s[4:7], s47 offen sc1
    buffer_store_dwordx4 v[164:167], v6, s[4:7], s47 offen offset:1024 sc1
    v_mov_b32 v40, 0
    v_mov_b32 v42, 0
    s_nop 0
    v_dot2c_f32_bf16 v40, v20, v28
    v_dot2c_f32_bf16 v42, v24, v28
    v_dot2c_f32_bf16 v40, v21, v29
    v_dot2c_f32_bf16 v42, v25, v29
    v_dot2c_f32_bf16 v40, v22, v30
    v_dot2c_f32_bf16 v42, v26, v30
    v_dot2c_f32_bf16 v40, v23, v31
    v_dot2c_f32_bf16 v42, v27, v31
    s_nop 2
    v_add_f32_dpp v40, v40, v40 row_shr:1 row_mask:0xf bank_mask:0xf bound_ctrl:0
    v_add_f32_dpp v42, v42, v42 row_shr:1 row_mask:0xf bank_mask:0xf bound_ctrl:0
    s_nop 0
    v_add_f32_dpp v40, v40, v40 row_shr:2 row_mask:0xf bank_mask:0xf bound_ctrl:0
    v_add_f32_dpp v42, v42, v42 row_shr:2 row_mask:0xf bank_mask:0xf bound_ctrl:0
    s_nop 0
    v_add_f32_dpp v40, v40, v40 row_shr:4 row_mask:0xf bank_mask:0xf bound_ctrl:0
    v_add_f32_dpp v42, v42, v42 row_shr:4 row_mask:0xf bank_mask:0xf bound_ctrl:0
    s_nop 0
    v_add_f32_dpp v40, v40, v40 row_shr:8 row_mask:0xf bank_mask:0xf bound_ctrl:0
    v_add_f32_dpp v42, v42, v42 row_shr:8 row_mask:0xf bank_mask:0xf bound_ctrl:0
    s_nop 0
    v_add_f32_dpp v40, v40, v40 row_bcast:15 row_mask:0xa bank_mask:0xf
    v_add_f32_dpp v42, v42, v42 row_bcast:15 row_mask:0xa bank_mask:0xf
    s_nop 0
    v_add_f32_dpp v40, v40, v40 row_bcast:31 row_mask:0xc bank_mask:0xf
    v_add_f32_dpp v42, v42, v42 row_bcast:31 row_mask:0xc bank_mask:0xf
    s_nop 0
    v_mul_f32 v40, 0xbfb8aa3b, v40
    v_mul_f32 v42, 0xbfb8aa3b, v42
    v_exp_f32 v40, v40
    v_exp_f32 v42, v42
    s_lshl_b32 s47, s55, 6
    v_add_f32 v40, 1.0, v40
    v_add_f32 v42, 1.0, v42
    v_rcp_f32 v40, v40
    v_rcp_f32 v42, v42
    v_mov_b32 v41, s50
    v_mov_b32 v43, s50
    s_add_u32 s54, s47, 18087936
    s_lshl_b32 s47, s96, 15
    s_lshl_b32 s48, s58, 7
    s_add_u32 s47, s47, s48
    s_lshl_b32 s48, s60, 6
    s_add_u32 s47, s47, s48
    v_and_b32 v3, 31, v1
    v_lshlrev_b32 v3, 10, v3
    v_lshrrev_b32 v4, 5, v1
    v_lshl_add_u32 v3, v4, 3, v3
    buffer_load_dwordx2 v[20:21], v3, s[8:11], s47 offen offset:0
    buffer_load_dwordx2 v[22:23], v3, s[8:11], s47 offen offset:16
    buffer_load_dwordx2 v[24:25], v3, s[8:11], s47 offen offset:32
    buffer_load_dwordx2 v[26:27], v3, s[8:11], s47 offen offset:48
    s_add_u32 s3, s3, 8192
    v_lshlrev_b32 v3, 9, v4
    v_bfe_u32 v4, v1, 2, 2
    v_lshl_add_u32 v3, v4, 7, v3
    v_bfe_u32 v4, v1, 3, 1
    v_lshl_add_u32 v3, v4, 6, v3
    v_bfe_u32 v4, v1, 4, 1
    v_lshl_add_u32 v3, v4, 5, v3
    v_and_b32 v4, 3, v1
    v_lshl_add_u32 v3, v4, 3, v3
    s_lshl_b32 s47, s60, 6
    s_or_b32 s47, s47, s61
    v_xor_b32 v30, s47, v3
    v_xor_b32 v31, 64, v30
    v_bfe_u32 v3, v1, 1, 3
    v_bfe_u32 v4, v1, 3, 1
    v_lshlrev_b32 v4, 1, v4
    v_add_u32 v4, -1, v4
    v_and_b32 v5, 1, v1
    v_mul_i32_i24 v4, v4, v5
    v_add_u32 v4, s96, v4
    v_and_b32 v4, 63, v4
    v_lshl_add_u32 v3, v3, 7, v4
    v_lshlrev_b32 v3, 7, v3
    s_lshl_b32 s47, s60, 17
    s_add_u32 s47, s47, 18227200
    v_add_u32 v11, s47, v3
    s_lshl_b32 s62, s96, 15
    s_lshl_b32 s47, s101, 13
    s_add_u32 s62, s62, s47
    s_and_b32 s47, s100, 7
    s_lshl_b32 s47, s47, 10
    s_add_u32 s53, s62, s47
    s_add_u32 s62, s53, 4194304
    v_mov_b32 v4, 0
    s_waitcnt vmcnt(4)
    v_mov_b32 v3, s50
    s_mov_b64 exec, 1
    buffer_store_dword v3, v2, s[4:7], s3 offen sc1
    s_mov_b64 exec, -1
    s_waitcnt vmcnt(1)
    v_lshlrev_b32 v48, 16, v20
    v_and_b32 v49, 0xffff0000, v20
    v_lshlrev_b32 v50, 16, v21
    v_and_b32 v51, 0xffff0000, v21
    v_lshlrev_b32 v52, 16, v22
    v_and_b32 v53, 0xffff0000, v22
    v_lshlrev_b32 v54, 16, v23
    v_and_b32 v55, 0xffff0000, v23
    v_lshlrev_b32 v56, 16, v24
    v_and_b32 v57, 0xffff0000, v24
    v_lshlrev_b32 v58, 16, v25
    v_and_b32 v59, 0xffff0000, v25
    v_lshlrev_b32 v60, 16, v26
    v_and_b32 v61, 0xffff0000, v26
    v_lshlrev_b32 v62, 16, v27
    v_and_b32 v63, 0xffff0000, v27
    s_mov_b32 s16, s32
    s_mov_b32 s17, s33
    s_mov_b32 s18, 1835008
    s_mov_b32 s19, 0x00020000
    v_lshrrev_b32 v3, 3, v1
    v_and_b32 v4, 0x70, v9
    v_mul_u32_u24 v10, 3584, v3
    v_add_u32 v10, v10, v4
    s_lshl_b32 s47, s99, 8
    s_cmp_eq_u32 s97, 0
    s_cselect_b32 s47, 0x1000000, s47
    v_add_u32 v10, s47, v10
    s_lshl_b32 s56, s100, 3
    s_and_b32 s56, s56, 63
    s_xor_b32 s56, s56, s101
    s_lshl_b32 s63, s101, 10
    s_mov_b64 exec, 1
    ds_add_u32 v7, v8 offset:0
    s_mov_b64 exec, -1
    s_mov_b32 s49, 1600000
z_lw31:
    ds_read_b32 v17, v7 offset:20
    s_waitcnt lgkmcnt(0)
    v_readfirstlane_b32 s48, v17
    s_nop 1
    s_cmp_ge_u32 s48, 4
    s_cbranch_scc1 z_lwd32
    s_sleep 1
    s_sub_u32 s49, s49, 1
    s_cmp_lg_u32 s49, 0
    s_cbranch_scc1 z_lw31
z_lwd32:
    s_add_u32 m0, s63, 65536
    s_xor_b32 s47, s56, 0
    s_mul_i32 s47, s47, 28672
    s_waitcnt vmcnt(8)
    buffer_load_dwordx4 v10, s[16:19], s47 offen lds
    s_add_u32 m0, s63, 69632
    s_xor_b32 s47, s56, 4
    s_mul_i32 s47, s47, 28672
    s_waitcnt vmcnt(8)
    buffer_load_dwordx4 v10, s[16:19], s47 offen lds
    s_add_u32 m0, s63, 73728
    s_xor_b32 s47, s56, 8
    s_mul_i32 s47, s47, 28672
    s_waitcnt vmcnt(8)
    buffer_load_dwordx4 v10, s[16:19], s47 offen lds
    s_add_u32 m0, s63, 77824
    s_xor_b32 s47, s56, 12
    s_mul_i32 s47, s47, 28672
    s_waitcnt vmcnt(8)
    buffer_load_dwordx4 v10, s[16:19], s47 offen lds
    s_add_u32 m0, s63, 81920
    s_xor_b32 s47, s56, 16
    s_mul_i32 s47, s47, 28672
    s_waitcnt vmcnt(8)
    buffer_load_dwordx4 v10, s[16:19], s47 offen lds
    s_add_u32 m0, s63, 86016
    s_xor_b32 s47, s56, 20
    s_mul_i32 s47, s47, 28672
    s_waitcnt vmcnt(8)
    buffer_load_dwordx4 v10, s[16:19], s47 offen lds
    s_add_u32 m0, s63, 90112
    s_xor_b32 s47, s56, 24
    s_mul_i32 s47, s47, 28672
    s_waitcnt vmcnt(8)
    buffer_load_dwordx4 v10, s[16:19], s47 offen lds
    s_add_u32 m0, s63, 94208
    s_xor_b32 s47, s56, 28
    s_mul_i32 s47, s47, 28672
    s_waitcnt vmcnt(8)
    buffer_load_dwordx4 v10, s[16:19], s47 offen lds
    s_add_u32 m0, s63, 98304
    s_xor_b32 s47, s56, 32
    s_mul_i32 s47, s47, 28672
    s_waitcnt vmcnt(8)
    buffer_load_dwordx4 v10, s[16:19], s47 offen lds
    s_add_u32 m0, s63, 102400
    s_xor_b32 s47, s56, 36
    s_mul_i32 s47, s47, 28672
    s_waitcnt vmcnt(8)
    buffer_load_dwordx4 v10, s[16:19], s47 offen lds
    s_add_u32 m0, s63, 106496
    s_xor_b32 s47, s56, 40
    s_mul_i32 s47, s47, 28672
    s_waitcnt vmcnt(8)
    buffer_load_dwordx4 v10, s[16:19], s47 offen lds
    s_add_u32 m0, s63, 110592
    s_xor_b32 s47, s56, 44
    s_mul_i32 s47, s47, 28672
    s_waitcnt vmcnt(8)
    buffer_load_dwordx4 v10, s[16:19], s47 offen lds
    s_mov_b32 s49, 200000
z_poll33:
    buffer_load_dword v17, v11, s[4:7], 0 offen sc1
z_pchk35:
    s_waitcnt vmcnt(0)
    v_cmp_ne_u32 vcc, s50, v17
    s_nop 1
    s_and_b32 vcc_lo, vcc_lo, vcc_lo
    s_cbranch_scc0 z_pdone34
    s_sleep 2
    s_sub_u32 s49, s49, 1
    s_cmp_lg_u32 s49, 0
    s_cbranch_scc1 z_poll33
z_pdone34:
    s_xor_b32 s48, s62, 0
    s_waitcnt vmcnt(8)
    buffer_load_dwordx4 v[128:131], v2, s[4:7], s48 offen sc1
    s_xor_b32 s48, s62, 1024
    s_waitcnt vmcnt(8)
    buffer_load_dwordx4 v[132:135], v2, s[4:7], s48 offen sc1
    s_xor_b32 s48, s62, 2048
    s_waitcnt vmcnt(8)
    buffer_load_dwordx4 v[136:139], v2, s[4:7], s48 offen sc1
    s_xor_b32 s48, s62, 3072
    s_waitcnt vmcnt(8)
    buffer_load_dwordx4 v[140:143], v2, s[4:7], s48 offen sc1
    s_xor_b32 s48, s62, 4096
    s_waitcnt vmcnt(8)
    buffer_load_dwordx4 v[144:147], v2, s[4:7], s48 offen sc1
    s_xor_b32 s48, s62, 5120
    s_waitcnt vmcnt(8)
    buffer_load_dwordx4 v[148:151], v2, s[4:7], s48 offen sc1
    s_xor_b32 s48, s62, 6144
    s_waitcnt vmcnt(8)
    buffer_load_dwordx4 v[152:155], v2, s[4:7], s48 offen sc1
    s_xor_b32 s48, s62, 7168
    s_waitcnt vmcnt(8)
    buffer_load_dwordx4 v[156:159], v2, s[4:7], s48 offen sc1
    s_xor_b32 s48, s62, 8192
    s_waitcnt vmcnt(8)
    buffer_load_dwordx4 v[160:163], v2, s[4:7], s48 offen sc1
    s_xor_b32 s48, s62, 9216
    s_waitcnt vmcnt(8)
    buffer_load_dwordx4 v[164:167], v2, s[4:7], s48 offen sc1
    s_xor_b32 s48, s62, 10240
    s_waitcnt vmcnt(8)
    buffer_load_dwordx4 v[168:171], v2, s[4:7], s48 offen sc1
    s_xor_b32 s48, s62, 11264
    s_waitcnt vmcnt(8)
    buffer_load_dwordx4 v[172:175], v2, s[4:7], s48 offen sc1
    s_xor_b32 s48, s62, 12288
    s_waitcnt vmcnt(8)
    buffer_load_dwordx4 v[176:179], v2, s[4:7], s48 offen sc1
    s_xor_b32 s48, s62, 13312
    s_waitcnt vmcnt(8)
    buffer_load_dwordx4 v[180:183], v2, s[4:7], s48 offen sc1
    s_xor_b32 s48, s62, 14336
    s_waitcnt vmcnt(8)
    buffer_load_dwordx4 v[184:187], v2, s[4:7], s48 offen sc1
    s_xor_b32 s48, s62, 15360
    s_waitcnt vmcnt(8)
    buffer_load_dwordx4 v[188:191], v2, s[4:7], s48 offen sc1
    s_mov_b32 s49, 1600000
z_lw36:
    ds_read_b32 v17, v7 offset:0
    s_waitcnt lgkmcnt(0)
    v_readfirstlane_b32 s48, v17
    s_nop 1
    s_cmp_ge_u32 s48, 4
    s_cbranch_scc1 z_lwd37
    s_sleep 1
    s_sub_u32 s49, s49, 1
    s_cmp_lg_u32 s49, 0
    s_cbranch_scc1 z_lw36
z_lwd37:
    v_xor_b32 v15, 0x0, v30
    v_xor_b32 v18, 0x0, v31
    ds_read_b64_tr_b16 v[112:113], v15 offset:0
    ds_read_b64_tr_b16 v[114:115], v15 offset:1024
    ds_read_b64_tr_b16 v[116:117], v18 offset:0
    ds_read_b64_tr_b16 v[118:119], v18 offset:1024
    ds_read_b64_tr_b16 v[120:121], v15 offset:2048
    ds_read_b64_tr_b16 v[122:123], v15 offset:3072
    ds_read_b64_tr_b16 v[124:125], v18 offset:2048
    ds_read_b64_tr_b16 v[126:127], v18 offset:3072
    ds_read_b64_tr_b16 v[192:193], v15 offset:4096
    ds_read_b64_tr_b16 v[194:195], v15 offset:5120
    ds_read_b64_tr_b16 v[196:197], v18 offset:4096
    ds_read_b64_tr_b16 v[198:199], v18 offset:5120
    s_waitcnt vmcnt(15) lgkmcnt(8)
    v_mfma_f32_32x32x16_bf16 v[64:79], v[116:119], v[128:131], 0
    v_mfma_f32_32x32x16_bf16 v[48:63], v[112:115], v[128:131], v[48:63]
    ds_read_b64_tr_b16 v[112:113], v15 offset:6144
    ds_read_b64_tr_b16 v[114:115], v15 offset:7168
    ds_read_b64_tr_b16 v[116:117], v18 offset:6144
    ds_read_b64_tr_b16 v[118:119], v18 offset:7168
    s_waitcnt vmcnt(14) lgkmcnt(8)
    v_mfma_f32_32x32x16_bf16 v[64:79], v[124:127], v[132:135], v[64:79]
    v_mfma_f32_32x32x16_bf16 v[48:63], v[120:123], v[132:135], v[48:63]
    v_xor_b32 v15, 0x0, v30
    v_xor_b32 v18, 0x0, v31
    ds_read_b64_tr_b16 v[120:121], v15 offset:8192
    ds_read_b64_tr_b16 v[122:123], v15 offset:9216
    ds_read_b64_tr_b16 v[124:125], v18 offset:8192
    ds_read_b64_tr_b16 v[126:127], v18 offset:9216
    s_waitcnt vmcnt(13) lgkmcnt(8)
    v_mfma_f32_32x32x16_bf16 v[64:79], v[196:199], v[136:139], v[64:79]
    v_mfma_f32_32x32x16_bf16 v[48:63], v[192:195], v[136:139], v[48:63]
    ds_read_b64_tr_b16 v[192:193], v15 offset:10240
    ds_read_b64_tr_b16 v[194:195], v15 offset:11264
    ds_read_b64_tr_b16 v[196:197], v18 offset:10240
    ds_read_b64_tr_b16 v[198:199], v18 offset:11264
    s_waitcnt vmcnt(12) lgkmcnt(8)
    v_mfma_f32_32x32x16_bf16 v[64:79], v[116:119], v[140:143], v[64:79]
    v_mfma_f32_32x32x16_bf16 v[48:63], v[112:115], v[140:143], v[48:63]
    ds_read_b64_tr_b16 v[112:113], v15 offset:12288
    ds_read_b64_tr_b16 v[114:115], v15 offset:13312
    ds_read_b64_tr_b16 v[116:117], v18 offset:12288
    ds_read_b64_tr_b16 v[118:119], v18 offset:13312
    s_waitcnt vmcnt(11) lgkmcnt(8)
    v_mfma_f32_32x32x16_bf16 v[64:79], v[124:127], v[144:147], v[64:79]
    v_mfma_f32_32x32x16_bf16 v[48:63], v[120:123], v[144:147], v[48:63]
    ds_read_b64_tr_b16 v[120:121], v15 offset:14336
    ds_read_b64_tr_b16 v[122:123], v15 offset:15360
    ds_read_b64_tr_b16 v[124:125], v18 offset:14336
    ds_read_b64_tr_b16 v[126:127], v18 offset:15360
    s_waitcnt vmcnt(10) lgkmcnt(8)
    v_mfma_f32_32x32x16_bf16 v[64:79], v[196:199], v[148:151], v[64:79]
    v_mfma_f32_32x32x16_bf16 v[48:63], v[192:195], v[148:151], v[48:63]
    v_xor_b32 v15, 0x4000, v30
    v_xor_b32 v18, 0x4000, v31
    ds_read_b64_tr_b16 v[192:193], v15 offset:0
    ds_read_b64_tr_b16 v[194:195], v15 offset:1024
    ds_read_b64_tr_b16 v[196:197], v18 offset:0
    ds_read_b64_tr_b16 v[198:199], v18 offset:1024
    s_waitcnt vmcnt(9) lgkmcnt(8)
    v_mfma_f32_32x32x16_bf16 v[64:79], v[116:119], v[152:155], v[64:79]
    v_mfma_f32_32x32x16_bf16 v[48:63], v[112:115], v[152:155], v[48:63]
    ds_read_b64_tr_b16 v[112:113], v15 offset:2048
    ds_read_b64_tr_b16 v[114:115], v15 offset:3072
    ds_read_b64_tr_b16 v[116:117], v18 offset:2048
    ds_read_b64_tr_b16 v[118:119], v18 offset:3072
    s_waitcnt vmcnt(8) lgkmcnt(8)
    v_mfma_f32_32x32x16_bf16 v[64:79], v[124:127], v[156:159], v[64:79]
    v_mfma_f32_32x32x16_bf16 v[48:63], v[120:123], v[156:159], v[48:63]
    ds_read_b64_tr_b16 v[120:121], v15 offset:4096
    ds_read_b64_tr_b16 v[122:123], v15 offset:5120
    ds_read_b64_tr_b16 v[124:125], v18 offset:4096
    ds_read_b64_tr_b16 v[126:127], v18 offset:5120
    s_waitcnt vmcnt(7) lgkmcnt(8)
    v_mfma_f32_32x32x16_bf16 v[64:79], v[196:199], v[160:163], v[64:79]
    v_mfma_f32_32x32x16_bf16 v[48:63], v[192:195], v[160:163], v[48:63]
    s_add_u32 m0, s63, 114688
    s_xor_b32 s47, s56, 48
    s_mul_i32 s47, s47, 28672
    s_waitcnt vmcnt(8)
    buffer_load_dwordx4 v10, s[16:19], s47 offen lds
    ds_read_b64_tr_b16 v[192:193], v15 offset:6144
    ds_read_b64_tr_b16 v[194:195], v15 offset:7168
    ds_read_b64_tr_b16 v[196:197], v18 offset:6144
    ds_read_b64_tr_b16 v[198:199], v18 offset:7168
    s_waitcnt vmcnt(7) lgkmcnt(8)
    v_mfma_f32_32x32x16_bf16 v[64:79], v[116:119], v[164:167], v[64:79]
    v_mfma_f32_32x32x16_bf16 v[48:63], v[112:115], v[164:167], v[48:63]
    s_add_u32 m0, s63, 118784
    s_xor_b32 s47, s56, 52
    s_mul_i32 s47, s47, 28672
    s_waitcnt vmcnt(8)
    buffer_load_dwordx4 v10, s[16:19], s47 offen lds
    v_xor_b32 v15, 0x4000, v30
    v_xor_b32 v18, 0x4000, v31
    ds_read_b64_tr_b16 v[112:113], v15 offset:8192
    ds_read_b64_tr_b16 v[114:115], v15 offset:9216
    ds_read_b64_tr_b16 v[116:117], v18 offset:8192
    ds_read_b64_tr_b16 v[118:119], v18 offset:9216
    s_waitcnt vmcnt(7) lgkmcnt(8)
    v_mfma_f32_32x32x16_bf16 v[64:79], v[124:127], v[168:171], v[64:79]
    v_mfma_f32_32x32x16_bf16 v[48:63], v[120:123], v[168:171], v[48:63]
    s_add_u32 m0, s63, 122880
    s_xor_b32 s47, s56, 56
    s_mul_i32 s47, s47, 28672
    s_waitcnt vmcnt(8)
    buffer_load_dwordx4 v10, s[16:19], s47 offen lds
    ds_read_b64_tr_b16 v[120:121], v15 offset:10240
    ds_read_b64_tr_b16 v[122:123], v15 offset:11264
    ds_read_b64_tr_b16 v[124:125], v18 offset:10240
    ds_read_b64_tr_b16 v[126:127], v18 offset:11264
    s_waitcnt vmcnt(7) lgkmcnt(8)
    v_mfma_f32_32x32x16_bf16 v[64:79], v[196:199], v[172:175], v[64:79]
    v_mfma_f32_32x32x16_bf16 v[48:63], v[192:195], v[172:175], v[48:63]
    s_add_u32 m0, s63, 126976
    s_xor_b32 s47, s56, 60
    s_mul_i32 s47, s47, 28672
    s_waitcnt vmcnt(8)
    buffer_load_dwordx4 v10, s[16:19], s47 offen lds
    ds_read_b64_tr_b16 v[192:193], v15 offset:12288
    ds_read_b64_tr_b16 v[194:195], v15 offset:13312
    ds_read_b64_tr_b16 v[196:197], v18 offset:12288
    ds_read_b64_tr_b16 v[198:199], v18 offset:13312
    s_waitcnt vmcnt(7) lgkmcnt(8)
    v_mfma_f32_32x32x16_bf16 v[64:79], v[116:119], v[176:179], v[64:79]
    v_mfma_f32_32x32x16_bf16 v[48:63], v[112:115], v[176:179], v[48:63]
    ds_read_b64_tr_b16 v[112:113], v15 offset:14336
    ds_read_b64_tr_b16 v[114:115], v15 offset:15360
    ds_read_b64_tr_b16 v[116:117], v18 offset:14336
    ds_read_b64_tr_b16 v[118:119], v18 offset:15360
    s_waitcnt vmcnt(6) lgkmcnt(8)
    v_mfma_f32_32x32x16_bf16 v[64:79], v[124:127], v[180:183], v[64:79]
    v_mfma_f32_32x32x16_bf16 v[48:63], v[120:123], v[180:183], v[48:63]
    s_waitcnt vmcnt(5) lgkmcnt(4)
    v_mfma_f32_32x32x16_bf16 v[64:79], v[196:199], v[184:187], v[64:79]
    v_mfma_f32_32x32x16_bf16 v[48:63], v[192:195], v[184:187], v[48:63]
    s_waitcnt vmcnt(4) lgkmcnt(0)
    v_mfma_f32_32x32x16_bf16 v[64:79], v[116:119], v[188:191], v[64:79]
    v_mfma_f32_32x32x16_bf16 v[48:63], v[112:115], v[188:191], v[48:63]
    s_mov_b32 s49, 1600000
z_lw38:
    ds_read_b32 v17, v7 offset:40
    s_waitcnt lgkmcnt(0)
    v_readfirstlane_b32 s48, v17
    s_nop 1
    s_cmp_ge_u32 s48, 4
    s_cbranch_scc1 z_lwd39
    s_sleep 1
    s_sub_u32 s49, s49, 1
    s_cmp_lg_u32 s49, 0
    s_cbranch_scc1 z_lw38
z_lwd39:
    s_cmp_eq_u32 s97, 0
    s_cbranch_scc1 g_no3z
g_no3z:
    s_lshl_b32 s47, s101, 12
    s_add_u32 s47, s47, 147456
    v_add_u32 v3, s47, v2
    v_xor_b32 v4, 0x2000, v3
    s_nop 8
    ds_write_b128 v3, v[64:67] offset:0
    ds_write_b128 v3, v[68:71] offset:1024
    ds_write_b128 v3, v[72:75] offset:2048
    ds_write_b128 v3, v[76:79] offset:3072
    s_waitcnt lgkmcnt(0)
    s_mov_b64 exec, 1
    ds_add_u32 v7, v8 offset:4
    s_mov_b64 exec, -1
    s_mov_b32 s49, 1600000
z_lw40:
    ds_read_b32 v17, v7 offset:4
    s_waitcnt lgkmcnt(0)
    v_readfirstlane_b32 s48, v17
    s_nop 1
    s_cmp_ge_u32 s48, 4
    s_cbranch_scc1 z_lwd41
    s_sleep 1
    s_sub_u32 s49, s49, 1
    s_cmp_lg_u32 s49, 0
    s_cbranch_scc1 z_lw40
z_lwd41:
    ds_read_b128 v[80:83], v4 offset:0
    ds_read_b128 v[84:87], v4 offset:1024
    ds_read_b128 v[88:91], v4 offset:2048
    ds_read_b128 v[92:95], v4 offset:3072
    s_waitcnt lgkmcnt(3)
    v_add_f32 v48, v48, v80
    v_add_f32 v49, v49, v81
    v_add_f32 v50, v50, v82
    v_add_f32 v51, v51, v83
    s_waitcnt lgkmcnt(2)
    v_add_f32 v52, v52, v84
    v_add_f32 v53, v53, v85
    v_add_f32 v54, v54, v86
    v_add_f32 v55, v55, v87
    s_waitcnt lgkmcnt(1)
    v_add_f32 v56, v56, v88
    v_add_f32 v57, v57, v89
    v_add_f32 v58, v58, v90
    v_add_f32 v59, v59, v91
    s_waitcnt lgkmcnt(0)
    v_add_f32 v60, v60, v92
    v_add_f32 v61, v61, v93
    v_add_f32 v62, v62, v94
    v_add_f32 v63, v63, v95
    s_mov_b64 exec, 1
    ds_add_u32 v7, v8 offset:44
    s_mov_b64 exec, -1
    v_cvt_pk_bf16_f32 v20, v48, v49
    v_cvt_pk_bf16_f32 v21, v50, v51
    v_cvt_pk_bf16_f32 v22, v52, v53
    v_cvt_pk_bf16_f32 v23, v54, v55
    v_cvt_pk_bf16_f32 v24, v56, v57
    v_cvt_pk_bf16_f32 v25, v58, v59
    v_cvt_pk_bf16_f32 v26, v60, v61
    v_cvt_pk_bf16_f32 v27, v62, v63
    s_lshl_b32 s47, s96, 15
    s_lshl_b32 s48, s58, 12
    s_add_u32 s47, s47, s48
    s_lshl_b32 s48, s60, 11
    s_add_u32 s47, s47, s48
    s_add_u32 s47, s47, 6291456
    buffer_store_dwordx4 v[20:23], v2, s[4:7], s47 offen sc1
    buffer_store_dwordx4 v[24:27], v2, s[4:7], s47 offen offset:1024 sc1
    v_add_f32 v80, v48, v49
    v_mul_f32 v81, v48, v48
    v_fmac_f32 v81, v49, v49
    v_add_f32 v80, v80, v50
    v_fmac_f32 v81, v50, v50
    v_add_f32 v80, v80, v51
    v_fmac_f32 v81, v51, v51
    v_add_f32 v80, v80, v52
    v_fmac_f32 v81, v52, v52
    v_add_f32 v80, v80, v53
    v_fmac_f32 v81, v53, v53
    v_add_f32 v80, v80, v54
    v_fmac_f32 v81, v54, v54
    v_add_f32 v80, v80, v55
    v_fmac_f32 v81, v55, v55
    v_add_f32 v80, v80, v56
    v_fmac_f32 v81, v56, v56
    v_add_f32 v80, v80, v57
    v_fmac_f32 v81, v57, v57
    v_add_f32 v80, v80, v58
    v_fmac_f32 v81, v58, v58
    v_add_f32 v80, v80, v59
    v_fmac_f32 v81, v59, v59
    v_add_f32 v80, v80, v60
    v_fmac_f32 v81, v60, v60
    v_add_f32 v80, v80, v61
    v_fmac_f32 v81, v61, v61
    v_add_f32 v80, v80, v62
    v_fmac_f32 v81, v62, v62
    v_add_f32 v80, v80, v63
    v_fmac_f32 v81, v63, v63
    v_mov_b32 v82, v80
    v_mov_b32 v83, v81
    s_lshl_b32 s47, s96, 8
    s_lshl_b32 s48, s58, 15
    v_permlane32_swap_b32 v82, v80
    v_permlane32_swap_b32 v83, v81
    s_add_u32 s47, s47, s48
    v_add_f32 v80, v80, v82
    v_add_f32 v81, v81, v83
    s_lshl_b32 s48, s60, 14
    s_add_u32 s47, s47, s48
    s_add_u32 s47, s47, 17825792
    v_lshlrev_b32 v3, 3, v1
    s_mov_b32 exec_hi, 0
    buffer_store_dwordx2 v[80:81], v3, s[4:7], s47 offen sc1
    s_mov_b32 exec_hi, -1
    s_lshl_b32 s47, s96, 4
    s_lshl_b32 s48, s58, 1
    s_add_u32 s47, s47, s48
    s_add_u32 s47, s47, s60
    s_lshl_b32 s47, s47, 7
    s_add_u32 s3, s47, 18481152
    v_add_u32 v10, 128, v10
    s_lshl_b32 s62, s98, 15
    s_xor_b32 s47, s56, s101
    s_lshl_b32 s47, s47, 9
    s_add_u32 s62, s62, s47
    s_add_u32 s62, s62, 6291456
    s_lshl_b32 s47, s98, 11
    s_add_u32 s47, s47, 18481152
    v_and_b32 v3, 15, v1
    v_lshl_add_u32 v11, v3, 7, s47
    s_cmp_eq_u32 s97, 0
    s_cbranch_scc1 g_no3a
    s_add_u32 m0, s63, 0
    s_xor_b32 s47, s56, 0
    s_mul_i32 s47, s47, 28672
    s_waitcnt vmcnt(8)
    buffer_load_dwordx4 v10, s[16:19], s47 offen lds
    s_add_u32 m0, s63, 4096
    s_xor_b32 s47, s56, 4
    s_mul_i32 s47, s47, 28672
    s_waitcnt vmcnt(8)
    buffer_load_dwordx4 v10, s[16:19], s47 offen lds
    s_add_u32 m0, s63, 8192
    s_xor_b32 s47, s56, 8
    s_mul_i32 s47, s47, 28672
    s_waitcnt vmcnt(8)
    buffer_load_dwordx4 v10, s[16:19], s47 offen lds
    s_add_u32 m0, s63, 12288
    s_xor_b32 s47, s56, 12
    s_mul_i32 s47, s47, 28672
    s_waitcnt vmcnt(8)
    buffer_load_dwordx4 v10, s[16:19], s47 offen lds
    s_add_u32 m0, s63, 16384
    s_xor_b32 s47, s56, 16
    s_mul_i32 s47, s47, 28672
    s_waitcnt vmcnt(8)
    buffer_load_dwordx4 v10, s[16:19], s47 offen lds
    s_add_u32 m0, s63, 20480
    s_xor_b32 s47, s56, 20
    s_mul_i32 s47, s47, 28672
    s_waitcnt vmcnt(8)
    buffer_load_dwordx4 v10, s[16:19], s47 offen lds
    s_add_u32 m0, s63, 24576
    s_xor_b32 s47, s56, 24
    s_mul_i32 s47, s47, 28672
    s_waitcnt vmcnt(8)
    buffer_load_dwordx4 v10, s[16:19], s47 offen lds
    s_add_u32 m0, s63, 28672
    s_xor_b32 s47, s56, 28
    s_mul_i32 s47, s47, 28672
    s_waitcnt vmcnt(8)
    buffer_load_dwordx4 v10, s[16:19], s47 offen lds
    s_waitcnt vmcnt(8)
    s_branch g_no3b
g_no3a:
    s_waitcnt vmcnt(0)
g_no3b:
    v_mov_b32 v3, s50
    s_mov_b64 exec, 1
    buffer_store_dword v3, v2, s[4:7], s3 offen sc1
    s_mov_b64 exec, -1
    s_mov_b64 exec, 1
    ds_add_u32 v7, v8 offset:48
    s_mov_b64 exec, -1
    v_mov_b32 v4, 0
    s_mov_b32 exec_lo, 0
    s_mov_b32 exec_hi, 0x80000000
    buffer_store_dwordx2 v[40:41], v4, s[4:7], s54 offen sc1
    buffer_store_dwordx2 v[42:43], v4, s[4:7], s54 offen offset:64 sc1
    s_mov_b64 exec, -1
    s_mov_b32 s12, s34
    s_mov_b32 s13, s35
    s_mov_b32 s14, 1835008
    s_mov_b32 s15, 0x00020000
    s_mul_i32 s47, s101, 7
    s_add_u32 s54, s47, s59
    s_sub_u32 s46, s47, s59
    s_add_u32 s46, s46, 1
    s_sub_u32 s45, 4, s59
    s_add_u32 s55, 3, s59
    s_and_b32 s29, s100, 3
    s_add_u32 s47, s29, 0
    s_sub_u32 s48, s47, s45
    s_cselect_b32 s47, s47, s48
    s_sub_u32 s48, s47, s45
    s_cselect_b32 s47, s47, s48
    s_lshl_b32 s47, s47, 1
    s_add_u32 s20, s47, s54
    s_add_u32 s47, s29, 1
    s_sub_u32 s48, s47, s45
    s_cselect_b32 s47, s47, s48
    s_sub_u32 s48, s47, s45
    s_cselect_b32 s47, s47, s48
    s_lshl_b32 s47, s47, 1
    s_add_u32 s21, s47, s54
    s_add_u32 s47, s29, 2
    s_sub_u32 s48, s47, s45
    s_cselect_b32 s47, s47, s48
    s_sub_u32 s48, s47, s45
    s_cselect_b32 s47, s47, s48
    s_lshl_b32 s47, s47, 1
    s_add_u32 s22, s47, s54
    s_add_u32 s47, s29, 3
    s_sub_u32 s48, s47, s45
    s_cselect_b32 s47, s47, s48
    s_sub_u32 s48, s47, s45
    s_cselect_b32 s47, s47, s48
    s_lshl_b32 s47, s47, 1
    s_add_u32 s23, s47, s54
    s_add_u32 s47, s29, 3
    s_sub_u32 s48, s47, s55
    s_cselect_b32 s47, s47, s48
    s_sub_u32 s48, s47, s55
    s_cselect_b32 s47, s47, s48
    s_lshl_b32 s47, s47, 1
    s_add_u32 s49, s47, s46
    s_cmp_lg_u32 s59, 0
    s_cselect_b32 s23, s49, s23
    s_add_u32 s47, s29, 0
    s_sub_u32 s48, s47, s55
    s_cselect_b32 s47, s47, s48
    s_sub_u32 s48, s47, s55
    s_cselect_b32 s47, s47, s48
    s_lshl_b32 s47, s47, 1
    s_add_u32 s26, s47, s46
    s_add_u32 s47, s29, 1
    s_sub_u32 s48, s47, s55
    s_cselect_b32 s47, s47, s48
    s_sub_u32 s48, s47, s55
    s_cselect_b32 s47, s47, s48
    s_lshl_b32 s47, s47, 1
    s_add_u32 s27, s47, s46
    s_add_u32 s47, s29, 2
    s_sub_u32 s48, s47, s55
    s_cselect_b32 s47, s47, s48
    s_sub_u32 s48, s47, s55
    s_cselect_b32 s47, s47, s48
    s_lshl_b32 s47, s47, 1
    s_add_u32 s28, s47, s46
    s_cmp_eq_u32 s97, 0
    s_cbranch_scc1 g_fin1
    s_add_u32 m0, s63, 32768
    s_xor_b32 s47, s56, 32
    s_mul_i32 s47, s47, 28672
    s_waitcnt vmcnt(7)
    buffer_load_dwordx4 v10, s[16:19], s47 offen lds
    s_add_u32 m0, s63, 36864
    s_xor_b32 s47, s56, 36
    s_mul_i32 s47, s47, 28672
    s_waitcnt vmcnt(7)
    buffer_load_dwordx4 v10, s[16:19], s47 offen lds
    s_add_u32 m0, s63, 40960
    s_xor_b32 s47, s56, 40
    s_mul_i32 s47, s47, 28672
    s_waitcnt vmcnt(7)
    buffer_load_dwordx4 v10, s[16:19], s47 offen lds
    s_add_u32 m0, s63, 45056
    s_xor_b32 s47, s56, 44
    s_mul_i32 s47, s47, 28672
    s_waitcnt vmcnt(7)
    buffer_load_dwordx4 v10, s[16:19], s47 offen lds
    s_add_u32 m0, s63, 49152
    s_xor_b32 s47, s56, 48
    s_mul_i32 s47, s47, 28672
    s_waitcnt vmcnt(7)
    buffer_load_dwordx4 v10, s[16:19], s47 offen lds
    s_add_u32 m0, s63, 53248
    s_xor_b32 s47, s56, 52
    s_mul_i32 s47, s47, 28672
    s_waitcnt vmcnt(7)
    buffer_load_dwordx4 v10, s[16:19], s47 offen lds
    s_add_u32 m0, s63, 57344
    s_xor_b32 s47, s56, 56
    s_mul_i32 s47, s47, 28672
    s_waitcnt vmcnt(7)
    buffer_load_dwordx4 v10, s[16:19], s47 offen lds
    s_add_u32 m0, s63, 61440
    s_xor_b32 s47, s56, 60
    s_mul_i32 s47, s47, 28672
    s_waitcnt vmcnt(7)
    buffer_load_dwordx4 v10, s[16:19], s47 offen lds
    s_lshl_b32 s47, s60, 6
    s_or_b32 s47, s47, s61
    v_xor_b32 v15, s47, v30
    v_xor_b32 v18, 64, v15
    s_lshl_b32 s47, s59, 6
    s_lshl_b32 s48, s60, 15
    s_or_b32 s47, s47, s48
    v_xor_b32 v6, s47, v15
    v_lshrrev_b32 v5, 5, v1
    s_lshl_b32 s47, s59, 7
    s_add_u32 s47, s47, 134144
    v_lshl_add_u32 v28, v1, 2, s47
    v_mov_b32 v44, 0x3f803f80
    v_mov_b32 v45, 0x3f803f80
    v_mov_b32 v46, 0x3f803f80
    v_mov_b32 v47, 0x3f803f80
    s_mov_b32 s49, 1600000
z_lw42:
    ds_read_b32 v17, v7 offset:48
    s_waitcnt lgkmcnt(0)
    v_readfirstlane_b32 s48, v17
    s_nop 1
    s_cmp_ge_u32 s48, 4
    s_cbranch_scc1 z_lwd43
    s_sleep 1
    s_sub_u32 s49, s49, 1
    s_cmp_lg_u32 s49, 0
    s_cbranch_scc1 z_lw42
z_lwd43:
    v_xor_b32 v3, 65536, v6
    ds_read_b64_tr_b16 v[48:49], v3 offset:0
    ds_read_b64_tr_b16 v[50:51], v3 offset:1024
    ds_read_b64_tr_b16 v[52:53], v3 offset:2048
    ds_read_b64_tr_b16 v[54:55], v3 offset:3072
    ds_read_b64_tr_b16 v[56:57], v3 offset:4096
    ds_read_b64_tr_b16 v[58:59], v3 offset:5120
    ds_read_b64_tr_b16 v[60:61], v3 offset:6144
    ds_read_b64_tr_b16 v[62:63], v3 offset:7168
    ds_read_b64_tr_b16 v[64:65], v3 offset:8192
    ds_read_b64_tr_b16 v[66:67], v3 offset:9216
    ds_read_b64_tr_b16 v[68:69], v3 offset:10240
    ds_read_b64_tr_b16 v[70:71], v3 offset:11264
    ds_read_b64_tr_b16 v[72:73], v3 offset:12288
    ds_read_b64_tr_b16 v[74:75], v3 offset:13312
    s_waitcnt lgkmcnt(12)
    v_mfma_f32_32x32x16_bf16 v[96:111], v[44:47], v[48:51], 0
    ds_read_b64_tr_b16 v[76:77], v3 offset:14336
    ds_read_b64_tr_b16 v[78:79], v3 offset:15360
    s_waitcnt lgkmcnt(12)
    v_mfma_f32_32x32x16_bf16 v[96:111], v[44:47], v[52:55], v[96:111]
    ds_read_b64_tr_b16 v[48:49], v3 offset:16384
    ds_read_b64_tr_b16 v[50:51], v3 offset:17408
    s_waitcnt lgkmcnt(12)
    v_mfma_f32_32x32x16_bf16 v[96:111], v[44:47], v[56:59], v[96:111]
    ds_read_b64_tr_b16 v[52:53], v3 offset:18432
    ds_read_b64_tr_b16 v[54:55], v3 offset:19456
    s_waitcnt lgkmcnt(12)
    v_mfma_f32_32x32x16_bf16 v[96:111], v[44:47], v[60:63], v[96:111]
    ds_read_b64_tr_b16 v[56:57], v3 offset:20480
    ds_read_b64_tr_b16 v[58:59], v3 offset:21504
    s_waitcnt lgkmcnt(12)
    v_mfma_f32_32x32x16_bf16 v[96:111], v[44:47], v[64:67], v[96:111]
    ds_read_b64_tr_b16 v[60:61], v3 offset:22528
    ds_read_b64_tr_b16 v[62:63], v3 offset:23552
    s_waitcnt lgkmcnt(12)
    v_mfma_f32_32x32x16_bf16 v[96:111], v[44:47], v[68:71], v[96:111]
    ds_read_b64_tr_b16 v[64:65], v3 offset:24576
    ds_read_b64_tr_b16 v[66:67], v3 offset:25600
    s_waitcnt lgkmcnt(12)
    v_mfma_f32_32x32x16_bf16 v[96:111], v[44:47], v[72:75], v[96:111]
    ds_read_b64_tr_b16 v[68:69], v3 offset:26624
    ds_read_b64_tr_b16 v[70:71], v3 offset:27648
    s_waitcnt lgkmcnt(12)
    v_mfma_f32_32x32x16_bf16 v[96:111], v[44:47], v[76:79], v[96:111]
    ds_read_b64_tr_b16 v[72:73], v3 offset:28672
    ds_read_b64_tr_b16 v[74:75], v3 offset:29696
    s_waitcnt lgkmcnt(12)
    v_mfma_f32_32x32x16_bf16 v[96:111], v[44:47], v[48:51], v[96:111]
    ds_read_b64_tr_b16 v[76:77], v3 offset:30720
    ds_read_b64_tr_b16 v[78:79], v3 offset:31744
    s_waitcnt lgkmcnt(12)
    v_mfma_f32_32x32x16_bf16 v[96:111], v[44:47], v[52:55], v[96:111]
    s_waitcnt lgkmcnt(10)
    v_mfma_f32_32x32x16_bf16 v[96:111], v[44:47], v[56:59], v[96:111]
    s_waitcnt lgkmcnt(8)
    v_mfma_f32_32x32x16_bf16 v[96:111], v[44:47], v[60:63], v[96:111]
    s_waitcnt lgkmcnt(6)
    v_mfma_f32_32x32x16_bf16 v[96:111], v[44:47], v[64:67], v[96:111]
    s_waitcnt lgkmcnt(4)
    v_mfma_f32_32x32x16_bf16 v[96:111], v[44:47], v[68:71], v[96:111]
    s_waitcnt lgkmcnt(2)
    v_mfma_f32_32x32x16_bf16 v[96:111], v[44:47], v[72:75], v[96:111]
    s_waitcnt lgkmcnt(0)
    v_mfma_f32_32x32x16_bf16 v[96:111], v[44:47], v[76:79], v[96:111]
    s_nop 10
    s_mov_b32 exec_hi, 0
    ds_add_f32 v28, v96 offset:0
    s_mov_b32 exec_hi, -1
    s_waitcnt vmcnt(0)
    s_mov_b64 exec, 1
    ds_add_u32 v7, v8 offset:8
    s_mov_b64 exec, -1
    s_mov_b32 s49, 200000
z_poll44:
    buffer_load_dword v17, v11, s[4:7], 0 offen sc1
z_pchk46:
    s_waitcnt vmcnt(0)
    v_cmp_ne_u32 vcc, s50, v17
    s_nop 1
    s_and_b32 vcc_lo, vcc_lo, vcc_lo
    s_cbranch_scc0 z_pdone45
    s_sleep 2
    s_sub_u32 s49, s49, 1
    s_cmp_lg_u32 s49, 0
    s_cbranch_scc1 z_poll44
z_pdone45:
    s_xor_b32 s63, s62, 0
    s_waitcnt vmcnt(8)
    buffer_load_dwordx4 v[128:131], v2, s[4:7], s63 offen offset:0 sc1
    s_waitcnt vmcnt(8)
    buffer_load_dwordx4 v[132:135], v2, s[4:7], s63 offen offset:1024 sc1
    s_waitcnt vmcnt(8)
    buffer_load_dwordx4 v[136:139], v2, s[4:7], s63 offen offset:2048 sc1
    s_waitcnt vmcnt(8)
    buffer_load_dwordx4 v[140:143], v2, s[4:7], s63 offen offset:3072 sc1
    s_xor_b32 s63, s62, 4096
    s_waitcnt vmcnt(8)
    buffer_load_dwordx4 v[144:147], v2, s[4:7], s63 offen offset:0 sc1
    s_waitcnt vmcnt(8)
    buffer_load_dwordx4 v[148:151], v2, s[4:7], s63 offen offset:1024 sc1
    s_waitcnt vmcnt(8)
    buffer_load_dwordx4 v[152:155], v2, s[4:7], s63 offen offset:2048 sc1
    s_waitcnt vmcnt(8)
    buffer_load_dwordx4 v[156:159], v2, s[4:7], s63 offen offset:3072 sc1
    s_mov_b32 s49, 1600000
z_lw47:
    ds_read_b32 v17, v7 offset:8
    s_waitcnt lgkmcnt(0)
    v_readfirstlane_b32 s48, v17
    s_nop 1
    s_cmp_ge_u32 s48, 4
    s_cbranch_scc1 z_lwd48
    s_sleep 1
    s_sub_u32 s49, s49, 1
    s_cmp_lg_u32 s49, 0
    s_cbranch_scc1 z_lw47
z_lwd48:
    v_xor_b32 v3, 0, v6
    ds_read_b64_tr_b16 v[48:49], v3 offset:0
    ds_read_b64_tr_b16 v[50:51], v3 offset:1024
    ds_read_b64_tr_b16 v[52:53], v3 offset:2048
    ds_read_b64_tr_b16 v[54:55], v3 offset:3072
    ds_read_b64_tr_b16 v[56:57], v3 offset:4096
    ds_read_b64_tr_b16 v[58:59], v3 offset:5120
    ds_read_b64_tr_b16 v[60:61], v3 offset:6144
    ds_read_b64_tr_b16 v[62:63], v3 offset:7168
    ds_read_b64_tr_b16 v[64:65], v3 offset:8192
    ds_read_b64_tr_b16 v[66:67], v3 offset:9216
    ds_read_b64_tr_b16 v[68:69], v3 offset:10240
    ds_read_b64_tr_b16 v[70:71], v3 offset:11264
    ds_read_b64_tr_b16 v[72:73], v3 offset:12288
    ds_read_b64_tr_b16 v[74:75], v3 offset:13312
    s_waitcnt lgkmcnt(12)
    v_mfma_f32_32x32x16_bf16 v[96:111], v[44:47], v[48:51], 0
    s_xor_b32 s63, s62, 8192
    s_waitcnt vmcnt(8)
    buffer_load_dwordx4 v[160:163], v2, s[4:7], s63 offen offset:0 sc1
    ds_read_b64_tr_b16 v[76:77], v3 offset:14336
    ds_read_b64_tr_b16 v[78:79], v3 offset:15360
    s_waitcnt lgkmcnt(12)
    v_mfma_f32_32x32x16_bf16 v[96:111], v[44:47], v[52:55], v[96:111]
    s_waitcnt vmcnt(8)
    buffer_load_dwordx4 v[164:167], v2, s[4:7], s63 offen offset:1024 sc1
    ds_read_b64_tr_b16 v[48:49], v3 offset:16384
    ds_read_b64_tr_b16 v[50:51], v3 offset:17408
    s_waitcnt lgkmcnt(12)
    v_mfma_f32_32x32x16_bf16 v[96:111], v[44:47], v[56:59], v[96:111]
    ds_read_b64_tr_b16 v[52:53], v3 offset:18432
    ds_read_b64_tr_b16 v[54:55], v3 offset:19456
    s_waitcnt lgkmcnt(12)
    v_mfma_f32_32x32x16_bf16 v[96:111], v[44:47], v[60:63], v[96:111]
    ds_read_b64_tr_b16 v[56:57], v3 offset:20480
    ds_read_b64_tr_b16 v[58:59], v3 offset:21504
    s_waitcnt lgkmcnt(12)
    v_mfma_f32_32x32x16_bf16 v[96:111], v[44:47], v[64:67], v[96:111]
    ds_read_b64_tr_b16 v[60:61], v3 offset:22528
    ds_read_b64_tr_b16 v[62:63], v3 offset:23552
    s_waitcnt lgkmcnt(12)
    v_mfma_f32_32x32x16_bf16 v[96:111], v[44:47], v[68:71], v[96:111]
    ds_read_b64_tr_b16 v[64:65], v3 offset:24576
    ds_read_b64_tr_b16 v[66:67], v3 offset:25600
    s_waitcnt lgkmcnt(12)
    v_mfma_f32_32x32x16_bf16 v[96:111], v[44:47], v[72:75], v[96:111]
    ds_read_b64_tr_b16 v[68:69], v3 offset:26624
    ds_read_b64_tr_b16 v[70:71], v3 offset:27648
    s_waitcnt lgkmcnt(12)
    v_mfma_f32_32x32x16_bf16 v[96:111], v[44:47], v[76:79], v[96:111]
    ds_read_b64_tr_b16 v[72:73], v3 offset:28672
    ds_read_b64_tr_b16 v[74:75], v3 offset:29696
    s_waitcnt lgkmcnt(12)
    v_mfma_f32_32x32x16_bf16 v[96:111], v[44:47], v[48:51], v[96:111]
    ds_read_b64_tr_b16 v[76:77], v3 offset:30720
    ds_read_b64_tr_b16 v[78:79], v3 offset:31744
    s_waitcnt lgkmcnt(12)
    v_mfma_f32_32x32x16_bf16 v[96:111], v[44:47], v[52:55], v[96:111]
    s_waitcnt lgkmcnt(10)
    v_mfma_f32_32x32x16_bf16 v[96:111], v[44:47], v[56:59], v[96:111]
    s_waitcnt lgkmcnt(8)
    v_mfma_f32_32x32x16_bf16 v[96:111], v[44:47], v[60:63], v[96:111]
    s_waitcnt lgkmcnt(6)
    v_mfma_f32_32x32x16_bf16 v[96:111], v[44:47], v[64:67], v[96:111]
    s_waitcnt lgkmcnt(4)
    v_mfma_f32_32x32x16_bf16 v[96:111], v[44:47], v[68:71], v[96:111]
    s_waitcnt lgkmcnt(2)
    v_mfma_f32_32x32x16_bf16 v[96:111], v[44:47], v[72:75], v[96:111]
    s_waitcnt lgkmcnt(0)
    v_mfma_f32_32x32x16_bf16 v[96:111], v[44:47], v[76:79], v[96:111]
    s_nop 10
    s_mov_b32 exec_hi, 0
    ds_add_f32 v28, v96 offset:256
    s_mov_b32 exec_hi, -1
    s_waitcnt lgkmcnt(0)
    s_mov_b64 exec, 1
    ds_add_u32 v7, v8 offset:12
    s_mov_b64 exec, -1
    s_lshl_b32 s3, s98, 8
    s_add_u32 s3, s3, 17825792
    v_and_b32 v3, 31, v1
    v_lshlrev_b32 v4, 3, v3
    v_lshl_add_u32 v4, v5, 17, v4
    s_lshl_b32 s48, s98, 11
    s_add_u32 s48, s48, 18087936
    v_lshl_add_u32 v11, v3, 6, s48
    v_lshlrev_b32 v6, 2, v3
    v_add_u32 v6, 134144, v6
    v_xor_b32 v15, 0x10000, v15
    v_xor_b32 v18, 0x10000, v18
    s_setprio 3
    ds_read_b64_tr_b16 v[112:113], v15 offset:0
    ds_read_b64_tr_b16 v[114:115], v15 offset:1024
    ds_read_b64_tr_b16 v[116:117], v18 offset:0
    ds_read_b64_tr_b16 v[118:119], v18 offset:1024
    ds_read_b64_tr_b16 v[120:121], v15 offset:2048
    ds_read_b64_tr_b16 v[122:123], v15 offset:3072
    ds_read_b64_tr_b16 v[124:125], v18 offset:2048
    ds_read_b64_tr_b16 v[126:127], v18 offset:3072
    ds_read_b64_tr_b16 v[80:81], v15 offset:4096
    ds_read_b64_tr_b16 v[82:83], v15 offset:5120
    ds_read_b64_tr_b16 v[84:85], v18 offset:4096
    ds_read_b64_tr_b16 v[86:87], v18 offset:5120
    s_waitcnt vmcnt(9) lgkmcnt(8)
    v_mfma_f32_32x32x16_bf16 v[48:63], v[112:115], v[128:131], 0
    ds_read_b64_tr_b16 v[88:89], v15 offset:6144
    ds_read_b64_tr_b16 v[90:91], v15 offset:7168
    ds_read_b64_tr_b16 v[92:93], v18 offset:6144
    ds_read_b64_tr_b16 v[94:95], v18 offset:7168
    v_mfma_f32_32x32x16_bf16 v[64:79], v[116:119], v[128:131], 0
    s_waitcnt vmcnt(8)
    buffer_load_dwordx4 v[168:171], v2, s[4:7], s63 offen offset:2048 sc1
    s_waitcnt vmcnt(9) lgkmcnt(8)
    v_mfma_f32_32x32x16_bf16 v[48:63], v[120:123], v[132:135], v[48:63]
    ds_read_b64_tr_b16 v[112:113], v15 offset:8192
    ds_read_b64_tr_b16 v[114:115], v15 offset:9216
    ds_read_b64_tr_b16 v[116:117], v18 offset:8192
    ds_read_b64_tr_b16 v[118:119], v18 offset:9216
    v_mfma_f32_32x32x16_bf16 v[64:79], v[124:127], v[132:135], v[64:79]
    s_waitcnt vmcnt(8)
    buffer_load_dwordx4 v[172:175], v2, s[4:7], s63 offen offset:3072 sc1
    s_waitcnt vmcnt(9) lgkmcnt(8)
    v_mfma_f32_32x32x16_bf16 v[48:63], v[80:83], v[136:139], v[48:63]
    ds_read_b64_tr_b16 v[120:121], v15 offset:10240
    ds_read_b64_tr_b16 v[122:123], v15 offset:11264
    ds_read_b64_tr_b16 v[124:125], v18 offset:10240
    ds_read_b64_tr_b16 v[126:127], v18 offset:11264
    v_mfma_f32_32x32x16_bf16 v[64:79], v[84:87], v[136:139], v[64:79]
    s_xor_b32 s63, s62, 12288
    s_waitcnt vmcnt(8)
    buffer_load_dwordx4 v[176:179], v2, s[4:7], s63 offen offset:0 sc1
    s_waitcnt vmcnt(9) lgkmcnt(8)
    v_mfma_f32_32x32x16_bf16 v[48:63], v[88:91], v[140:143], v[48:63]
    ds_read_b64_tr_b16 v[80:81], v15 offset:12288
    ds_read_b64_tr_b16 v[82:83], v15 offset:13312
    ds_read_b64_tr_b16 v[84:85], v18 offset:12288
    ds_read_b64_tr_b16 v[86:87], v18 offset:13312
    v_mfma_f32_32x32x16_bf16 v[64:79], v[92:95], v[140:143], v[64:79]
    s_waitcnt vmcnt(8)
    buffer_load_dwordx4 v[180:183], v2, s[4:7], s63 offen offset:1024 sc1
    s_waitcnt vmcnt(9) lgkmcnt(8)
    v_mfma_f32_32x32x16_bf16 v[48:63], v[112:115], v[144:147], v[48:63]
    ds_read_b64_tr_b16 v[88:89], v15 offset:14336
    ds_read_b64_tr_b16 v[90:91], v15 offset:15360
    ds_read_b64_tr_b16 v[92:93], v18 offset:14336
    ds_read_b64_tr_b16 v[94:95], v18 offset:15360
    v_mfma_f32_32x32x16_bf16 v[64:79], v[116:119], v[144:147], v[64:79]
    s_waitcnt vmcnt(8)
    buffer_load_dwordx4 v[184:187], v2, s[4:7], s63 offen offset:2048 sc1
    s_waitcnt vmcnt(9) lgkmcnt(8)
    v_mfma_f32_32x32x16_bf16 v[48:63], v[120:123], v[148:151], v[48:63]
    ds_read_b64_tr_b16 v[112:113], v15 offset:16384
    ds_read_b64_tr_b16 v[114:115], v15 offset:17408
    ds_read_b64_tr_b16 v[116:117], v18 offset:16384
    ds_read_b64_tr_b16 v[118:119], v18 offset:17408
    v_mfma_f32_32x32x16_bf16 v[64:79], v[124:127], v[148:151], v[64:79]
    s_waitcnt vmcnt(8)
    buffer_load_dwordx4 v[188:191], v2, s[4:7], s63 offen offset:3072 sc1
    s_waitcnt vmcnt(9) lgkmcnt(8)
    v_mfma_f32_32x32x16_bf16 v[48:63], v[80:83], v[152:155], v[48:63]
    ds_read_b64_tr_b16 v[120:121], v15 offset:18432
    ds_read_b64_tr_b16 v[122:123], v15 offset:19456
    ds_read_b64_tr_b16 v[124:125], v18 offset:18432
    ds_read_b64_tr_b16 v[126:127], v18 offset:19456
    v_mfma_f32_32x32x16_bf16 v[64:79], v[84:87], v[152:155], v[64:79]
    s_xor_b32 s63, s62, 16384
    s_waitcnt vmcnt(8)
    buffer_load_dwordx4 v[192:195], v2, s[4:7], s63 offen offset:0 sc1
    s_waitcnt vmcnt(9) lgkmcnt(8)
    v_mfma_f32_32x32x16_bf16 v[48:63], v[88:91], v[156:159], v[48:63]
    ds_read_b64_tr_b16 v[80:81], v15 offset:20480
    ds_read_b64_tr_b16 v[82:83], v15 offset:21504
    ds_read_b64_tr_b16 v[84:85], v18 offset:20480
    ds_read_b64_tr_b16 v[86:87], v18 offset:21504
    v_mfma_f32_32x32x16_bf16 v[64:79], v[92:95], v[156:159], v[64:79]
    s_waitcnt vmcnt(8)
    buffer_load_dwordx4 v[196:199], v2, s[4:7], s63 offen offset:1024 sc1
    s_waitcnt vmcnt(9) lgkmcnt(8)
    v_mfma_f32_32x32x16_bf16 v[48:63], v[112:115], v[160:163], v[48:63]
    ds_read_b64_tr_b16 v[88:89], v15 offset:22528
    ds_read_b64_tr_b16 v[90:91], v15 offset:23552
    ds_read_b64_tr_b16 v[92:93], v18 offset:22528
    ds_read_b64_tr_b16 v[94:95], v18 offset:23552
    v_mfma_f32_32x32x16_bf16 v[64:79], v[116:119], v[160:163], v[64:79]
    s_waitcnt vmcnt(8)
    buffer_load_dwordx4 v[200:203], v2, s[4:7], s63 offen offset:2048 sc1
    s_waitcnt vmcnt(9) lgkmcnt(8)
    v_mfma_f32_32x32x16_bf16 v[48:63], v[120:123], v[164:167], v[48:63]
    ds_read_b64_tr_b16 v[112:113], v15 offset:24576
    ds_read_b64_tr_b16 v[114:115], v15 offset:25600
    ds_read_b64_tr_b16 v[116:117], v18 offset:24576
    ds_read_b64_tr_b16 v[118:119], v18 offset:25600
    v_mfma_f32_32x32x16_bf16 v[64:79], v[124:127], v[164:167], v[64:79]
    s_waitcnt vmcnt(8)
    buffer_load_dwordx4 v[204:207], v2, s[4:7], s63 offen offset:3072 sc1
    s_waitcnt vmcnt(9) lgkmcnt(8)
    v_mfma_f32_32x32x16_bf16 v[48:63], v[80:83], v[168:171], v[48:63]
    ds_read_b64_tr_b16 v[120:121], v15 offset:26624
    ds_read_b64_tr_b16 v[122:123], v15 offset:27648
    ds_read_b64_tr_b16 v[124:125], v18 offset:26624
    ds_read_b64_tr_b16 v[126:127], v18 offset:27648
    v_mfma_f32_32x32x16_bf16 v[64:79], v[84:87], v[168:171], v[64:79]
    s_xor_b32 s63, s62, 20480
    s_waitcnt vmcnt(8)
    buffer_load_dwordx4 v[208:211], v2, s[4:7], s63 offen offset:0 sc1
    s_waitcnt vmcnt(9) lgkmcnt(8)
    v_mfma_f32_32x32x16_bf16 v[48:63], v[88:91], v[172:175], v[48:63]
    ds_read_b64_tr_b16 v[80:81], v15 offset:28672
    ds_read_b64_tr_b16 v[82:83], v15 offset:29696
    ds_read_b64_tr_b16 v[84:85], v18 offset:28672
    ds_read_b64_tr_b16 v[86:87], v18 offset:29696
    v_mfma_f32_32x32x16_bf16 v[64:79], v[92:95], v[172:175], v[64:79]
    s_waitcnt vmcnt(8)
    buffer_load_dwordx4 v[212:215], v2, s[4:7], s63 offen offset:1024 sc1
    s_waitcnt vmcnt(9) lgkmcnt(8)
    v_mfma_f32_32x32x16_bf16 v[48:63], v[112:115], v[176:179], v[48:63]
    ds_read_b64_tr_b16 v[88:89], v15 offset:30720
    ds_read_b64_tr_b16 v[90:91], v15 offset:31744
    ds_read_b64_tr_b16 v[92:93], v18 offset:30720
    ds_read_b64_tr_b16 v[94:95], v18 offset:31744
    v_mfma_f32_32x32x16_bf16 v[64:79], v[116:119], v[176:179], v[64:79]
    s_waitcnt vmcnt(8)
    buffer_load_dwordx4 v[216:219], v2, s[4:7], s63 offen offset:2048 sc1
    s_waitcnt vmcnt(9) lgkmcnt(8)
    v_mfma_f32_32x32x16_bf16 v[48:63], v[120:123], v[180:183], v[48:63]
    ds_read_b64_tr_b16 v[112:113], v15 offset:32768
    ds_read_b64_tr_b16 v[114:115], v15 offset:33792
    ds_read_b64_tr_b16 v[116:117], v18 offset:32768
    ds_read_b64_tr_b16 v[118:119], v18 offset:33792
    v_mfma_f32_32x32x16_bf16 v[64:79], v[124:127], v[180:183], v[64:79]
    s_waitcnt vmcnt(8)
    buffer_load_dwordx4 v[220:223], v2, s[4:7], s63 offen offset:3072 sc1
    s_waitcnt vmcnt(9) lgkmcnt(8)
    v_mfma_f32_32x32x16_bf16 v[48:63], v[80:83], v[184:187], v[48:63]
    ds_read_b64_tr_b16 v[120:121], v15 offset:34816
    ds_read_b64_tr_b16 v[122:123], v15 offset:35840
    ds_read_b64_tr_b16 v[124:125], v18 offset:34816
    ds_read_b64_tr_b16 v[126:127], v18 offset:35840
    v_mfma_f32_32x32x16_bf16 v[64:79], v[84:87], v[184:187], v[64:79]
    s_xor_b32 s63, s62, 24576
    s_waitcnt vmcnt(8)
    buffer_load_dwordx4 v[224:227], v2, s[4:7], s63 offen offset:0 sc1
    s_waitcnt vmcnt(9) lgkmcnt(8)
    v_mfma_f32_32x32x16_bf16 v[48:63], v[88:91], v[188:191], v[48:63]
    ds_read_b64_tr_b16 v[80:81], v15 offset:36864
    ds_read_b64_tr_b16 v[82:83], v15 offset:37888
    ds_read_b64_tr_b16 v[84:85], v18 offset:36864
    ds_read_b64_tr_b16 v[86:87], v18 offset:37888
    v_mfma_f32_32x32x16_bf16 v[64:79], v[92:95], v[188:191], v[64:79]
    s_waitcnt vmcnt(8)
    buffer_load_dwordx4 v[228:231], v2, s[4:7], s63 offen offset:1024 sc1
    s_waitcnt vmcnt(9) lgkmcnt(8)
    v_mfma_f32_32x32x16_bf16 v[48:63], v[112:115], v[192:195], v[48:63]
    ds_read_b64_tr_b16 v[88:89], v15 offset:38912
    ds_read_b64_tr_b16 v[90:91], v15 offset:39936
    ds_read_b64_tr_b16 v[92:93], v18 offset:38912
    ds_read_b64_tr_b16 v[94:95], v18 offset:39936
    v_mfma_f32_32x32x16_bf16 v[64:79], v[116:119], v[192:195], v[64:79]
    s_waitcnt vmcnt(8)
    buffer_load_dwordx4 v[232:235], v2, s[4:7], s63 offen offset:2048 sc1
    s_waitcnt vmcnt(9) lgkmcnt(8)
    v_mfma_f32_32x32x16_bf16 v[48:63], v[120:123], v[196:199], v[48:63]
    ds_read_b64_tr_b16 v[112:113], v15 offset:40960
    ds_read_b64_tr_b16 v[114:115], v15 offset:41984
    ds_read_b64_tr_b16 v[116:117], v18 offset:40960
    ds_read_b64_tr_b16 v[118:119], v18 offset:41984
    v_mfma_f32_32x32x16_bf16 v[64:79], v[124:127], v[196:199], v[64:79]
    s_waitcnt vmcnt(8)
    buffer_load_dwordx4 v[236:239], v2, s[4:7], s63 offen offset:3072 sc1
    s_waitcnt vmcnt(9) lgkmcnt(8)
    v_mfma_f32_32x32x16_bf16 v[48:63], v[80:83], v[200:203], v[48:63]
    ds_read_b64_tr_b16 v[120:121], v15 offset:43008
    ds_read_b64_tr_b16 v[122:123], v15 offset:44032
    ds_read_b64_tr_b16 v[124:125], v18 offset:43008
    ds_read_b64_tr_b16 v[126:127], v18 offset:44032
    v_mfma_f32_32x32x16_bf16 v[64:79], v[84:87], v[200:203], v[64:79]
    s_xor_b32 s63, s62, 28672
    s_waitcnt vmcnt(8)
    buffer_load_dwordx4 v[240:243], v2, s[4:7], s63 offen offset:0 sc1
    s_waitcnt vmcnt(9) lgkmcnt(8)
    v_mfma_f32_32x32x16_bf16 v[48:63], v[88:91], v[204:207], v[48:63]
    ds_read_b64_tr_b16 v[80:81], v15 offset:45056
    ds_read_b64_tr_b16 v[82:83], v15 offset:46080
    ds_read_b64_tr_b16 v[84:85], v18 offset:45056
    ds_read_b64_tr_b16 v[86:87], v18 offset:46080
    v_mfma_f32_32x32x16_bf16 v[64:79], v[92:95], v[204:207], v[64:79]
    s_waitcnt vmcnt(8)
    buffer_load_dwordx4 v[244:247], v2, s[4:7], s63 offen offset:1024 sc1
    s_waitcnt vmcnt(9) lgkmcnt(8)
    v_mfma_f32_32x32x16_bf16 v[48:63], v[112:115], v[208:211], v[48:63]
    ds_read_b64_tr_b16 v[88:89], v15 offset:47104
    ds_read_b64_tr_b16 v[90:91], v15 offset:48128
    ds_read_b64_tr_b16 v[92:93], v18 offset:47104
    ds_read_b64_tr_b16 v[94:95], v18 offset:48128
    v_mfma_f32_32x32x16_bf16 v[64:79], v[116:119], v[208:211], v[64:79]
    s_waitcnt vmcnt(8)
    buffer_load_dwordx4 v[248:251], v2, s[4:7], s63 offen offset:2048 sc1
    s_waitcnt vmcnt(9) lgkmcnt(8)
    v_mfma_f32_32x32x16_bf16 v[48:63], v[120:123], v[212:215], v[48:63]
    ds_read_b64_tr_b16 v[112:113], v15 offset:49152
    ds_read_b64_tr_b16 v[114:115], v15 offset:50176
    ds_read_b64_tr_b16 v[116:117], v18 offset:49152
    ds_read_b64_tr_b16 v[118:119], v18 offset:50176
    v_mfma_f32_32x32x16_bf16 v[64:79], v[124:127], v[212:215], v[64:79]
    s_waitcnt vmcnt(8)
    buffer_load_dwordx4 v[252:255], v2, s[4:7], s63 offen offset:3072 sc1
    s_waitcnt vmcnt(9) lgkmcnt(8)
    v_mfma_f32_32x32x16_bf16 v[48:63], v[80:83], v[216:219], v[48:63]
    ds_read_b64_tr_b16 v[120:121], v15 offset:51200
    ds_read_b64_tr_b16 v[122:123], v15 offset:52224
    ds_read_b64_tr_b16 v[124:125], v18 offset:51200
    ds_read_b64_tr_b16 v[126:127], v18 offset:52224
    v_mfma_f32_32x32x16_bf16 v[64:79], v[84:87], v[216:219], v[64:79]
    buffer_load_dwordx2 v[32:33], v4, s[4:7], s3 offen sc1
    s_add_u32 s3, s3, 16384
    s_waitcnt vmcnt(9) lgkmcnt(8)
    v_mfma_f32_32x32x16_bf16 v[48:63], v[88:91], v[220:223], v[48:63]
    ds_read_b64_tr_b16 v[80:81], v15 offset:53248
    ds_read_b64_tr_b16 v[82:83], v15 offset:54272
    ds_read_b64_tr_b16 v[84:85], v18 offset:53248
    ds_read_b64_tr_b16 v[86:87], v18 offset:54272
    v_mfma_f32_32x32x16_bf16 v[64:79], v[92:95], v[220:223], v[64:79]
    buffer_load_dwordx2 v[34:35], v4, s[4:7], s3 offen sc1
    s_add_u32 s3, s3, 16384
    s_waitcnt vmcnt(9) lgkmcnt(8)
    v_mfma_f32_32x32x16_bf16 v[48:63], v[112:115], v[224:227], v[48:63]
    ds_read_b64_tr_b16 v[88:89], v15 offset:55296
    ds_read_b64_tr_b16 v[90:91], v15 offset:56320
    ds_read_b64_tr_b16 v[92:93], v18 offset:55296
    ds_read_b64_tr_b16 v[94:95], v18 offset:56320
    v_mfma_f32_32x32x16_bf16 v[64:79], v[116:119], v[224:227], v[64:79]
    buffer_load_dwordx2 v[36:37], v4, s[4:7], s3 offen sc1
    s_add_u32 s3, s3, 16384
    s_waitcnt vmcnt(9) lgkmcnt(8)
    v_mfma_f32_32x32x16_bf16 v[48:63], v[120:123], v[228:231], v[48:63]
    ds_read_b64_tr_b16 v[112:113], v15 offset:57344
    ds_read_b64_tr_b16 v[114:115], v15 offset:58368
    ds_read_b64_tr_b16 v[116:117], v18 offset:57344
    ds_read_b64_tr_b16 v[118:119], v18 offset:58368
    v_mfma_f32_32x32x16_bf16 v[64:79], v[124:127], v[228:231], v[64:79]
    buffer_load_dwordx2 v[38:39], v4, s[4:7], s3 offen sc1
    s_add_u32 s3, s3, 16384
    s_waitcnt vmcnt(9) lgkmcnt(8)
    v_mfma_f32_32x32x16_bf16 v[48:63], v[80:83], v[232:235], v[48:63]
    ds_read_b64_tr_b16 v[120:121], v15 offset:59392
    ds_read_b64_tr_b16 v[122:123], v15 offset:60416
    ds_read_b64_tr_b16 v[124:125], v18 offset:59392
    ds_read_b64_tr_b16 v[126:127], v18 offset:60416
    v_mfma_f32_32x32x16_bf16 v[64:79], v[84:87], v[232:235], v[64:79]
    buffer_load_dwordx2 v[40:41], v4, s[4:7], s3 offen sc1
    s_add_u32 s3, s3, 16384
    s_waitcnt vmcnt(9) lgkmcnt(8)
    v_mfma_f32_32x32x16_bf16 v[48:63], v[88:91], v[236:239], v[48:63]
    ds_read_b64_tr_b16 v[80:81], v15 offset:61440
    ds_read_b64_tr_b16 v[82:83], v15 offset:62464
    ds_read_b64_tr_b16 v[84:85], v18 offset:61440
    ds_read_b64_tr_b16 v[86:87], v18 offset:62464
    v_mfma_f32_32x32x16_bf16 v[64:79], v[92:95], v[236:239], v[64:79]
    buffer_load_dwordx2 v[42:43], v4, s[4:7], s3 offen sc1
    s_add_u32 s3, s3, 16384
    s_waitcnt vmcnt(9) lgkmcnt(8)
    v_mfma_f32_32x32x16_bf16 v[48:63], v[112:115], v[240:243], v[48:63]
    ds_read_b64_tr_b16 v[88:89], v15 offset:63488
    ds_read_b64_tr_b16 v[90:91], v15 offset:64512
    ds_read_b64_tr_b16 v[92:93], v18 offset:63488
    ds_read_b64_tr_b16 v[94:95], v18 offset:64512
    v_mfma_f32_32x32x16_bf16 v[64:79], v[116:119], v[240:243], v[64:79]
    buffer_load_dwordx2 v[44:45], v4, s[4:7], s3 offen sc1
    s_add_u32 s3, s3, 16384
    s_waitcnt vmcnt(9) lgkmcnt(8)
    v_mfma_f32_32x32x16_bf16 v[48:63], v[120:123], v[244:247], v[48:63]
    v_mfma_f32_32x32x16_bf16 v[64:79], v[124:127], v[244:247], v[64:79]
    buffer_load_dwordx2 v[46:47], v4, s[4:7], s3 offen sc1
    s_waitcnt vmcnt(9) lgkmcnt(4)
    v_mfma_f32_32x32x16_bf16 v[48:63], v[80:83], v[248:251], v[48:63]
    v_mfma_f32_32x32x16_bf16 v[64:79], v[84:87], v[248:251], v[64:79]
    buffer_load_dwordx2 v[28:29], v11, s[4:7], 0 offen sc1
    s_waitcnt vmcnt(9) lgkmcnt(0)
    v_mfma_f32_32x32x16_bf16 v[48:63], v[88:91], v[252:255], v[48:63]
    v_mfma_f32_32x32x16_bf16 v[64:79], v[92:95], v[252:255], v[64:79]
    s_mov_b64 exec, 1
    ds_add_u32 v7, v8 offset:24
    s_mov_b64 exec, -1
    s_setprio 3
    v_xor_b32 v15, 0x10000, v15
    v_xor_b32 v18, 0x10000, v18
    ds_read_b64_tr_b16 v[112:113], v15 offset:0
    ds_read_b64_tr_b16 v[114:115], v15 offset:1024
    ds_read_b64_tr_b16 v[116:117], v18 offset:0
    ds_read_b64_tr_b16 v[118:119], v18 offset:1024
    s_waitcnt lgkmcnt(0)
    v_mfma_f32_32x32x16_bf16 v[80:95], v[112:115], v[128:131], 0
    ds_read_b64_tr_b16 v[120:121], v15 offset:2048
    ds_read_b64_tr_b16 v[122:123], v15 offset:3072
    ds_read_b64_tr_b16 v[124:125], v18 offset:2048
    ds_read_b64_tr_b16 v[126:127], v18 offset:3072
    v_mfma_f32_32x32x16_bf16 v[96:111], v[116:119], v[128:131], 0
    s_waitcnt lgkmcnt(0)
    v_mfma_f32_32x32x16_bf16 v[80:95], v[120:123], v[132:135], v[80:95]
    ds_read_b64_tr_b16 v[112:113], v15 offset:4096
    ds_read_b64_tr_b16 v[114:115], v15 offset:5120
    ds_read_b64_tr_b16 v[116:117], v18 offset:4096
    ds_read_b64_tr_b16 v[118:119], v18 offset:5120
    v_mfma_f32_32x32x16_bf16 v[96:111], v[124:127], v[132:135], v[96:111]
    s_waitcnt lgkmcnt(0)
    v_mfma_f32_32x32x16_bf16 v[80:95], v[112:115], v[136:139], v[80:95]
    ds_read_b64_tr_b16 v[120:121], v15 offset:6144
    ds_read_b64_tr_b16 v[122:123], v15 offset:7168
    ds_read_b64_tr_b16 v[124:125], v18 offset:6144
    ds_read_b64_tr_b16 v[126:127], v18 offset:7168
    v_mfma_f32_32x32x16_bf16 v[96:111], v[116:119], v[136:139], v[96:111]
    s_waitcnt lgkmcnt(0)
    v_mfma_f32_32x32x16_bf16 v[80:95], v[120:123], v[140:143], v[80:95]
    ds_read_b64_tr_b16 v[112:113], v15 offset:8192
    ds_read_b64_tr_b16 v[114:115], v15 offset:9216
    ds_read_b64_tr_b16 v[116:117], v18 offset:8192
    ds_read_b64_tr_b16 v[118:119], v18 offset:9216
    v_mfma_f32_32x32x16_bf16 v[96:111], v[124:127], v[140:143], v[96:111]
    s_waitcnt vmcnt(0)
    v_cmp_ne_u32 vcc, s50, v29
    v_add_f32 v32, v32, v40
    v_add_f32 v33, v33, v41
    v_add_f32 v34, v34, v42
    v_add_f32 v35, v35, v43
    v_add_f32 v36, v36, v44
    v_add_f32 v37, v37, v45
    v_add_f32 v38, v38, v46
    v_add_f32 v39, v39, v47
    s_cmp_eq_u32 vcc_lo, 0
    s_cbranch_scc1 g_gok
    s_mov_b32 s49, 200000
z_poll49:
    buffer_load_dwordx2 v[28:29], v11, s[4:7], 0 offen sc1
z_pchk51:
    s_waitcnt vmcnt(0)
    v_cmp_ne_u32 vcc, s50, v29
    s_nop 1
    s_and_b32 vcc_lo, vcc_lo, vcc_lo
    s_cbranch_scc0 z_pdone50
    s_sleep 2
    s_sub_u32 s49, s49, 1
    s_cmp_lg_u32 s49, 0
    s_cbranch_scc1 z_poll49
z_pdone50:
g_gok:
    v_add_f32 v32, v32, v36
    v_add_f32 v33, v33, v37
    v_add_f32 v34, v34, v38
    v_add_f32 v35, v35, v39
    v_add_f32 v32, v32, v34
    v_add_f32 v33, v33, v35
    v_mov_b32 v34, v32
    v_mov_b32 v35, v33
    v_sub_f32 v28, 1.0, v28
    s_nop 0
    v_permlane32_swap_b32 v34, v32
    v_permlane32_swap_b32 v35, v33
    s_nop 0
    v_add_f32 v32, v32, v34
    v_add_f32 v33, v33, v35
    v_mul_f32 v13, 0x3b000000, v32
    v_mul_f32 v3, v13, v13
    v_mov_b32 v5, 0x3b000000
    v_fma_f32 v3, v33, v5, -v3
    v_max_f32 v3, 0, v3
    v_add_f32 v3, 0x3727c5ac, v3
    v_rsq_f32 v5, v3
    s_nop 0
    v_mul_f32 v16, v3, v5
    v_mul_f32 v12, 0xc0135761, v5
    v_mul_f32 v14, v5, v5
    v_mul_f32 v14, v14, v5
    v_mul_f32 v14, 0xbdd2d3e8, v14
    v_max_f32 v3, 0x21800000, v28
    v_rcp_f32 v3, v3
    s_nop 0
    v_mul_f32 v16, v16, v3
    v_cvt_pk_bf16_f32 v36, -v13, -v13
    v_and_b32 v3, 0xffff0000, v36
    v_add_f32 v3, v3, v13
    v_cvt_pk_bf16_f32 v37, -v3, 0
    v_mov_b32 v38, 0
    v_mov_b32 v39, 0
    s_mov_b32 exec_lo, 0
    v_mov_b32 v36, 0
    v_mov_b32 v37, 0
    s_mov_b32 exec_lo, -1
    s_mov_b32 s49, 1600000
z_lw52:
    ds_read_b32 v17, v7 offset:12
    s_waitcnt lgkmcnt(0)
    v_readfirstlane_b32 s48, v17
    s_nop 1
    s_cmp_ge_u32 s48, 4
    s_cbranch_scc1 z_lwd53
    s_sleep 1
    s_sub_u32 s49, s49, 1
    s_cmp_lg_u32 s49, 0
    s_cbranch_scc1 z_lw52
z_lwd53:
    ds_read_b32 v32, v6 offset:0
    ds_read_b32 v33, v6 offset:128
    ds_read_b32 v34, v6 offset:256
    ds_read_b32 v35, v6 offset:384
    v_mov_b32 v42, 0
    v_mov_b32 v43, 0
    v_mov_b32 v46, 0
    v_mov_b32 v47, 0
    s_mov_b32 s49, 1600000
z_lw54:
    ds_read_b32 v17, v7 offset:24
    s_waitcnt lgkmcnt(0)
    v_readfirstlane_b32 s48, v17
    s_nop 1
    s_cmp_ge_u32 s48, 4
    s_cbranch_scc1 z_lwd55
    s_sleep 1
    s_sub_u32 s49, s49, 1
    s_cmp_lg_u32 s49, 0
    s_cbranch_scc1 z_lw54
z_lwd55:
    v_cvt_pk_bf16_f32 v41, v32, 0
    v_lshlrev_b32 v3, 16, v41
    v_sub_f32 v3, v32, v3
    v_cvt_pk_bf16_f32 v40, v32, v3
    s_nop 1
    v_mfma_f32_32x32x16_bf16 v[48:63], v[40:43], v[36:39], v[48:63]
    v_cvt_pk_bf16_f32 v45, v33, 0
    v_lshlrev_b32 v3, 16, v45
    v_sub_f32 v3, v33, v3
    v_cvt_pk_bf16_f32 v44, v33, v3
    s_nop 1
    v_mfma_f32_32x32x16_bf16 v[64:79], v[44:47], v[36:39], v[64:79]
    v_cvt_pk_bf16_f32 v41, v34, 0
    v_lshlrev_b32 v3, 16, v41
    v_sub_f32 v3, v34, v3
    v_cvt_pk_bf16_f32 v40, v34, v3
    s_nop 1
    v_mfma_f32_32x32x16_bf16 v[80:95], v[40:43], v[36:39], v[80:95]
    v_cvt_pk_bf16_f32 v45, v35, 0
    v_lshlrev_b32 v3, 16, v45
    v_sub_f32 v3, v35, v3
    v_cvt_pk_bf16_f32 v44, v35, v3
    s_nop 1
    v_mfma_f32_32x32x16_bf16 v[96:111], v[44:47], v[36:39], v[96:111]
    s_mul_i32 s62, s98, 114688
    s_lshl_b32 s47, s99, 13
    s_add_u32 s62, s62, s47
    s_add_u32 s62, s62, 10485760
    s_lshl_b32 s47, s98, 5
    s_lshl_b32 s48, s99, 1
    s_add_u32 s47, s47, s48
    s_lshl_b32 s47, s47, 7
    s_add_u32 s3, s47, 18612224
    s_waitcnt lgkmcnt(0)
    v_mfma_f32_32x32x16_bf16 v[80:95], v[112:115], v[144:147], v[80:95]
    ds_read_b64_tr_b16 v[120:121], v15 offset:10240
    ds_read_b64_tr_b16 v[122:123], v15 offset:11264
    ds_read_b64_tr_b16 v[124:125], v18 offset:10240
    ds_read_b64_tr_b16 v[126:127], v18 offset:11264
    v_mul_f32 v32, v48, v48
    v_mul_f32 v33, v49, v49
    v_mul_f32 v34, v50, v50
    v_mul_f32 v35, v51, v51
    v_mul_f32 v36, v52, v52
    v_mfma_f32_32x32x16_bf16 v[96:111], v[116:119], v[144:147], v[96:111]
    v_mul_f32 v37, v53, v53
    v_mul_f32 v38, v54, v54
    v_mul_f32 v39, v55, v55
    v_mul_f32 v40, v56, v56
    v_mul_f32 v41, v57, v57
    s_add_u32 m0, s61, 65536
    s_lshl_b32 s47, s20, 16
    s_add_u32 s47, s47, 0
    s_waitcnt vmcnt(8)
    buffer_load_dwordx4 v9, s[12:15], s47 offen lds
    s_waitcnt lgkmcnt(0)
    v_mfma_f32_32x32x16_bf16 v[80:95], v[120:123], v[148:151], v[80:95]
    ds_read_b64_tr_b16 v[112:113], v15 offset:12288
    ds_read_b64_tr_b16 v[114:115], v15 offset:13312
    ds_read_b64_tr_b16 v[116:117], v18 offset:12288
    ds_read_b64_tr_b16 v[118:119], v18 offset:13312
    v_mul_f32 v42, v58, v58
    v_mul_f32 v43, v59, v59
    v_mul_f32 v44, v60, v60
    v_mul_f32 v45, v61, v61
    v_mul_f32 v46, v62, v62
    v_mfma_f32_32x32x16_bf16 v[96:111], v[124:127], v[148:151], v[96:111]
    v_mul_f32 v47, v63, v63
    v_fma_f32 v32, v32, v14, v12
    v_fma_f32 v33, v33, v14, v12
    v_fma_f32 v34, v34, v14, v12
    v_fma_f32 v35, v35, v14, v12
    s_waitcnt lgkmcnt(0)
    v_mfma_f32_32x32x16_bf16 v[80:95], v[112:115], v[152:155], v[80:95]
    ds_read_b64_tr_b16 v[120:121], v15 offset:14336
    ds_read_b64_tr_b16 v[122:123], v15 offset:15360
    ds_read_b64_tr_b16 v[124:125], v18 offset:14336
    ds_read_b64_tr_b16 v[126:127], v18 offset:15360
    v_fma_f32 v36, v36, v14, v12
    v_fma_f32 v37, v37, v14, v12
    v_fma_f32 v38, v38, v14, v12
    v_fma_f32 v39, v39, v14, v12
    v_fma_f32 v40, v40, v14, v12
    v_mfma_f32_32x32x16_bf16 v[96:111], v[116:119], v[152:155], v[96:111]
    v_fma_f32 v41, v41, v14, v12
    v_fma_f32 v42, v42, v14, v12
    v_fma_f32 v43, v43, v14, v12
    v_fma_f32 v44, v44, v14, v12
    v_fma_f32 v45, v45, v14, v12
    s_add_u32 m0, s61, 66560
    s_lshl_b32 s47, s20, 16
    s_add_u32 s47, s47, 8192
    s_waitcnt vmcnt(8)
    buffer_load_dwordx4 v9, s[12:15], s47 offen lds
    s_waitcnt lgkmcnt(0)
    v_mfma_f32_32x32x16_bf16 v[80:95], v[120:123], v[156:159], v[80:95]
    ds_read_b64_tr_b16 v[112:113], v15 offset:16384
    ds_read_b64_tr_b16 v[114:115], v15 offset:17408
    ds_read_b64_tr_b16 v[116:117], v18 offset:16384
    ds_read_b64_tr_b16 v[118:119], v18 offset:17408
    v_fma_f32 v46, v46, v14, v12
    v_fma_f32 v47, v47, v14, v12
    v_mul_f32 v32, v32, v48
    v_mul_f32 v33, v33, v49
    v_mul_f32 v34, v34, v50
    v_mfma_f32_32x32x16_bf16 v[96:111], v[124:127], v[156:159], v[96:111]
    v_mul_f32 v35, v35, v51
    v_mul_f32 v36, v36, v52
    v_mul_f32 v37, v37, v53
    v_mul_f32 v38, v38, v54
    v_mul_f32 v39, v39, v55
    s_waitcnt lgkmcnt(0)
    v_mfma_f32_32x32x16_bf16 v[80:95], v[112:115], v[160:163], v[80:95]
    ds_read_b64_tr_b16 v[120:121], v15 offset:18432
    ds_read_b64_tr_b16 v[122:123], v15 offset:19456
    ds_read_b64_tr_b16 v[124:125], v18 offset:18432
    ds_read_b64_tr_b16 v[126:127], v18 offset:19456
    ds_read_b64_tr_b16 v[144:145], v15 offset:20480
    ds_read_b64_tr_b16 v[146:147], v15 offset:21504
    ds_read_b64_tr_b16 v[148:149], v18 offset:20480
    ds_read_b64_tr_b16 v[150:151], v18 offset:21504
    v_mul_f32 v40, v40, v56
    v_mul_f32 v41, v41, v57
    v_mul_f32 v42, v42, v58
    v_mul_f32 v43, v43, v59
    v_mul_f32 v44, v44, v60
    v_mfma_f32_32x32x16_bf16 v[96:111], v[116:119], v[160:163], v[96:111]
    v_mul_f32 v45, v45, v61
    v_mul_f32 v46, v46, v62
    v_mul_f32 v47, v47, v63
    v_exp_f32 v32, v32
    v_exp_f32 v33, v33
    s_add_u32 m0, s61, 67584
    s_lshl_b32 s47, s20, 16
    s_add_u32 s47, s47, 16384
    s_waitcnt vmcnt(8)
    buffer_load_dwordx4 v9, s[12:15], s47 offen lds
    s_waitcnt lgkmcnt(4)
    v_mfma_f32_32x32x16_bf16 v[80:95], v[120:123], v[164:167], v[80:95]
    ds_read_b64_tr_b16 v[152:153], v15 offset:22528
    ds_read_b64_tr_b16 v[154:155], v15 offset:23552
    ds_read_b64_tr_b16 v[156:157], v18 offset:22528
    ds_read_b64_tr_b16 v[158:159], v18 offset:23552
    ds_read_b64_tr_b16 v[128:129], v15 offset:24576
    ds_read_b64_tr_b16 v[130:131], v15 offset:25600
    ds_read_b64_tr_b16 v[132:133], v18 offset:24576
    ds_read_b64_tr_b16 v[134:135], v18 offset:25600
    v_exp_f32 v34, v34
    v_exp_f32 v35, v35
    v_exp_f32 v36, v36
    v_exp_f32 v37, v37
    v_exp_f32 v38, v38
    v_mfma_f32_32x32x16_bf16 v[96:111], v[124:127], v[164:167], v[96:111]
    v_exp_f32 v39, v39
    v_exp_f32 v40, v40
    v_exp_f32 v41, v41
    v_exp_f32 v42, v42
    v_exp_f32 v43, v43
    s_waitcnt lgkmcnt(8)
    v_mfma_f32_32x32x16_bf16 v[80:95], v[144:147], v[168:171], v[80:95]
    ds_read_b64_tr_b16 v[136:137], v15 offset:26624
    ds_read_b64_tr_b16 v[138:139], v15 offset:27648
    ds_read_b64_tr_b16 v[140:141], v18 offset:26624
    ds_read_b64_tr_b16 v[142:143], v18 offset:27648
    v_exp_f32 v44, v44
    v_exp_f32 v45, v45
    v_exp_f32 v46, v46
    v_exp_f32 v47, v47
    v_fma_f32 v32, v32, v16, v16
    v_mfma_f32_32x32x16_bf16 v[96:111], v[148:151], v[168:171], v[96:111]
    v_fma_f32 v33, v33, v16, v16
    v_fma_f32 v34, v34, v16, v16
    v_fma_f32 v35, v35, v16, v16
    v_fma_f32 v36, v36, v16, v16
    v_fma_f32 v37, v37, v16, v16
    s_add_u32 m0, s61, 68608
    s_lshl_b32 s47, s20, 16
    s_add_u32 s47, s47, 24576
    s_waitcnt vmcnt(8)
    buffer_load_dwordx4 v9, s[12:15], s47 offen lds
    s_waitcnt lgkmcnt(8)
    v_mfma_f32_32x32x16_bf16 v[80:95], v[152:155], v[172:175], v[80:95]
    ds_read_b64_tr_b16 v[144:145], v15 offset:28672
    ds_read_b64_tr_b16 v[146:147], v15 offset:29696
    ds_read_b64_tr_b16 v[148:149], v18 offset:28672
    ds_read_b64_tr_b16 v[150:151], v18 offset:29696
    v_fma_f32 v38, v38, v16, v16
    v_fma_f32 v39, v39, v16, v16
    v_fma_f32 v40, v40, v16, v16
    v_fma_f32 v41, v41, v16, v16
    v_fma_f32 v42, v42, v16, v16
    v_mfma_f32_32x32x16_bf16 v[96:111], v[156:159], v[172:175], v[96:111]
    v_fma_f32 v43, v43, v16, v16
    v_fma_f32 v44, v44, v16, v16
    v_fma_f32 v45, v45, v16, v16
    v_fma_f32 v46, v46, v16, v16
    v_fma_f32 v47, v47, v16, v16
    s_waitcnt lgkmcnt(8)
    v_mfma_f32_32x32x16_bf16 v[80:95], v[128:131], v[176:179], v[80:95]
    ds_read_b64_tr_b16 v[152:153], v15 offset:30720
    ds_read_b64_tr_b16 v[154:155], v15 offset:31744
    ds_read_b64_tr_b16 v[156:157], v18 offset:30720
    ds_read_b64_tr_b16 v[158:159], v18 offset:31744
    v_rcp_f32 v32, v32
    v_rcp_f32 v33, v33
    v_rcp_f32 v34, v34
    v_rcp_f32 v35, v35
    v_rcp_f32 v36, v36
    v_mfma_f32_32x32x16_bf16 v[96:111], v[132:135], v[176:179], v[96:111]
    v_rcp_f32 v37, v37
    v_rcp_f32 v38, v38
    v_rcp_f32 v39, v39
    v_rcp_f32 v40, v40
    v_rcp_f32 v41, v41
    s_add_u32 m0, s61, 69632
    s_lshl_b32 s47, s20, 16
    s_add_u32 s47, s47, 32768
    s_waitcnt vmcnt(8)
    buffer_load_dwordx4 v9, s[12:15], s47 offen lds
    s_waitcnt lgkmcnt(8)
    v_mfma_f32_32x32x16_bf16 v[80:95], v[136:139], v[180:183], v[80:95]
    ds_read_b64_tr_b16 v[128:129], v15 offset:32768
    ds_read_b64_tr_b16 v[130:131], v15 offset:33792
    ds_read_b64_tr_b16 v[132:133], v18 offset:32768
    ds_read_b64_tr_b16 v[134:135], v18 offset:33792
    v_rcp_f32 v42, v42
    v_rcp_f32 v43, v43
    v_rcp_f32 v44, v44
    v_rcp_f32 v45, v45
    v_rcp_f32 v46, v46
    v_mfma_f32_32x32x16_bf16 v[96:111], v[140:143], v[180:183], v[96:111]
    v_rcp_f32 v47, v47
    v_mul_f32 v48, v48, v32
    v_mul_f32 v49, v49, v33
    v_mul_f32 v50, v50, v34
    v_mul_f32 v51, v51, v35
    s_waitcnt lgkmcnt(8)
    v_mfma_f32_32x32x16_bf16 v[80:95], v[144:147], v[184:187], v[80:95]
    ds_read_b64_tr_b16 v[136:137], v15 offset:34816
    ds_read_b64_tr_b16 v[138:139], v15 offset:35840
    ds_read_b64_tr_b16 v[140:141], v18 offset:34816
    ds_read_b64_tr_b16 v[142:143], v18 offset:35840
    v_mul_f32 v52, v52, v36
    v_mul_f32 v53, v53, v37
    v_mul_f32 v54, v54, v38
    v_mul_f32 v55, v55, v39
    v_mul_f32 v56, v56, v40
    v_mfma_f32_32x32x16_bf16 v[96:111], v[148:151], v[184:187], v[96:111]
    v_mul_f32 v57, v57, v41
    v_mul_f32 v58, v58, v42
    v_mul_f32 v59, v59, v43
    v_mul_f32 v60, v60, v44
    v_mul_f32 v61, v61, v45
    s_add_u32 m0, s61, 70656
    s_lshl_b32 s47, s20, 16
    s_add_u32 s47, s47, 40960
    s_waitcnt vmcnt(8)
    buffer_load_dwordx4 v9, s[12:15], s47 offen lds
    s_waitcnt lgkmcnt(8)
    v_mfma_f32_32x32x16_bf16 v[80:95], v[152:155], v[188:191], v[80:95]
    ds_read_b64_tr_b16 v[144:145], v15 offset:36864
    ds_read_b64_tr_b16 v[146:147], v15 offset:37888
    ds_read_b64_tr_b16 v[148:149], v18 offset:36864
    ds_read_b64_tr_b16 v[150:151], v18 offset:37888
    v_mul_f32 v62, v62, v46
    v_mul_f32 v63, v63, v47
    v_cvt_pk_bf16_f32 v48, v48, v49
    v_cvt_pk_bf16_f32 v49, v50, v51
    v_cvt_pk_bf16_f32 v50, v52, v53
    v_mfma_f32_32x32x16_bf16 v[96:111], v[156:159], v[188:191], v[96:111]
    v_cvt_pk_bf16_f32 v51, v54, v55
    v_cvt_pk_bf16_f32 v52, v56, v57
    v_cvt_pk_bf16_f32 v53, v58, v59
    v_cvt_pk_bf16_f32 v54, v60, v61
    v_cvt_pk_bf16_f32 v55, v62, v63
    s_waitcnt lgkmcnt(8)
    v_mfma_f32_32x32x16_bf16 v[80:95], v[128:131], v[192:195], v[80:95]
    ds_read_b64_tr_b16 v[152:153], v15 offset:38912
    ds_read_b64_tr_b16 v[154:155], v15 offset:39936
    ds_read_b64_tr_b16 v[156:157], v18 offset:38912
    ds_read_b64_tr_b16 v[158:159], v18 offset:39936
    s_add_u32 s48, s62, 0
    buffer_store_dwordx4 v[48:51], v2, s[4:7], s48 offen sc1
    buffer_store_dwordx4 v[52:55], v2, s[4:7], s48 offen offset:1024 sc1
    v_mul_f32 v32, v64, v64
    v_mul_f32 v33, v65, v65
    v_mul_f32 v34, v66, v66
    v_mul_f32 v35, v67, v67
    v_mfma_f32_32x32x16_bf16 v[96:111], v[132:135], v[192:195], v[96:111]
    v_mul_f32 v36, v68, v68
    v_mul_f32 v37, v69, v69
    v_mul_f32 v38, v70, v70
    v_mul_f32 v39, v71, v71
    v_mul_f32 v40, v72, v72
    s_add_u32 m0, s61, 71680
    s_lshl_b32 s47, s20, 16
    s_add_u32 s47, s47, 49152
    s_waitcnt vmcnt(8)
    buffer_load_dwordx4 v9, s[12:15], s47 offen lds
    s_waitcnt lgkmcnt(8)
    v_mfma_f32_32x32x16_bf16 v[80:95], v[136:139], v[196:199], v[80:95]
    ds_read_b64_tr_b16 v[128:129], v15 offset:40960
    ds_read_b64_tr_b16 v[130:131], v15 offset:41984
    ds_read_b64_tr_b16 v[132:133], v18 offset:40960
    ds_read_b64_tr_b16 v[134:135], v18 offset:41984
    v_mul_f32 v41, v73, v73
    v_mul_f32 v42, v74, v74
    v_mul_f32 v43, v75, v75
    v_mul_f32 v44, v76, v76
    v_mul_f32 v45, v77, v77
    v_mfma_f32_32x32x16_bf16 v[96:111], v[140:143], v[196:199], v[96:111]
    v_mul_f32 v46, v78, v78
    v_mul_f32 v47, v79, v79
    v_fma_f32 v32, v32, v14, v12
    v_fma_f32 v33, v33, v14, v12
    v_fma_f32 v34, v34, v14, v12
    s_waitcnt lgkmcnt(8)
    v_mfma_f32_32x32x16_bf16 v[80:95], v[144:147], v[200:203], v[80:95]
    ds_read_b64_tr_b16 v[136:137], v15 offset:43008
    ds_read_b64_tr_b16 v[138:139], v15 offset:44032
    ds_read_b64_tr_b16 v[140:141], v18 offset:43008
    ds_read_b64_tr_b16 v[142:143], v18 offset:44032
    v_fma_f32 v35, v35, v14, v12
    v_fma_f32 v36, v36, v14, v12
    v_fma_f32 v37, v37, v14, v12
    v_fma_f32 v38, v38, v14, v12
    v_fma_f32 v39, v39, v14, v12
    v_mfma_f32_32x32x16_bf16 v[96:111], v[148:151], v[200:203], v[96:111]
    v_fma_f32 v40, v40, v14, v12
    v_fma_f32 v41, v41, v14, v12
    v_fma_f32 v42, v42, v14, v12
    v_fma_f32 v43, v43, v14, v12
    v_fma_f32 v44, v44, v14, v12
    s_add_u32 m0, s61, 72704
    s_lshl_b32 s47, s20, 16
    s_add_u32 s47, s47, 57344
    s_waitcnt vmcnt(8)
    buffer_load_dwordx4 v9, s[12:15], s47 offen lds
    s_waitcnt lgkmcnt(8)
    v_mfma_f32_32x32x16_bf16 v[80:95], v[152:155], v[204:207], v[80:95]
    ds_read_b64_tr_b16 v[144:145], v15 offset:45056
    ds_read_b64_tr_b16 v[146:147], v15 offset:46080
    ds_read_b64_tr_b16 v[148:149], v18 offset:45056
    ds_read_b64_tr_b16 v[150:151], v18 offset:46080
    v_fma_f32 v45, v45, v14, v12
    v_fma_f32 v46, v46, v14, v12
    v_fma_f32 v47, v47, v14, v12
    v_mul_f32 v32, v32, v64
    v_mul_f32 v33, v33, v65
    v_mfma_f32_32x32x16_bf16 v[96:111], v[156:159], v[204:207], v[96:111]
    v_mul_f32 v34, v34, v66
    v_mul_f32 v35, v35, v67
    v_mul_f32 v36, v36, v68
    v_mul_f32 v37, v37, v69
    v_mul_f32 v38, v38, v70
    s_waitcnt lgkmcnt(8)
    v_mfma_f32_32x32x16_bf16 v[80:95], v[128:131], v[208:211], v[80:95]
    ds_read_b64_tr_b16 v[152:153], v15 offset:47104
    ds_read_b64_tr_b16 v[154:155], v15 offset:48128
    ds_read_b64_tr_b16 v[156:157], v18 offset:47104
    ds_read_b64_tr_b16 v[158:159], v18 offset:48128
    v_mul_f32 v39, v39, v71
    v_mul_f32 v40, v40, v72
    v_mul_f32 v41, v41, v73
    v_mul_f32 v42, v42, v74
    v_mul_f32 v43, v43, v75
    v_mfma_f32_32x32x16_bf16 v[96:111], v[132:135], v[208:211], v[96:111]
    v_mul_f32 v44, v44, v76
    v_mul_f32 v45, v45, v77
    v_mul_f32 v46, v46, v78
    v_mul_f32 v47, v47, v79
    v_exp_f32 v32, v32
    s_waitcnt lgkmcnt(8)
    v_mfma_f32_32x32x16_bf16 v[80:95], v[136:139], v[212:215], v[80:95]
    ds_read_b64_tr_b16 v[128:129], v15 offset:49152
    ds_read_b64_tr_b16 v[130:131], v15 offset:50176
    ds_read_b64_tr_b16 v[132:133], v18 offset:49152
    ds_read_b64_tr_b16 v[134:135], v18 offset:50176
    v_exp_f32 v33, v33
    v_exp_f32 v34, v34
    v_exp_f32 v35, v35
    v_exp_f32 v36, v36
    v_exp_f32 v37, v37
    v_mfma_f32_32x32x16_bf16 v[96:111], v[140:143], v[212:215], v[96:111]
    v_exp_f32 v38, v38
    v_exp_f32 v39, v39
    v_exp_f32 v40, v40
    v_exp_f32 v41, v41
    v_exp_f32 v42, v42
    s_waitcnt lgkmcnt(8)
    v_mfma_f32_32x32x16_bf16 v[80:95], v[144:147], v[216:219], v[80:95]
    ds_read_b64_tr_b16 v[136:137], v15 offset:51200
    ds_read_b64_tr_b16 v[138:139], v15 offset:52224
    ds_read_b64_tr_b16 v[140:141], v18 offset:51200
    ds_read_b64_tr_b16 v[142:143], v18 offset:52224
    v_exp_f32 v43, v43
    v_exp_f32 v44, v44
    v_exp_f32 v45, v45
    v_exp_f32 v46, v46
    v_exp_f32 v47, v47
    v_mfma_f32_32x32x16_bf16 v[96:111], v[148:151], v[216:219], v[96:111]
    v_fma_f32 v32, v32, v16, v16
    v_fma_f32 v33, v33, v16, v16
    v_fma_f32 v34, v34, v16, v16
    v_fma_f32 v35, v35, v16, v16
    v_fma_f32 v36, v36, v16, v16
    s_waitcnt lgkmcnt(8)
    v_mfma_f32_32x32x16_bf16 v[80:95], v[152:155], v[220:223], v[80:95]
    ds_read_b64_tr_b16 v[144:145], v15 offset:53248
    ds_read_b64_tr_b16 v[146:147], v15 offset:54272
    ds_read_b64_tr_b16 v[148:149], v18 offset:53248
    ds_read_b64_tr_b16 v[150:151], v18 offset:54272
    v_fma_f32 v37, v37, v16, v16
    v_fma_f32 v38, v38, v16, v16
    v_fma_f32 v39, v39, v16, v16
    v_fma_f32 v40, v40, v16, v16
    v_fma_f32 v41, v41, v16, v16
    v_mfma_f32_32x32x16_bf16 v[96:111], v[156:159], v[220:223], v[96:111]
    v_fma_f32 v42, v42, v16, v16
    v_fma_f32 v43, v43, v16, v16
    v_fma_f32 v44, v44, v16, v16
    v_fma_f32 v45, v45, v16, v16
    v_fma_f32 v46, v46, v16, v16
    s_waitcnt lgkmcnt(8)
    v_mfma_f32_32x32x16_bf16 v[80:95], v[128:131], v[224:227], v[80:95]
    ds_read_b64_tr_b16 v[152:153], v15 offset:55296
    ds_read_b64_tr_b16 v[154:155], v15 offset:56320
    ds_read_b64_tr_b16 v[156:157], v18 offset:55296
    ds_read_b64_tr_b16 v[158:159], v18 offset:56320
    v_fma_f32 v47, v47, v16, v16
    v_rcp_f32 v32, v32
    v_rcp_f32 v33, v33
    v_rcp_f32 v34, v34
    v_rcp_f32 v35, v35
    v_mfma_f32_32x32x16_bf16 v[96:111], v[132:135], v[224:227], v[96:111]
    v_rcp_f32 v36, v36
    v_rcp_f32 v37, v37
    v_rcp_f32 v38, v38
    v_rcp_f32 v39, v39
    v_rcp_f32 v40, v40
    s_waitcnt lgkmcnt(8)
    v_mfma_f32_32x32x16_bf16 v[80:95], v[136:139], v[228:231], v[80:95]
    ds_read_b64_tr_b16 v[128:129], v15 offset:57344
    ds_read_b64_tr_b16 v[130:131], v15 offset:58368
    ds_read_b64_tr_b16 v[132:133], v18 offset:57344
    ds_read_b64_tr_b16 v[134:135], v18 offset:58368
    v_rcp_f32 v41, v41
    v_rcp_f32 v42, v42
    v_rcp_f32 v43, v43
    v_rcp_f32 v44, v44
    v_rcp_f32 v45, v45
    v_mfma_f32_32x32x16_bf16 v[96:111], v[140:143], v[228:231], v[96:111]
    v_rcp_f32 v46, v46
    v_rcp_f32 v47, v47
    v_mul_f32 v64, v64, v32
    v_mul_f32 v65, v65, v33
    v_mul_f32 v66, v66, v34
    s_waitcnt lgkmcnt(8)
    v_mfma_f32_32x32x16_bf16 v[80:95], v[144:147], v[232:235], v[80:95]
    ds_read_b64_tr_b16 v[136:137], v15 offset:59392
    ds_read_b64_tr_b16 v[138:139], v15 offset:60416
    ds_read_b64_tr_b16 v[140:141], v18 offset:59392
    ds_read_b64_tr_b16 v[142:143], v18 offset:60416
    v_mul_f32 v67, v67, v35
    v_mul_f32 v68, v68, v36
    v_mul_f32 v69, v69, v37
    v_mul_f32 v70, v70, v38
    v_mul_f32 v71, v71, v39
    v_mfma_f32_32x32x16_bf16 v[96:111], v[148:151], v[232:235], v[96:111]
    v_mul_f32 v72, v72, v40
    v_mul_f32 v73, v73, v41
    v_mul_f32 v74, v74, v42
    v_mul_f32 v75, v75, v43
    v_mul_f32 v76, v76, v44
    s_waitcnt lgkmcnt(8)
    v_mfma_f32_32x32x16_bf16 v[80:95], v[152:155], v[236:239], v[80:95]
    ds_read_b64_tr_b16 v[144:145], v15 offset:61440
    ds_read_b64_tr_b16 v[146:147], v15 offset:62464
    ds_read_b64_tr_b16 v[148:149], v18 offset:61440
    ds_read_b64_tr_b16 v[150:151], v18 offset:62464
    v_mul_f32 v77, v77, v45
    v_mul_f32 v78, v78, v46
    v_mul_f32 v79, v79, v47
    v_cvt_pk_bf16_f32 v64, v64, v65
    v_cvt_pk_bf16_f32 v65, v66, v67
    v_mfma_f32_32x32x16_bf16 v[96:111], v[156:159], v[236:239], v[96:111]
    v_cvt_pk_bf16_f32 v66, v68, v69
    v_cvt_pk_bf16_f32 v67, v70, v71
    v_cvt_pk_bf16_f32 v68, v72, v73
    v_cvt_pk_bf16_f32 v69, v74, v75
    v_cvt_pk_bf16_f32 v70, v76, v77
    s_waitcnt lgkmcnt(8)
    v_mfma_f32_32x32x16_bf16 v[80:95], v[128:131], v[240:243], v[80:95]
    ds_read_b64_tr_b16 v[152:153], v15 offset:63488
    ds_read_b64_tr_b16 v[154:155], v15 offset:64512
    ds_read_b64_tr_b16 v[156:157], v18 offset:63488
    ds_read_b64_tr_b16 v[158:159], v18 offset:64512
    v_cvt_pk_bf16_f32 v71, v78, v79
    s_add_u32 s48, s62, 2048
    buffer_store_dwordx4 v[64:67], v2, s[4:7], s48 offen sc1
    buffer_store_dwordx4 v[68:71], v2, s[4:7], s48 offen offset:1024 sc1
    v_mfma_f32_32x32x16_bf16 v[96:111], v[132:135], v[240:243], v[96:111]
    s_waitcnt lgkmcnt(8)
    v_mfma_f32_32x32x16_bf16 v[80:95], v[136:139], v[244:247], v[80:95]
    v_mfma_f32_32x32x16_bf16 v[96:111], v[140:143], v[244:247], v[96:111]
    s_waitcnt lgkmcnt(4)
    v_mfma_f32_32x32x16_bf16 v[80:95], v[144:147], v[248:251], v[80:95]
    v_mfma_f32_32x32x16_bf16 v[96:111], v[148:151], v[248:251], v[96:111]
    s_waitcnt lgkmcnt(0)
    v_mfma_f32_32x32x16_bf16 v[80:95], v[152:155], v[252:255], v[80:95]
    v_mfma_f32_32x32x16_bf16 v[96:111], v[156:159], v[252:255], v[96:111]
    s_mov_b64 exec, 1
    ds_add_u32 v7, v8 offset:52
    s_mov_b64 exec, -1
    s_nop 7
    v_pk_mul_f32 v[32:33], v[80:81], v[80:81]
    v_pk_mul_f32 v[34:35], v[82:83], v[82:83]
    v_pk_mul_f32 v[36:37], v[84:85], v[84:85]
    v_pk_mul_f32 v[38:39], v[86:87], v[86:87]
    v_pk_mul_f32 v[40:41], v[88:89], v[88:89]
    v_pk_mul_f32 v[42:43], v[90:91], v[90:91]
    v_pk_mul_f32 v[44:45], v[92:93], v[92:93]
    v_pk_mul_f32 v[46:47], v[94:95], v[94:95]
    v_pk_fma_f32 v[32:33], v[32:33], v[14:15], v[12:13] op_sel_hi:[1,0,0]
    v_pk_fma_f32 v[34:35], v[34:35], v[14:15], v[12:13] op_sel_hi:[1,0,0]
    v_pk_fma_f32 v[36:37], v[36:37], v[14:15], v[12:13] op_sel_hi:[1,0,0]
    v_pk_fma_f32 v[38:39], v[38:39], v[14:15], v[12:13] op_sel_hi:[1,0,0]
    s_add_u32 m0, s61, 73728
    s_lshl_b32 s47, s21, 16
    s_add_u32 s47, s47, 0
    s_waitcnt vmcnt(8)
    buffer_load_dwordx4 v9, s[12:15], s47 offen lds
    v_pk_fma_f32 v[40:41], v[40:41], v[14:15], v[12:13] op_sel_hi:[1,0,0]
    v_pk_fma_f32 v[42:43], v[42:43], v[14:15], v[12:13] op_sel_hi:[1,0,0]
    v_pk_fma_f32 v[44:45], v[44:45], v[14:15], v[12:13] op_sel_hi:[1,0,0]
    v_pk_fma_f32 v[46:47], v[46:47], v[14:15], v[12:13] op_sel_hi:[1,0,0]
    v_pk_mul_f32 v[32:33], v[32:33], v[80:81]
    v_pk_mul_f32 v[34:35], v[34:35], v[82:83]
    v_pk_mul_f32 v[36:37], v[36:37], v[84:85]
    v_pk_mul_f32 v[38:39], v[38:39], v[86:87]
    s_add_u32 m0, s61, 74752
    s_lshl_b32 s47, s21, 16
    s_add_u32 s47, s47, 8192
    s_waitcnt vmcnt(8)
    buffer_load_dwordx4 v9, s[12:15], s47 offen lds
    v_pk_mul_f32 v[40:41], v[40:41], v[88:89]
    v_pk_mul_f32 v[42:43], v[42:43], v[90:91]
    v_pk_mul_f32 v[44:45], v[44:45], v[92:93]
    v_pk_mul_f32 v[46:47], v[46:47], v[94:95]
    v_exp_f32 v32, v32
    v_exp_f32 v33, v33
    v_exp_f32 v34, v34
    v_exp_f32 v35, v35
    s_add_u32 m0, s61, 75776
    s_lshl_b32 s47, s21, 16
    s_add_u32 s47, s47, 16384
    s_waitcnt vmcnt(8)
    buffer_load_dwordx4 v9, s[12:15], s47 offen lds
    v_exp_f32 v36, v36
    v_exp_f32 v37, v37
    v_exp_f32 v38, v38
    v_exp_f32 v39, v39
    v_exp_f32 v40, v40
    v_exp_f32 v41, v41
    v_exp_f32 v42, v42
    v_exp_f32 v43, v43
    s_add_u32 m0, s61, 76800
    s_lshl_b32 s47, s21, 16
    s_add_u32 s47, s47, 24576
    s_waitcnt vmcnt(8)
    buffer_load_dwordx4 v9, s[12:15], s47 offen lds
    v_exp_f32 v44, v44
    v_exp_f32 v45, v45
    v_exp_f32 v46, v46
    v_exp_f32 v47, v47
    v_pk_fma_f32 v[32:33], v[32:33], v[16:17], v[16:17] op_sel_hi:[1,0,0]
    v_pk_fma_f32 v[34:35], v[34:35], v[16:17], v[16:17] op_sel_hi:[1,0,0]
    v_pk_fma_f32 v[36:37], v[36:37], v[16:17], v[16:17] op_sel_hi:[1,0,0]
    v_pk_fma_f32 v[38:39], v[38:39], v[16:17], v[16:17] op_sel_hi:[1,0,0]
    s_add_u32 m0, s61, 77824
    s_lshl_b32 s47, s21, 16
    s_add_u32 s47, s47, 32768
    s_waitcnt vmcnt(8)
    buffer_load_dwordx4 v9, s[12:15], s47 offen lds
    v_pk_fma_f32 v[40:41], v[40:41], v[16:17], v[16:17] op_sel_hi:[1,0,0]
    v_pk_fma_f32 v[42:43], v[42:43], v[16:17], v[16:17] op_sel_hi:[1,0,0]
    v_pk_fma_f32 v[44:45], v[44:45], v[16:17], v[16:17] op_sel_hi:[1,0,0]
    v_pk_fma_f32 v[46:47], v[46:47], v[16:17], v[16:17] op_sel_hi:[1,0,0]
    v_rcp_f32 v32, v32
    v_rcp_f32 v33, v33
    v_rcp_f32 v34, v34
    v_rcp_f32 v35, v35
    s_add_u32 m0, s61, 78848
    s_lshl_b32 s47, s21, 16
    s_add_u32 s47, s47, 40960
    s_waitcnt vmcnt(8)
    buffer_load_dwordx4 v9, s[12:15], s47 offen lds
    v_rcp_f32 v36, v36
    v_rcp_f32 v37, v37
    v_rcp_f32 v38, v38
    v_rcp_f32 v39, v39
    v_rcp_f32 v40, v40
    v_rcp_f32 v41, v41
    v_rcp_f32 v42, v42
    v_rcp_f32 v43, v43
    s_add_u32 m0, s61, 79872
    s_lshl_b32 s47, s21, 16
    s_add_u32 s47, s47, 49152
    s_waitcnt vmcnt(8)
    buffer_load_dwordx4 v9, s[12:15], s47 offen lds
    v_rcp_f32 v44, v44
    v_rcp_f32 v45, v45
    v_rcp_f32 v46, v46
    v_rcp_f32 v47, v47
    v_pk_mul_f32 v[80:81], v[80:81], v[32:33]
    v_pk_mul_f32 v[82:83], v[82:83], v[34:35]
    v_pk_mul_f32 v[84:85], v[84:85], v[36:37]
    v_pk_mul_f32 v[86:87], v[86:87], v[38:39]
    s_add_u32 m0, s61, 80896
    s_lshl_b32 s47, s21, 16
    s_add_u32 s47, s47, 57344
    s_waitcnt vmcnt(8)
    buffer_load_dwordx4 v9, s[12:15], s47 offen lds
    v_pk_mul_f32 v[88:89], v[88:89], v[40:41]
    v_pk_mul_f32 v[90:91], v[90:91], v[42:43]
    v_pk_mul_f32 v[92:93], v[92:93], v[44:45]
    v_pk_mul_f32 v[94:95], v[94:95], v[46:47]
    v_cvt_pk_bf16_f32 v80, v80, v81
    v_cvt_pk_bf16_f32 v81, v82, v83
    v_cvt_pk_bf16_f32 v82, v84, v85
    v_cvt_pk_bf16_f32 v83, v86, v87
    v_cvt_pk_bf16_f32 v84, v88, v89
    v_cvt_pk_bf16_f32 v85, v90, v91
    v_cvt_pk_bf16_f32 v86, v92, v93
    v_cvt_pk_bf16_f32 v87, v94, v95
    s_waitcnt vmcnt(8)
    v_mov_b32 v3, s50
    s_mov_b64 exec, 1
    buffer_store_dword v3, v2, s[4:7], s3 offen sc1
    s_mov_b64 exec, -1
    s_add_u32 s48, s62, 4096
    buffer_store_dwordx4 v[80:83], v2, s[4:7], s48 offen sc1
    buffer_store_dwordx4 v[84:87], v2, s[4:7], s48 offen offset:1024 sc1
    v_pk_mul_f32 v[32:33], v[96:97], v[96:97]
    v_pk_mul_f32 v[34:35], v[98:99], v[98:99]
    v_pk_mul_f32 v[36:37], v[100:101], v[100:101]
    v_pk_mul_f32 v[38:39], v[102:103], v[102:103]
    v_pk_mul_f32 v[40:41], v[104:105], v[104:105]
    v_pk_mul_f32 v[42:43], v[106:107], v[106:107]
    v_pk_mul_f32 v[44:45], v[108:109], v[108:109]
    v_pk_mul_f32 v[46:47], v[110:111], v[110:111]
    v_pk_fma_f32 v[32:33], v[32:33], v[14:15], v[12:13] op_sel_hi:[1,0,0]
    v_pk_fma_f32 v[34:35], v[34:35], v[14:15], v[12:13] op_sel_hi:[1,0,0]
    v_pk_fma_f32 v[36:37], v[36:37], v[14:15], v[12:13] op_sel_hi:[1,0,0]
    v_pk_fma_f32 v[38:39], v[38:39], v[14:15], v[12:13] op_sel_hi:[1,0,0]
    v_pk_fma_f32 v[40:41], v[40:41], v[14:15], v[12:13] op_sel_hi:[1,0,0]
    v_pk_fma_f32 v[42:43], v[42:43], v[14:15], v[12:13] op_sel_hi:[1,0,0]
    v_pk_fma_f32 v[44:45], v[44:45], v[14:15], v[12:13] op_sel_hi:[1,0,0]
    v_pk_fma_f32 v[46:47], v[46:47], v[14:15], v[12:13] op_sel_hi:[1,0,0]
    v_pk_mul_f32 v[32:33], v[32:33], v[96:97]
    v_pk_mul_f32 v[34:35], v[34:35], v[98:99]
    v_pk_mul_f32 v[36:37], v[36:37], v[100:101]
    v_pk_mul_f32 v[38:39], v[38:39], v[102:103]
    v_pk_mul_f32 v[40:41], v[40:41], v[104:105]
    v_pk_mul_f32 v[42:43], v[42:43], v[106:107]
    v_pk_mul_f32 v[44:45], v[44:45], v[108:109]
    v_pk_mul_f32 v[46:47], v[46:47], v[110:111]
    v_exp_f32 v32, v32
    v_exp_f32 v33, v33
    v_exp_f32 v34, v34
    v_exp_f32 v35, v35
    v_exp_f32 v36, v36
    v_exp_f32 v37, v37
    v_exp_f32 v38, v38
    v_exp_f32 v39, v39
    v_exp_f32 v40, v40
    v_exp_f32 v41, v41
    v_exp_f32 v42, v42
    v_exp_f32 v43, v43
    v_exp_f32 v44, v44
    v_exp_f32 v45, v45
    v_exp_f32 v46, v46
    v_exp_f32 v47, v47
    v_pk_fma_f32 v[32:33], v[32:33], v[16:17], v[16:17] op_sel_hi:[1,0,0]
    v_pk_fma_f32 v[34:35], v[34:35], v[16:17], v[16:17] op_sel_hi:[1,0,0]
    v_pk_fma_f32 v[36:37], v[36:37], v[16:17], v[16:17] op_sel_hi:[1,0,0]
    v_pk_fma_f32 v[38:39], v[38:39], v[16:17], v[16:17] op_sel_hi:[1,0,0]
    v_pk_fma_f32 v[40:41], v[40:41], v[16:17], v[16:17] op_sel_hi:[1,0,0]
    v_pk_fma_f32 v[42:43], v[42:43], v[16:17], v[16:17] op_sel_hi:[1,0,0]
    v_pk_fma_f32 v[44:45], v[44:45], v[16:17], v[16:17] op_sel_hi:[1,0,0]
    v_pk_fma_f32 v[46:47], v[46:47], v[16:17], v[16:17] op_sel_hi:[1,0,0]
    v_rcp_f32 v32, v32
    v_rcp_f32 v33, v33
    v_rcp_f32 v34, v34
    v_rcp_f32 v35, v35
    v_rcp_f32 v36, v36
    v_rcp_f32 v37, v37
    v_rcp_f32 v38, v38
    v_rcp_f32 v39, v39
    v_rcp_f32 v40, v40
    v_rcp_f32 v41, v41
    v_rcp_f32 v42, v42
    v_rcp_f32 v43, v43
    v_rcp_f32 v44, v44
    v_rcp_f32 v45, v45
    v_rcp_f32 v46, v46
    v_rcp_f32 v47, v47
    v_pk_mul_f32 v[96:97], v[96:97], v[32:33]
    v_pk_mul_f32 v[98:99], v[98:99], v[34:35]
    v_pk_mul_f32 v[100:101], v[100:101], v[36:37]
    v_pk_mul_f32 v[102:103], v[102:103], v[38:39]
    v_pk_mul_f32 v[104:105], v[104:105], v[40:41]
    v_pk_mul_f32 v[106:107], v[106:107], v[42:43]
    v_pk_mul_f32 v[108:109], v[108:109], v[44:45]
    v_pk_mul_f32 v[110:111], v[110:111], v[46:47]
    v_cvt_pk_bf16_f32 v96, v96, v97
    v_cvt_pk_bf16_f32 v97, v98, v99
    v_cvt_pk_bf16_f32 v98, v100, v101
    v_cvt_pk_bf16_f32 v99, v102, v103
    v_cvt_pk_bf16_f32 v100, v104, v105
    v_cvt_pk_bf16_f32 v101, v106, v107
    v_cvt_pk_bf16_f32 v102, v108, v109
    v_cvt_pk_bf16_f32 v103, v110, v111
    s_add_u32 s48, s62, 6144
    buffer_store_dwordx4 v[96:99], v2, s[4:7], s48 offen sc1
    buffer_store_dwordx4 v[100:103], v2, s[4:7], s48 offen offset:1024 sc1
    s_mov_b32 s49, 1600000
z_lw56:
    ds_read_b32 v17, v7 offset:52
    s_waitcnt lgkmcnt(0)
    v_readfirstlane_b32 s48, v17
    s_nop 1
    s_cmp_ge_u32 s48, 4
    s_cbranch_scc1 z_lwd57
    s_sleep 1
    s_sub_u32 s49, s49, 1
    s_cmp_lg_u32 s49, 0
    s_cbranch_scc1 z_lw56
z_lwd57:
    s_add_u32 m0, s61, 0
    s_lshl_b32 s47, s22, 16
    s_add_u32 s47, s47, 0
    s_waitcnt vmcnt(8)
    buffer_load_dwordx4 v9, s[12:15], s47 offen lds
    s_add_u32 m0, s61, 1024
    s_lshl_b32 s47, s22, 16
    s_add_u32 s47, s47, 8192
    s_waitcnt vmcnt(8)
    buffer_load_dwordx4 v9, s[12:15], s47 offen lds
    s_add_u32 m0, s61, 2048
    s_lshl_b32 s47, s22, 16
    s_add_u32 s47, s47, 16384
    s_waitcnt vmcnt(8)
    buffer_load_dwordx4 v9, s[12:15], s47 offen lds
    s_add_u32 m0, s61, 3072
    s_lshl_b32 s47, s22, 16
    s_add_u32 s47, s47, 24576
    s_waitcnt vmcnt(8)
    buffer_load_dwordx4 v9, s[12:15], s47 offen lds
    s_add_u32 m0, s61, 4096
    s_lshl_b32 s47, s22, 16
    s_add_u32 s47, s47, 32768
    s_waitcnt vmcnt(8)
    buffer_load_dwordx4 v9, s[12:15], s47 offen lds
    s_add_u32 m0, s61, 5120
    s_lshl_b32 s47, s22, 16
    s_add_u32 s47, s47, 40960
    s_waitcnt vmcnt(8)
    buffer_load_dwordx4 v9, s[12:15], s47 offen lds
    s_add_u32 m0, s61, 6144
    s_lshl_b32 s47, s22, 16
    s_add_u32 s47, s47, 49152
    s_waitcnt vmcnt(8)
    buffer_load_dwordx4 v9, s[12:15], s47 offen lds
    s_add_u32 m0, s61, 7168
    s_lshl_b32 s47, s22, 16
    s_add_u32 s47, s47, 57344
    s_waitcnt vmcnt(8)
    buffer_load_dwordx4 v9, s[12:15], s47 offen lds
    s_add_u32 s3, s3, 128
    s_waitcnt vmcnt(8)
    v_mov_b32 v3, s50
    s_mov_b64 exec, 1
    buffer_store_dword v3, v2, s[4:7], s3 offen sc1
    s_mov_b64 exec, -1
    s_branch g_fin2
g_fin1:
    s_and_b32 s47, s52, 3
    s_lshl_b32 s47, s47, 2
    s_add_u32 s47, s47, s101
    s_lshl_b32 s30, s47, 12
    s_mov_b32 s31, 28
g_wl:
    s_waitcnt vmcnt(7)
    buffer_load_dwordx4 v[128:131], v2, s[12:15], s30 offen offset:0
    s_waitcnt vmcnt(7)
    buffer_load_dwordx4 v[128:131], v2, s[12:15], s30 offen offset:1024
    s_waitcnt vmcnt(7)
    buffer_load_dwordx4 v[128:131], v2, s[12:15], s30 offen offset:2048
    s_waitcnt vmcnt(7)
    buffer_load_dwordx4 v[128:131], v2, s[12:15], s30 offen offset:3072
    s_add_u32 s30, s30, 131072
    s_cmp_eq_u32 s31, 15
    s_cselect_b32 s47, 1769472, 0
    s_sub_u32 s30, s30, s47
    s_sub_u32 s31, s31, 1
    s_cmp_lg_u32 s31, 12
    s_cbranch_scc1 g_wl
    s_mov_b32 s49, 1600000
z_lw58:
    ds_read_b32 v17, v7 offset:48
    s_waitcnt lgkmcnt(0)
    v_readfirstlane_b32 s48, v17
    s_nop 1
    s_cmp_ge_u32 s48, 4
    s_cbranch_scc1 z_lwd59
    s_sleep 1
    s_sub_u32 s49, s49, 1
    s_cmp_lg_u32 s49, 0
    s_cbranch_scc1 z_lw58
z_lwd59:
    s_add_u32 m0, s61, 65536
    s_lshl_b32 s47, s20, 16
    s_add_u32 s47, s47, 0
    s_waitcnt vmcnt(7)
    buffer_load_dwordx4 v9, s[12:15], s47 offen lds
    s_add_u32 m0, s61, 66560
    s_lshl_b32 s47, s20, 16
    s_add_u32 s47, s47, 8192
    s_waitcnt vmcnt(7)
    buffer_load_dwordx4 v9, s[12:15], s47 offen lds
    s_add_u32 m0, s61, 67584
    s_lshl_b32 s47, s20, 16
    s_add_u32 s47, s47, 16384
    s_waitcnt vmcnt(7)
    buffer_load_dwordx4 v9, s[12:15], s47 offen lds
    s_add_u32 m0, s61, 68608
    s_lshl_b32 s47, s20, 16
    s_add_u32 s47, s47, 24576
    s_waitcnt vmcnt(7)
    buffer_load_dwordx4 v9, s[12:15], s47 offen lds
    s_add_u32 m0, s61, 69632
    s_lshl_b32 s47, s20, 16
    s_add_u32 s47, s47, 32768
    s_waitcnt vmcnt(7)
    buffer_load_dwordx4 v9, s[12:15], s47 offen lds
    s_add_u32 m0, s61, 70656
    s_lshl_b32 s47, s20, 16
    s_add_u32 s47, s47, 40960
    s_waitcnt vmcnt(7)
    buffer_load_dwordx4 v9, s[12:15], s47 offen lds
    s_add_u32 m0, s61, 71680
    s_lshl_b32 s47, s20, 16
    s_add_u32 s47, s47, 49152
    s_waitcnt vmcnt(7)
    buffer_load_dwordx4 v9, s[12:15], s47 offen lds
    s_add_u32 m0, s61, 72704
    s_lshl_b32 s47, s20, 16
    s_add_u32 s47, s47, 57344
    s_waitcnt vmcnt(7)
    buffer_load_dwordx4 v9, s[12:15], s47 offen lds
    s_add_u32 m0, s61, 73728
    s_lshl_b32 s47, s21, 16
    s_add_u32 s47, s47, 0
    s_waitcnt vmcnt(7)
    buffer_load_dwordx4 v9, s[12:15], s47 offen lds
    s_add_u32 m0, s61, 74752
    s_lshl_b32 s47, s21, 16
    s_add_u32 s47, s47, 8192
    s_waitcnt vmcnt(7)
    buffer_load_dwordx4 v9, s[12:15], s47 offen lds
    s_add_u32 m0, s61, 75776
    s_lshl_b32 s47, s21, 16
    s_add_u32 s47, s47, 16384
    s_waitcnt vmcnt(7)
    buffer_load_dwordx4 v9, s[12:15], s47 offen lds
    s_add_u32 m0, s61, 76800
    s_lshl_b32 s47, s21, 16
    s_add_u32 s47, s47, 24576
    s_waitcnt vmcnt(7)
    buffer_load_dwordx4 v9, s[12:15], s47 offen lds
    s_add_u32 m0, s61, 77824
    s_lshl_b32 s47, s21, 16
    s_add_u32 s47, s47, 32768
    s_waitcnt vmcnt(7)
    buffer_load_dwordx4 v9, s[12:15], s47 offen lds
    s_add_u32 m0, s61, 78848
    s_lshl_b32 s47, s21, 16
    s_add_u32 s47, s47, 40960
    s_waitcnt vmcnt(7)
    buffer_load_dwordx4 v9, s[12:15], s47 offen lds
    s_add_u32 m0, s61, 79872
    s_lshl_b32 s47, s21, 16
    s_add_u32 s47, s47, 49152
    s_waitcnt vmcnt(7)
    buffer_load_dwordx4 v9, s[12:15], s47 offen lds
    s_add_u32 m0, s61, 80896
    s_lshl_b32 s47, s21, 16
    s_add_u32 s47, s47, 57344
    s_waitcnt vmcnt(7)
    buffer_load_dwordx4 v9, s[12:15], s47 offen lds
    s_add_u32 m0, s61, 0
    s_lshl_b32 s47, s22, 16
    s_add_u32 s47, s47, 0
    s_waitcnt vmcnt(7)
    buffer_load_dwordx4 v9, s[12:15], s47 offen lds
    s_add_u32 m0, s61, 1024
    s_lshl_b32 s47, s22, 16
    s_add_u32 s47, s47, 8192
    s_waitcnt vmcnt(7)
    buffer_load_dwordx4 v9, s[12:15], s47 offen lds
    s_add_u32 m0, s61, 2048
    s_lshl_b32 s47, s22, 16
    s_add_u32 s47, s47, 16384
    s_waitcnt vmcnt(7)
    buffer_load_dwordx4 v9, s[12:15], s47 offen lds
    s_add_u32 m0, s61, 3072
    s_lshl_b32 s47, s22, 16
    s_add_u32 s47, s47, 24576
    s_waitcnt vmcnt(7)
    buffer_load_dwordx4 v9, s[12:15], s47 offen lds
    s_add_u32 m0, s61, 4096
    s_lshl_b32 s47, s22, 16
    s_add_u32 s47, s47, 32768
    s_waitcnt vmcnt(7)
    buffer_load_dwordx4 v9, s[12:15], s47 offen lds
    s_add_u32 m0, s61, 5120
    s_lshl_b32 s47, s22, 16
    s_add_u32 s47, s47, 40960
    s_waitcnt vmcnt(7)
    buffer_load_dwordx4 v9, s[12:15], s47 offen lds
    s_add_u32 m0, s61, 6144
    s_lshl_b32 s47, s22, 16
    s_add_u32 s47, s47, 49152
    s_waitcnt vmcnt(7)
    buffer_load_dwordx4 v9, s[12:15], s47 offen lds
    s_add_u32 m0, s61, 7168
    s_lshl_b32 s47, s22, 16
    s_add_u32 s47, s47, 57344
    s_waitcnt vmcnt(7)
    buffer_load_dwordx4 v9, s[12:15], s47 offen lds
    s_waitcnt vmcnt(8)
g_fin2:
    s_mov_b32 s16, s24
    s_mov_b32 s17, s25
    s_mov_b32 s18, 524288
    s_mov_b32 s19, 0x00020000
    s_lshl_b32 s47, s96, 11
    s_add_u32 s47, s47, 18087936
    v_and_b32 v3, 31, v1
    v_lshl_add_u32 v19, v3, 6, s47
    buffer_load_dwordx2 v[28:29], v19, s[4:7], 0 offen sc1
    s_lshl_b32 s48, s57, 13
    s_add_u32 s48, s48, 18612224
    v_bfe_u32 v3, v1, 2, 1
    v_lshlrev_b32 v3, 5, v3
    v_and_b32 v4, 3, v1
    s_sub_u32 s47, s45, 1
    v_min_u32 v5, s47, v4
    v_lshl_add_u32 v5, v5, 1, v3
    v_add_u32 v5, s54, v5
    v_lshl_add_u32 v11, v5, 7, s48
    s_sub_u32 s47, s55, 1
    v_min_u32 v5, s47, v4
    v_lshl_add_u32 v5, v5, 1, v3
    v_add_u32 v5, s46, v5
    v_lshl_add_u32 v13, v5, 7, s48
    s_mul_i32 s49, s57, 229376
    s_add_u32 s49, s49, 10485760
    s_mul_i32 s47, s59, 114688
    s_sub_u32 s48, 114688, s47
    s_add_u32 s47, s47, s49
    s_add_u32 s48, s48, s49
    v_add_u32 v10, s47, v2
    v_add_u32 v12, s48, v2
    s_and_b32 s47, s100, 7
    s_lshl_b32 s47, s47, 14
    s_lshl_b32 s62, s101, 17
    s_xor_b32 s62, s62, s47
    buffer_load_dword v17, v11, s[4:7], 0 offen sc1
    v_xor_b32 v15, 0x10000, v30
    v_xor_b32 v18, 0x10000, v31
    ds_read_b64_tr_b16 v[192:193], v15 offset:0
    ds_read_b64_tr_b16 v[194:195], v15 offset:1024
    ds_read_b64_tr_b16 v[196:197], v18 offset:0
    ds_read_b64_tr_b16 v[198:199], v18 offset:1024
    ds_read_b64_tr_b16 v[200:201], v15 offset:2048
    ds_read_b64_tr_b16 v[202:203], v15 offset:3072
    ds_read_b64_tr_b16 v[204:205], v18 offset:2048
    ds_read_b64_tr_b16 v[206:207], v18 offset:3072
    ds_read_b64_tr_b16 v[208:209], v15 offset:4096
    ds_read_b64_tr_b16 v[210:211], v15 offset:5120
    ds_read_b64_tr_b16 v[212:213], v18 offset:4096
    ds_read_b64_tr_b16 v[214:215], v18 offset:5120
    ds_read_b64_tr_b16 v[216:217], v15 offset:6144
    ds_read_b64_tr_b16 v[218:219], v15 offset:7168
    ds_read_b64_tr_b16 v[220:221], v18 offset:6144
    ds_read_b64_tr_b16 v[222:223], v18 offset:7168
    ds_read_b64_tr_b16 v[224:225], v15 offset:8192
    ds_read_b64_tr_b16 v[226:227], v15 offset:9216
    ds_read_b64_tr_b16 v[228:229], v18 offset:8192
    ds_read_b64_tr_b16 v[230:231], v18 offset:9216
    ds_read_b64_tr_b16 v[232:233], v15 offset:10240
    ds_read_b64_tr_b16 v[234:235], v15 offset:11264
    ds_read_b64_tr_b16 v[236:237], v18 offset:10240
    ds_read_b64_tr_b16 v[238:239], v18 offset:11264
    ds_read_b64_tr_b16 v[240:241], v15 offset:12288
    ds_read_b64_tr_b16 v[242:243], v15 offset:13312
    ds_read_b64_tr_b16 v[244:245], v18 offset:12288
    ds_read_b64_tr_b16 v[246:247], v18 offset:13312
    ds_read_b64_tr_b16 v[248:249], v15 offset:14336
    ds_read_b64_tr_b16 v[250:251], v15 offset:15360
    ds_read_b64_tr_b16 v[252:253], v18 offset:14336
    ds_read_b64_tr_b16 v[254:255], v18 offset:15360
    v_lshlrev_b32 v48, 16, v20
    v_and_b32 v49, 0xffff0000, v20
    v_lshlrev_b32 v50, 16, v21
    v_and_b32 v51, 0xffff0000, v21
    v_lshlrev_b32 v52, 16, v22
    v_and_b32 v53, 0xffff0000, v22
    v_lshlrev_b32 v54, 16, v23
    v_and_b32 v55, 0xffff0000, v23
    v_lshlrev_b32 v56, 16, v24
    v_and_b32 v57, 0xffff0000, v24
    v_lshlrev_b32 v58, 16, v25
    v_and_b32 v59, 0xffff0000, v25
    v_lshlrev_b32 v60, 16, v26
    v_and_b32 v61, 0xffff0000, v26
    v_lshlrev_b32 v62, 16, v27
    v_and_b32 v63, 0xffff0000, v27
    s_mov_b32 s49, 200000
    s_branch z_pchk62
z_poll60:
    buffer_load_dword v17, v11, s[4:7], 0 offen sc1
z_pchk62:
    s_waitcnt vmcnt(0)
    v_cmp_ne_u32 vcc, s50, v17
    s_nop 1
    s_and_b32 vcc_lo, vcc_lo, vcc_lo
    s_cbranch_scc0 z_pdone61
    s_sleep 2
    s_sub_u32 s49, s49, 1
    s_cmp_lg_u32 s49, 0
    s_cbranch_scc1 z_poll60
z_pdone61:
    s_lshl_b32 s63, s20, 12
    s_waitcnt vmcnt(8)
    buffer_load_dwordx4 v[128:131], v10, s[4:7], s63 offen offset:0 sc1
    s_lshl_b32 s63, s20, 12
    s_waitcnt vmcnt(8)
    buffer_load_dwordx4 v[132:135], v12, s[4:7], s63 offen offset:0 sc1
    s_lshl_b32 s63, s20, 12
    s_waitcnt vmcnt(8)
    buffer_load_dwordx4 v[136:139], v10, s[4:7], s63 offen offset:1024 sc1
    s_lshl_b32 s63, s20, 12
    s_waitcnt vmcnt(8)
    buffer_load_dwordx4 v[140:143], v12, s[4:7], s63 offen offset:1024 sc1
    s_lshl_b32 s63, s20, 12
    s_waitcnt vmcnt(8)
    buffer_load_dwordx4 v[144:147], v10, s[4:7], s63 offen offset:2048 sc1
    s_lshl_b32 s63, s20, 12
    s_waitcnt vmcnt(8)
    buffer_load_dwordx4 v[148:151], v12, s[4:7], s63 offen offset:2048 sc1
    s_lshl_b32 s63, s20, 12
    s_waitcnt vmcnt(8)
    buffer_load_dwordx4 v[152:155], v10, s[4:7], s63 offen offset:3072 sc1
    s_lshl_b32 s63, s20, 12
    s_waitcnt vmcnt(8)
    buffer_load_dwordx4 v[156:159], v12, s[4:7], s63 offen offset:3072 sc1
    s_lshl_b32 s63, s21, 12
    s_waitcnt vmcnt(8)
    buffer_load_dwordx4 v[160:163], v10, s[4:7], s63 offen offset:0 sc1
    s_lshl_b32 s63, s21, 12
    s_waitcnt vmcnt(8)
    buffer_load_dwordx4 v[164:167], v12, s[4:7], s63 offen offset:0 sc1
    s_lshl_b32 s63, s21, 12
    s_waitcnt vmcnt(8)
    buffer_load_dwordx4 v[168:171], v10, s[4:7], s63 offen offset:1024 sc1
    s_lshl_b32 s63, s21, 12
    s_waitcnt vmcnt(8)
    buffer_load_dwordx4 v[172:175], v12, s[4:7], s63 offen offset:1024 sc1
    s_lshl_b32 s63, s21, 12
    s_waitcnt vmcnt(8)
    buffer_load_dwordx4 v[176:179], v10, s[4:7], s63 offen offset:2048 sc1
    s_lshl_b32 s63, s21, 12
    s_waitcnt vmcnt(8)
    buffer_load_dwordx4 v[180:183], v12, s[4:7], s63 offen offset:2048 sc1
    s_lshl_b32 s63, s21, 12
    s_waitcnt vmcnt(8)
    buffer_load_dwordx4 v[184:187], v10, s[4:7], s63 offen offset:3072 sc1
    s_lshl_b32 s63, s21, 12
    s_waitcnt vmcnt(8)
    buffer_load_dwordx4 v[188:191], v12, s[4:7], s63 offen offset:3072 sc1
    v_cmp_ne_u32 vcc, s50, v29
    s_nop 1
    s_cmp_eq_u32 vcc_lo, 0
    s_cbranch_scc1 g_gok2
    s_mov_b32 s49, 200000
z_poll63:
    buffer_load_dwordx2 v[28:29], v19, s[4:7], 0 offen sc1
z_pchk65:
    s_waitcnt vmcnt(0)
    v_cmp_ne_u32 vcc, s50, v29
    s_nop 1
    s_and_b32 vcc_lo, vcc_lo, vcc_lo
    s_cbranch_scc0 z_pdone64
    s_sleep 2
    s_sub_u32 s49, s49, 1
    s_cmp_lg_u32 s49, 0
    s_cbranch_scc1 z_poll63
z_pdone64:
g_gok2:
    v_sub_f32 v28, 1.0, v28
    v_mul_f32 v48, v48, v28
    v_mul_f32 v49, v49, v28
    v_mul_f32 v50, v50, v28
    v_mul_f32 v51, v51, v28
    v_mul_f32 v52, v52, v28
    v_mul_f32 v53, v53, v28
    v_mul_f32 v54, v54, v28
    v_mul_f32 v55, v55, v28
    v_mul_f32 v56, v56, v28
    v_mul_f32 v57, v57, v28
    v_mul_f32 v58, v58, v28
    v_mul_f32 v59, v59, v28
    v_mul_f32 v60, v60, v28
    v_mul_f32 v61, v61, v28
    v_mul_f32 v62, v62, v28
    v_mul_f32 v63, v63, v28
    s_setprio 0
    s_waitcnt vmcnt(14) lgkmcnt(0)
    v_mfma_f32_32x32x16_bf16 v[48:63], v[192:195], v[128:131], v[48:63]
    s_add_u32 m0, s61, 8192
    s_lshl_b32 s47, s23, 16
    s_add_u32 s47, s47, 0
    s_waitcnt vmcnt(8)
    buffer_load_dwordx4 v9, s[12:15], s47 offen lds
    v_mfma_f32_32x32x16_bf16 v[64:79], v[196:199], v[128:131], 0
    s_add_u32 m0, s61, 9216
    s_lshl_b32 s47, s23, 16
    s_add_u32 s47, s47, 8192
    s_waitcnt vmcnt(8)
    buffer_load_dwordx4 v9, s[12:15], s47 offen lds
    v_mfma_f32_32x32x16_bf16 v[80:95], v[192:195], v[132:135], 0
    s_add_u32 m0, s61, 10240
    s_lshl_b32 s47, s23, 16
    s_add_u32 s47, s47, 16384
    s_waitcnt vmcnt(8)
    buffer_load_dwordx4 v9, s[12:15], s47 offen lds
    v_mfma_f32_32x32x16_bf16 v[96:111], v[196:199], v[132:135], 0
    s_add_u32 m0, s61, 11264
    s_lshl_b32 s47, s23, 16
    s_add_u32 s47, s47, 24576
    s_waitcnt vmcnt(8)
    buffer_load_dwordx4 v9, s[12:15], s47 offen lds
    s_lshl_b32 s63, s22, 12
    s_waitcnt vmcnt(8)
    buffer_load_dwordx4 v[128:131], v10, s[4:7], s63 offen offset:0 sc1
    s_lshl_b32 s63, s22, 12
    s_waitcnt vmcnt(8)
    buffer_load_dwordx4 v[132:135], v12, s[4:7], s63 offen offset:0 sc1
    s_waitcnt vmcnt(18)
    v_mfma_f32_32x32x16_bf16 v[48:63], v[200:203], v[136:139], v[48:63]
    s_add_u32 m0, s61, 12288
    s_lshl_b32 s47, s23, 16
    s_add_u32 s47, s47, 32768
    s_waitcnt vmcnt(8)
    buffer_load_dwordx4 v9, s[12:15], s47 offen lds
    v_mfma_f32_32x32x16_bf16 v[64:79], v[204:207], v[136:139], v[64:79]
    s_add_u32 m0, s61, 13312
    s_lshl_b32 s47, s23, 16
    s_add_u32 s47, s47, 40960
    s_waitcnt vmcnt(8)
    buffer_load_dwordx4 v9, s[12:15], s47 offen lds
    v_mfma_f32_32x32x16_bf16 v[80:95], v[200:203], v[140:143], v[80:95]
    s_add_u32 m0, s61, 14336
    s_lshl_b32 s47, s23, 16
    s_add_u32 s47, s47, 49152
    s_waitcnt vmcnt(8)
    buffer_load_dwordx4 v9, s[12:15], s47 offen lds
    v_mfma_f32_32x32x16_bf16 v[96:111], v[204:207], v[140:143], v[96:111]
    s_add_u32 m0, s61, 15360
    s_lshl_b32 s47, s23, 16
    s_add_u32 s47, s47, 57344
    s_waitcnt vmcnt(8)
    buffer_load_dwordx4 v9, s[12:15], s47 offen lds
    s_lshl_b32 s63, s22, 12
    s_waitcnt vmcnt(8)
    buffer_load_dwordx4 v[136:139], v10, s[4:7], s63 offen offset:1024 sc1
    s_lshl_b32 s63, s22, 12
    s_waitcnt vmcnt(8)
    buffer_load_dwordx4 v[140:143], v12, s[4:7], s63 offen offset:1024 sc1
    s_waitcnt vmcnt(22)
    v_mfma_f32_32x32x16_bf16 v[48:63], v[208:211], v[144:147], v[48:63]
    s_add_u32 m0, s61, 65536
    s_lshl_b32 s47, s26, 16
    s_add_u32 s47, s47, 0
    s_waitcnt vmcnt(8)
    buffer_load_dwordx4 v9, s[12:15], s47 offen lds
    v_mfma_f32_32x32x16_bf16 v[64:79], v[212:215], v[144:147], v[64:79]
    s_add_u32 m0, s61, 66560
    s_lshl_b32 s47, s26, 16
    s_add_u32 s47, s47, 8192
    s_waitcnt vmcnt(8)
    buffer_load_dwordx4 v9, s[12:15], s47 offen lds
    v_mfma_f32_32x32x16_bf16 v[80:95], v[208:211], v[148:151], v[80:95]
    s_add_u32 m0, s61, 67584
    s_lshl_b32 s47, s26, 16
    s_add_u32 s47, s47, 16384
    s_waitcnt vmcnt(8)
    buffer_load_dwordx4 v9, s[12:15], s47 offen lds
    v_mfma_f32_32x32x16_bf16 v[96:111], v[212:215], v[148:151], v[96:111]
    s_add_u32 m0, s61, 68608
    s_lshl_b32 s47, s26, 16
    s_add_u32 s47, s47, 24576
    s_waitcnt vmcnt(8)
    buffer_load_dwordx4 v9, s[12:15], s47 offen lds
    s_lshl_b32 s63, s22, 12
    s_waitcnt vmcnt(8)
    buffer_load_dwordx4 v[144:147], v10, s[4:7], s63 offen offset:2048 sc1
    s_lshl_b32 s63, s22, 12
    s_waitcnt vmcnt(8)
    buffer_load_dwordx4 v[148:151], v12, s[4:7], s63 offen offset:2048 sc1
    s_waitcnt vmcnt(26)
    v_mfma_f32_32x32x16_bf16 v[48:63], v[216:219], v[152:155], v[48:63]
    s_add_u32 m0, s61, 69632
    s_lshl_b32 s47, s26, 16
    s_add_u32 s47, s47, 32768
    s_waitcnt vmcnt(8)
    buffer_load_dwordx4 v9, s[12:15], s47 offen lds
    v_mfma_f32_32x32x16_bf16 v[64:79], v[220:223], v[152:155], v[64:79]
    s_add_u32 m0, s61, 70656
    s_lshl_b32 s47, s26, 16
    s_add_u32 s47, s47, 40960
    s_waitcnt vmcnt(8)
    buffer_load_dwordx4 v9, s[12:15], s47 offen lds
    v_mfma_f32_32x32x16_bf16 v[80:95], v[216:219], v[156:159], v[80:95]
    s_add_u32 m0, s61, 71680
    s_lshl_b32 s47, s26, 16
    s_add_u32 s47, s47, 49152
    s_waitcnt vmcnt(8)
    buffer_load_dwordx4 v9, s[12:15], s47 offen lds
    v_mfma_f32_32x32x16_bf16 v[96:111], v[220:223], v[156:159], v[96:111]
    s_add_u32 m0, s61, 72704
    s_lshl_b32 s47, s26, 16
    s_add_u32 s47, s47, 57344
    s_waitcnt vmcnt(8)
    buffer_load_dwordx4 v9, s[12:15], s47 offen lds
    s_lshl_b32 s63, s22, 12
    s_waitcnt vmcnt(8)
    buffer_load_dwordx4 v[152:155], v10, s[4:7], s63 offen offset:3072 sc1
    s_lshl_b32 s63, s22, 12
    s_waitcnt vmcnt(8)
    buffer_load_dwordx4 v[156:159], v12, s[4:7], s63 offen offset:3072 sc1
    s_waitcnt vmcnt(30) lgkmcnt(0)
    v_mfma_f32_32x32x16_bf16 v[48:63], v[224:227], v[160:163], v[48:63]
    buffer_load_dword v14, v13, s[4:7], 0 offen sc1
    v_mfma_f32_32x32x16_bf16 v[64:79], v[228:231], v[160:163], v[64:79]
    s_add_u32 m0, s61, 73728
    s_lshl_b32 s47, s27, 16
    s_add_u32 s47, s47, 0
    s_waitcnt vmcnt(8)
    buffer_load_dwordx4 v9, s[12:15], s47 offen lds
    v_mfma_f32_32x32x16_bf16 v[80:95], v[224:227], v[164:167], v[80:95]
    s_add_u32 m0, s61, 74752
    s_lshl_b32 s47, s27, 16
    s_add_u32 s47, s47, 8192
    s_waitcnt vmcnt(8)
    buffer_load_dwordx4 v9, s[12:15], s47 offen lds
    v_mfma_f32_32x32x16_bf16 v[96:111], v[228:231], v[164:167], v[96:111]
    s_add_u32 m0, s61, 75776
    s_lshl_b32 s47, s27, 16
    s_add_u32 s47, s47, 16384
    s_waitcnt vmcnt(8)
    buffer_load_dwordx4 v9, s[12:15], s47 offen lds
    s_waitcnt vmcnt(32)
    v_mfma_f32_32x32x16_bf16 v[48:63], v[232:235], v[168:171], v[48:63]
    s_add_u32 m0, s61, 76800
    s_lshl_b32 s47, s27, 16
    s_add_u32 s47, s47, 24576
    s_waitcnt vmcnt(8)
    buffer_load_dwordx4 v9, s[12:15], s47 offen lds
    v_mfma_f32_32x32x16_bf16 v[64:79], v[236:239], v[168:171], v[64:79]
    s_add_u32 m0, s61, 77824
    s_lshl_b32 s47, s27, 16
    s_add_u32 s47, s47, 32768
    s_waitcnt vmcnt(8)
    buffer_load_dwordx4 v9, s[12:15], s47 offen lds
    v_mfma_f32_32x32x16_bf16 v[80:95], v[232:235], v[172:175], v[80:95]
    s_add_u32 m0, s61, 78848
    s_lshl_b32 s47, s27, 16
    s_add_u32 s47, s47, 40960
    s_waitcnt vmcnt(8)
    buffer_load_dwordx4 v9, s[12:15], s47 offen lds
    v_mfma_f32_32x32x16_bf16 v[96:111], v[236:239], v[172:175], v[96:111]
    s_add_u32 m0, s61, 79872
    s_lshl_b32 s47, s27, 16
    s_add_u32 s47, s47, 49152
    s_waitcnt vmcnt(8)
    buffer_load_dwordx4 v9, s[12:15], s47 offen lds
    s_waitcnt vmcnt(34)
    v_mfma_f32_32x32x16_bf16 v[48:63], v[240:243], v[176:179], v[48:63]
    s_add_u32 m0, s61, 80896
    s_lshl_b32 s47, s27, 16
    s_add_u32 s47, s47, 57344
    s_waitcnt vmcnt(8)
    buffer_load_dwordx4 v9, s[12:15], s47 offen lds
    v_mfma_f32_32x32x16_bf16 v[64:79], v[244:247], v[176:179], v[64:79]
    v_mfma_f32_32x32x16_bf16 v[80:95], v[240:243], v[180:183], v[80:95]
    v_mfma_f32_32x32x16_bf16 v[96:111], v[244:247], v[180:183], v[96:111]
    s_waitcnt vmcnt(33)
    v_mfma_f32_32x32x16_bf16 v[48:63], v[248:251], v[184:187], v[48:63]
    v_mfma_f32_32x32x16_bf16 v[64:79], v[252:255], v[184:187], v[64:79]
    v_mfma_f32_32x32x16_bf16 v[80:95], v[248:251], v[188:191], v[80:95]
    v_mfma_f32_32x32x16_bf16 v[96:111], v[252:255], v[188:191], v[96:111]
    s_waitcnt vmcnt(8)
    v_cmp_ne_u32 vcc, s50, v14
    s_mov_b32 s97, 0
    s_nop 0
    s_cmp_lg_u32 vcc_lo, 0
    s_cbranch_scc1 g_onot
    s_lshl_b32 s63, s23, 12
    s_waitcnt vmcnt(8)
    buffer_load_dwordx4 v[160:163], v10, s[4:7], s63 offen offset:0 sc1
    s_lshl_b32 s63, s23, 12
    s_waitcnt vmcnt(8)
    buffer_load_dwordx4 v[164:167], v12, s[4:7], s63 offen offset:0 sc1
    s_lshl_b32 s63, s23, 12
    s_waitcnt vmcnt(8)
    buffer_load_dwordx4 v[168:171], v10, s[4:7], s63 offen offset:1024 sc1
    s_lshl_b32 s63, s23, 12
    s_waitcnt vmcnt(8)
    buffer_load_dwordx4 v[172:175], v12, s[4:7], s63 offen offset:1024 sc1
    s_lshl_b32 s63, s23, 12
    s_waitcnt vmcnt(8)
    buffer_load_dwordx4 v[176:179], v10, s[4:7], s63 offen offset:2048 sc1
    s_lshl_b32 s63, s23, 12
    s_waitcnt vmcnt(8)
    buffer_load_dwordx4 v[180:183], v12, s[4:7], s63 offen offset:2048 sc1
    s_lshl_b32 s63, s23, 12
    s_waitcnt vmcnt(8)
    buffer_load_dwordx4 v[184:187], v10, s[4:7], s63 offen offset:3072 sc1
    s_lshl_b32 s63, s23, 12
    s_waitcnt vmcnt(8)
    buffer_load_dwordx4 v[188:191], v12, s[4:7], s63 offen offset:3072 sc1
    s_mov_b32 s97, 1
g_onot:
    ds_read_b64_tr_b16 v[192:193], v30 offset:8192
    ds_read_b64_tr_b16 v[194:195], v30 offset:9216
    ds_read_b64_tr_b16 v[196:197], v31 offset:8192
    ds_read_b64_tr_b16 v[198:199], v31 offset:9216
    ds_read_b64_tr_b16 v[200:201], v30 offset:10240
    ds_read_b64_tr_b16 v[202:203], v30 offset:11264
    ds_read_b64_tr_b16 v[204:205], v31 offset:10240
    ds_read_b64_tr_b16 v[206:207], v31 offset:11264
    ds_read_b64_tr_b16 v[208:209], v30 offset:12288
    ds_read_b64_tr_b16 v[210:211], v30 offset:13312
    ds_read_b64_tr_b16 v[212:213], v31 offset:12288
    ds_read_b64_tr_b16 v[214:215], v31 offset:13312
    ds_read_b64_tr_b16 v[216:217], v30 offset:14336
    ds_read_b64_tr_b16 v[218:219], v30 offset:15360
    ds_read_b64_tr_b16 v[220:221], v31 offset:14336
    ds_read_b64_tr_b16 v[222:223], v31 offset:15360
    ds_read_b64_tr_b16 v[224:225], v15 offset:0
    ds_read_b64_tr_b16 v[226:227], v15 offset:1024
    ds_read_b64_tr_b16 v[228:229], v18 offset:0
    ds_read_b64_tr_b16 v[230:231], v18 offset:1024
    ds_read_b64_tr_b16 v[232:233], v15 offset:2048
    ds_read_b64_tr_b16 v[234:235], v15 offset:3072
    ds_read_b64_tr_b16 v[236:237], v18 offset:2048
    ds_read_b64_tr_b16 v[238:239], v18 offset:3072
    ds_read_b64_tr_b16 v[240:241], v15 offset:4096
    ds_read_b64_tr_b16 v[242:243], v15 offset:5120
    ds_read_b64_tr_b16 v[244:245], v18 offset:4096
    ds_read_b64_tr_b16 v[246:247], v18 offset:5120
    ds_read_b64_tr_b16 v[248:249], v15 offset:6144
    ds_read_b64_tr_b16 v[250:251], v15 offset:7168
    ds_read_b64_tr_b16 v[252:253], v18 offset:6144
    ds_read_b64_tr_b16 v[254:255], v18 offset:7168
    s_waitcnt lgkmcnt(0)
    ds_read_b64_tr_b16 v[112:113], v30 offset:0
    ds_read_b64_tr_b16 v[114:115], v30 offset:1024
    ds_read_b64_tr_b16 v[116:117], v31 offset:0
    ds_read_b64_tr_b16 v[118:119], v31 offset:1024
    s_waitcnt vmcnt(27) lgkmcnt(0)
    ds_read_b64_tr_b16 v[120:121], v30 offset:2048
    ds_read_b64_tr_b16 v[122:123], v30 offset:3072
    ds_read_b64_tr_b16 v[124:125], v31 offset:2048
    ds_read_b64_tr_b16 v[126:127], v31 offset:3072
    v_mfma_f32_32x32x16_bf16 v[48:63], v[112:115], v[128:131], v[48:63]
    s_add_u32 m0, s61, 8192
    s_xor_b32 s47, s62, 0
    s_waitcnt vmcnt(8)
    buffer_load_dwordx4 v9, s[16:19], s47 offen lds
    v_mfma_f32_32x32x16_bf16 v[64:79], v[116:119], v[128:131], v[64:79]
    s_add_u32 m0, s61, 9216
    s_xor_b32 s47, s62, 8192
    s_waitcnt vmcnt(8)
    buffer_load_dwordx4 v9, s[16:19], s47 offen lds
    v_mfma_f32_32x32x16_bf16 v[80:95], v[112:115], v[132:135], v[80:95]
    s_add_u32 m0, s61, 10240
    s_xor_b32 s47, s62, 16384
    s_waitcnt vmcnt(8)
    buffer_load_dwordx4 v9, s[16:19], s47 offen lds
    v_mfma_f32_32x32x16_bf16 v[96:111], v[116:119], v[132:135], v[96:111]
    s_add_u32 m0, s61, 11264
    s_xor_b32 s47, s62, 24576
    s_waitcnt vmcnt(8)
    buffer_load_dwordx4 v9, s[16:19], s47 offen lds
    s_waitcnt vmcnt(25) lgkmcnt(0)
    ds_read_b64_tr_b16 v[112:113], v30 offset:4096
    ds_read_b64_tr_b16 v[114:115], v30 offset:5120
    ds_read_b64_tr_b16 v[116:117], v31 offset:4096
    ds_read_b64_tr_b16 v[118:119], v31 offset:5120
    v_mfma_f32_32x32x16_bf16 v[48:63], v[120:123], v[136:139], v[48:63]
    s_add_u32 m0, s61, 12288
    s_xor_b32 s47, s62, 32768
    s_waitcnt vmcnt(8)
    buffer_load_dwordx4 v9, s[16:19], s47 offen lds
    v_mfma_f32_32x32x16_bf16 v[64:79], v[124:127], v[136:139], v[64:79]
    s_add_u32 m0, s61, 13312
    s_xor_b32 s47, s62, 40960
    s_waitcnt vmcnt(8)
    buffer_load_dwordx4 v9, s[16:19], s47 offen lds
    v_mfma_f32_32x32x16_bf16 v[80:95], v[120:123], v[140:143], v[80:95]
    s_add_u32 m0, s61, 14336
    s_xor_b32 s47, s62, 49152
    s_waitcnt vmcnt(8)
    buffer_load_dwordx4 v9, s[16:19], s47 offen lds
    v_mfma_f32_32x32x16_bf16 v[96:111], v[124:127], v[140:143], v[96:111]
    s_add_u32 m0, s61, 15360
    s_xor_b32 s47, s62, 57344
    s_waitcnt vmcnt(8)
    buffer_load_dwordx4 v9, s[16:19], s47 offen lds
    s_waitcnt vmcnt(23) lgkmcnt(0)
    ds_read_b64_tr_b16 v[120:121], v30 offset:6144
    ds_read_b64_tr_b16 v[122:123], v30 offset:7168
    ds_read_b64_tr_b16 v[124:125], v31 offset:6144
    ds_read_b64_tr_b16 v[126:127], v31 offset:7168
    v_mfma_f32_32x32x16_bf16 v[48:63], v[112:115], v[144:147], v[48:63]
    s_add_u32 m0, s61, 65536
    s_xor_b32 s47, s62, 65536
    s_waitcnt vmcnt(8)
    buffer_load_dwordx4 v9, s[16:19], s47 offen lds
    v_mfma_f32_32x32x16_bf16 v[64:79], v[116:119], v[144:147], v[64:79]
    s_add_u32 m0, s61, 66560
    s_xor_b32 s47, s62, 73728
    s_waitcnt vmcnt(8)
    buffer_load_dwordx4 v9, s[16:19], s47 offen lds
    v_mfma_f32_32x32x16_bf16 v[80:95], v[112:115], v[148:151], v[80:95]
    s_add_u32 m0, s61, 67584
    s_xor_b32 s47, s62, 81920
    s_waitcnt vmcnt(8)
    buffer_load_dwordx4 v9, s[16:19], s47 offen lds
    v_mfma_f32_32x32x16_bf16 v[96:111], v[116:119], v[148:151], v[96:111]
    s_add_u32 m0, s61, 68608
    s_xor_b32 s47, s62, 90112
    s_waitcnt vmcnt(8)
    buffer_load_dwordx4 v9, s[16:19], s47 offen lds
    s_waitcnt vmcnt(21) lgkmcnt(0)
    v_mfma_f32_32x32x16_bf16 v[48:63], v[120:123], v[152:155], v[48:63]
    s_add_u32 m0, s61, 69632
    s_xor_b32 s47, s62, 98304
    s_waitcnt vmcnt(8)
    buffer_load_dwordx4 v9, s[16:19], s47 offen lds
    v_mfma_f32_32x32x16_bf16 v[64:79], v[124:127], v[152:155], v[64:79]
    s_add_u32 m0, s61, 70656
    s_xor_b32 s47, s62, 106496
    s_waitcnt vmcnt(8)
    buffer_load_dwordx4 v9, s[16:19], s47 offen lds
    v_mfma_f32_32x32x16_bf16 v[80:95], v[120:123], v[156:159], v[80:95]
    s_add_u32 m0, s61, 71680
    s_xor_b32 s47, s62, 114688
    s_waitcnt vmcnt(8)
    buffer_load_dwordx4 v9, s[16:19], s47 offen lds
    v_mfma_f32_32x32x16_bf16 v[96:111], v[124:127], v[156:159], v[96:111]
    s_add_u32 m0, s61, 72704
    s_xor_b32 s47, s62, 122880
    s_waitcnt vmcnt(8)
    buffer_load_dwordx4 v9, s[16:19], s47 offen lds
    s_add_u32 m0, s61, 0
    s_lshl_b32 s47, s28, 16
    s_add_u32 s47, s47, 0
    s_waitcnt vmcnt(8)
    buffer_load_dwordx4 v9, s[12:15], s47 offen lds
    s_add_u32 m0, s61, 1024
    s_lshl_b32 s47, s28, 16
    s_add_u32 s47, s47, 8192
    s_waitcnt vmcnt(8)
    buffer_load_dwordx4 v9, s[12:15], s47 offen lds
    s_add_u32 m0, s61, 2048
    s_lshl_b32 s47, s28, 16
    s_add_u32 s47, s47, 16384
    s_waitcnt vmcnt(8)
    buffer_load_dwordx4 v9, s[12:15], s47 offen lds
    s_add_u32 m0, s61, 3072
    s_lshl_b32 s47, s28, 16
    s_add_u32 s47, s47, 24576
    s_waitcnt vmcnt(8)
    buffer_load_dwordx4 v9, s[12:15], s47 offen lds
    s_add_u32 m0, s61, 4096
    s_lshl_b32 s47, s28, 16
    s_add_u32 s47, s47, 32768
    s_waitcnt vmcnt(8)
    buffer_load_dwordx4 v9, s[12:15], s47 offen lds
    s_add_u32 m0, s61, 5120
    s_lshl_b32 s47, s28, 16
    s_add_u32 s47, s47, 40960
    s_waitcnt vmcnt(8)
    buffer_load_dwordx4 v9, s[12:15], s47 offen lds
    s_add_u32 m0, s61, 6144
    s_lshl_b32 s47, s28, 16
    s_add_u32 s47, s47, 49152
    s_waitcnt vmcnt(8)
    buffer_load_dwordx4 v9, s[12:15], s47 offen lds
    s_add_u32 m0, s61, 7168
    s_lshl_b32 s47, s28, 16
    s_add_u32 s47, s47, 57344
    s_waitcnt vmcnt(8)
    buffer_load_dwordx4 v9, s[12:15], s47 offen lds
    s_cmp_lg_u32 s97, 0
    s_cbranch_scc1 g_ook
    s_mov_b32 s49, 200000
z_poll66:
    buffer_load_dword v14, v13, s[4:7], 0 offen sc1
z_pchk68:
    s_waitcnt vmcnt(0)
    v_cmp_ne_u32 vcc, s50, v14
    s_nop 1
    s_and_b32 vcc_lo, vcc_lo, vcc_lo
    s_cbranch_scc0 z_pdone67
    s_sleep 2
    s_sub_u32 s49, s49, 1
    s_cmp_lg_u32 s49, 0
    s_cbranch_scc1 z_poll66
z_pdone67:
    s_lshl_b32 s63, s23, 12
    s_waitcnt vmcnt(8)
    buffer_load_dwordx4 v[160:163], v10, s[4:7], s63 offen offset:0 sc1
    s_lshl_b32 s63, s23, 12
    s_waitcnt vmcnt(8)
    buffer_load_dwordx4 v[164:167], v12, s[4:7], s63 offen offset:0 sc1
    s_lshl_b32 s63, s23, 12
    s_waitcnt vmcnt(8)
    buffer_load_dwordx4 v[168:171], v10, s[4:7], s63 offen offset:1024 sc1
    s_lshl_b32 s63, s23, 12
    s_waitcnt vmcnt(8)
    buffer_load_dwordx4 v[172:175], v12, s[4:7], s63 offen offset:1024 sc1
    s_lshl_b32 s63, s23, 12
    s_waitcnt vmcnt(8)
    buffer_load_dwordx4 v[176:179], v10, s[4:7], s63 offen offset:2048 sc1
    s_lshl_b32 s63, s23, 12
    s_waitcnt vmcnt(8)
    buffer_load_dwordx4 v[180:183], v12, s[4:7], s63 offen offset:2048 sc1
    s_lshl_b32 s63, s23, 12
    s_waitcnt vmcnt(8)
    buffer_load_dwordx4 v[184:187], v10, s[4:7], s63 offen offset:3072 sc1
    s_lshl_b32 s63, s23, 12
    s_waitcnt vmcnt(8)
    buffer_load_dwordx4 v[188:191], v12, s[4:7], s63 offen offset:3072 sc1
g_ook:
    s_lshl_b32 s63, s26, 12
    s_waitcnt vmcnt(8)
    buffer_load_dwordx4 v[128:131], v10, s[4:7], s63 offen offset:0 sc1
    s_lshl_b32 s63, s26, 12
    s_waitcnt vmcnt(8)
    buffer_load_dwordx4 v[132:135], v12, s[4:7], s63 offen offset:0 sc1
    s_lshl_b32 s63, s26, 12
    s_waitcnt vmcnt(8)
    buffer_load_dwordx4 v[136:139], v10, s[4:7], s63 offen offset:1024 sc1
    s_lshl_b32 s63, s26, 12
    s_waitcnt vmcnt(8)
    buffer_load_dwordx4 v[140:143], v12, s[4:7], s63 offen offset:1024 sc1
    s_lshl_b32 s63, s26, 12
    s_waitcnt vmcnt(8)
    buffer_load_dwordx4 v[144:147], v10, s[4:7], s63 offen offset:2048 sc1
    s_lshl_b32 s63, s26, 12
    s_waitcnt vmcnt(8)
    buffer_load_dwordx4 v[148:151], v12, s[4:7], s63 offen offset:2048 sc1
    s_lshl_b32 s63, s26, 12
    s_waitcnt vmcnt(8)
    buffer_load_dwordx4 v[152:155], v10, s[4:7], s63 offen offset:3072 sc1
    s_lshl_b32 s63, s26, 12
    s_waitcnt vmcnt(8)
    buffer_load_dwordx4 v[156:159], v12, s[4:7], s63 offen offset:3072 sc1
    s_waitcnt vmcnt(14) lgkmcnt(0)
    v_mfma_f32_32x32x16_bf16 v[48:63], v[192:195], v[160:163], v[48:63]
    v_mfma_f32_32x32x16_bf16 v[64:79], v[196:199], v[160:163], v[64:79]
    v_mfma_f32_32x32x16_bf16 v[80:95], v[192:195], v[164:167], v[80:95]
    v_mfma_f32_32x32x16_bf16 v[96:111], v[196:199], v[164:167], v[96:111]
    s_lshl_b32 s63, s27, 12
    s_waitcnt vmcnt(8)
    buffer_load_dwordx4 v[160:163], v10, s[4:7], s63 offen offset:0 sc1
    s_lshl_b32 s63, s27, 12
    s_waitcnt vmcnt(8)
    buffer_load_dwordx4 v[164:167], v12, s[4:7], s63 offen offset:0 sc1
    s_waitcnt vmcnt(14)
    v_mfma_f32_32x32x16_bf16 v[48:63], v[200:203], v[168:171], v[48:63]
    v_mfma_f32_32x32x16_bf16 v[64:79], v[204:207], v[168:171], v[64:79]
    v_mfma_f32_32x32x16_bf16 v[80:95], v[200:203], v[172:175], v[80:95]
    v_mfma_f32_32x32x16_bf16 v[96:111], v[204:207], v[172:175], v[96:111]
    s_lshl_b32 s63, s27, 12
    s_waitcnt vmcnt(8)
    buffer_load_dwordx4 v[168:171], v10, s[4:7], s63 offen offset:1024 sc1
    s_lshl_b32 s63, s27, 12
    s_waitcnt vmcnt(8)
    buffer_load_dwordx4 v[172:175], v12, s[4:7], s63 offen offset:1024 sc1
    s_waitcnt vmcnt(14)
    v_mfma_f32_32x32x16_bf16 v[48:63], v[208:211], v[176:179], v[48:63]
    v_mfma_f32_32x32x16_bf16 v[64:79], v[212:215], v[176:179], v[64:79]
    v_mfma_f32_32x32x16_bf16 v[80:95], v[208:211], v[180:183], v[80:95]
    v_mfma_f32_32x32x16_bf16 v[96:111], v[212:215], v[180:183], v[96:111]
    s_lshl_b32 s63, s27, 12
    s_waitcnt vmcnt(8)
    buffer_load_dwordx4 v[176:179], v10, s[4:7], s63 offen offset:2048 sc1
    s_lshl_b32 s63, s27, 12
    s_waitcnt vmcnt(8)
    buffer_load_dwordx4 v[180:183], v12, s[4:7], s63 offen offset:2048 sc1
    s_waitcnt vmcnt(14)
    v_mfma_f32_32x32x16_bf16 v[48:63], v[216:219], v[184:187], v[48:63]
    v_mfma_f32_32x32x16_bf16 v[64:79], v[220:223], v[184:187], v[64:79]
    v_mfma_f32_32x32x16_bf16 v[80:95], v[216:219], v[188:191], v[80:95]
    v_mfma_f32_32x32x16_bf16 v[96:111], v[220:223], v[188:191], v[96:111]
    s_lshl_b32 s63, s27, 12
    s_waitcnt vmcnt(8)
    buffer_load_dwordx4 v[184:187], v10, s[4:7], s63 offen offset:3072 sc1
    s_lshl_b32 s63, s27, 12
    s_waitcnt vmcnt(8)
    buffer_load_dwordx4 v[188:191], v12, s[4:7], s63 offen offset:3072 sc1
    s_waitcnt vmcnt(14) lgkmcnt(0)
    v_mfma_f32_32x32x16_bf16 v[48:63], v[224:227], v[128:131], v[48:63]
    v_mfma_f32_32x32x16_bf16 v[64:79], v[228:231], v[128:131], v[64:79]
    v_mfma_f32_32x32x16_bf16 v[80:95], v[224:227], v[132:135], v[80:95]
    v_mfma_f32_32x32x16_bf16 v[96:111], v[228:231], v[132:135], v[96:111]
    s_lshl_b32 s63, s28, 12
    s_waitcnt vmcnt(8)
    buffer_load_dwordx4 v[128:131], v10, s[4:7], s63 offen offset:0 sc1
    s_lshl_b32 s63, s28, 12
    s_waitcnt vmcnt(8)
    buffer_load_dwordx4 v[132:135], v12, s[4:7], s63 offen offset:0 sc1
    s_waitcnt vmcnt(14)
    v_mfma_f32_32x32x16_bf16 v[48:63], v[232:235], v[136:139], v[48:63]
    v_mfma_f32_32x32x16_bf16 v[64:79], v[236:239], v[136:139], v[64:79]
    v_mfma_f32_32x32x16_bf16 v[80:95], v[232:235], v[140:143], v[80:95]
    v_mfma_f32_32x32x16_bf16 v[96:111], v[236:239], v[140:143], v[96:111]
    s_lshl_b32 s63, s28, 12
    s_waitcnt vmcnt(8)
    buffer_load_dwordx4 v[136:139], v10, s[4:7], s63 offen offset:1024 sc1
    s_lshl_b32 s63, s28, 12
    s_waitcnt vmcnt(8)
    buffer_load_dwordx4 v[140:143], v12, s[4:7], s63 offen offset:1024 sc1
    s_waitcnt vmcnt(14)
    v_mfma_f32_32x32x16_bf16 v[48:63], v[240:243], v[144:147], v[48:63]
    v_mfma_f32_32x32x16_bf16 v[64:79], v[244:247], v[144:147], v[64:79]
    v_mfma_f32_32x32x16_bf16 v[80:95], v[240:243], v[148:151], v[80:95]
    v_mfma_f32_32x32x16_bf16 v[96:111], v[244:247], v[148:151], v[96:111]
    s_lshl_b32 s63, s28, 12
    s_waitcnt vmcnt(8)
    buffer_load_dwordx4 v[144:147], v10, s[4:7], s63 offen offset:2048 sc1
    s_lshl_b32 s63, s28, 12
    s_waitcnt vmcnt(8)
    buffer_load_dwordx4 v[148:151], v12, s[4:7], s63 offen offset:2048 sc1
    s_waitcnt vmcnt(14)
    v_mfma_f32_32x32x16_bf16 v[48:63], v[248:251], v[152:155], v[48:63]
    v_mfma_f32_32x32x16_bf16 v[64:79], v[252:255], v[152:155], v[64:79]
    v_mfma_f32_32x32x16_bf16 v[80:95], v[248:251], v[156:159], v[80:95]
    v_mfma_f32_32x32x16_bf16 v[96:111], v[252:255], v[156:159], v[96:111]
    s_lshl_b32 s63, s28, 12
    s_waitcnt vmcnt(8)
    buffer_load_dwordx4 v[152:155], v10, s[4:7], s63 offen offset:3072 sc1
    s_lshl_b32 s63, s28, 12
    s_waitcnt vmcnt(8)
    buffer_load_dwordx4 v[156:159], v12, s[4:7], s63 offen offset:3072 sc1
    s_waitcnt vmcnt(56)
    ds_read_b64_tr_b16 v[112:113], v15 offset:8192
    ds_read_b64_tr_b16 v[114:115], v15 offset:9216
    ds_read_b64_tr_b16 v[116:117], v18 offset:8192
    ds_read_b64_tr_b16 v[118:119], v18 offset:9216
    s_waitcnt vmcnt(14) lgkmcnt(0)
    ds_read_b64_tr_b16 v[120:121], v15 offset:10240
    ds_read_b64_tr_b16 v[122:123], v15 offset:11264
    ds_read_b64_tr_b16 v[124:125], v18 offset:10240
    ds_read_b64_tr_b16 v[126:127], v18 offset:11264
    v_mfma_f32_32x32x16_bf16 v[48:63], v[112:115], v[160:163], v[48:63]
    v_mfma_f32_32x32x16_bf16 v[64:79], v[116:119], v[160:163], v[64:79]
    v_mfma_f32_32x32x16_bf16 v[80:95], v[112:115], v[164:167], v[80:95]
    v_mfma_f32_32x32x16_bf16 v[96:111], v[116:119], v[164:167], v[96:111]
    s_waitcnt vmcnt(12) lgkmcnt(0)
    ds_read_b64_tr_b16 v[112:113], v15 offset:12288
    ds_read_b64_tr_b16 v[114:115], v15 offset:13312
    ds_read_b64_tr_b16 v[116:117], v18 offset:12288
    ds_read_b64_tr_b16 v[118:119], v18 offset:13312
    v_mfma_f32_32x32x16_bf16 v[48:63], v[120:123], v[168:171], v[48:63]
    v_mfma_f32_32x32x16_bf16 v[64:79], v[124:127], v[168:171], v[64:79]
    v_mfma_f32_32x32x16_bf16 v[80:95], v[120:123], v[172:175], v[80:95]
    v_mfma_f32_32x32x16_bf16 v[96:111], v[124:127], v[172:175], v[96:111]
    s_waitcnt vmcnt(10) lgkmcnt(0)
    ds_read_b64_tr_b16 v[120:121], v15 offset:14336
    ds_read_b64_tr_b16 v[122:123], v15 offset:15360
    ds_read_b64_tr_b16 v[124:125], v18 offset:14336
    ds_read_b64_tr_b16 v[126:127], v18 offset:15360
    v_mfma_f32_32x32x16_bf16 v[48:63], v[112:115], v[176:179], v[48:63]
    v_mfma_f32_32x32x16_bf16 v[64:79], v[116:119], v[176:179], v[64:79]
    v_mfma_f32_32x32x16_bf16 v[80:95], v[112:115], v[180:183], v[80:95]
    v_mfma_f32_32x32x16_bf16 v[96:111], v[116:119], v[180:183], v[96:111]
    s_waitcnt vmcnt(8) lgkmcnt(0)
    v_mfma_f32_32x32x16_bf16 v[48:63], v[120:123], v[184:187], v[48:63]
    v_mfma_f32_32x32x16_bf16 v[64:79], v[124:127], v[184:187], v[64:79]
    v_mfma_f32_32x32x16_bf16 v[80:95], v[120:123], v[188:191], v[80:95]
    v_mfma_f32_32x32x16_bf16 v[96:111], v[124:127], v[188:191], v[96:111]
    s_waitcnt vmcnt(32)
    ds_read_b64_tr_b16 v[112:113], v30 offset:0
    ds_read_b64_tr_b16 v[114:115], v30 offset:1024
    ds_read_b64_tr_b16 v[116:117], v31 offset:0
    ds_read_b64_tr_b16 v[118:119], v31 offset:1024
    s_waitcnt vmcnt(6) lgkmcnt(0)
    ds_read_b64_tr_b16 v[120:121], v30 offset:2048
    ds_read_b64_tr_b16 v[122:123], v30 offset:3072
    ds_read_b64_tr_b16 v[124:125], v31 offset:2048
    ds_read_b64_tr_b16 v[126:127], v31 offset:3072
    v_mfma_f32_32x32x16_bf16 v[48:63], v[112:115], v[128:131], v[48:63]
    v_mfma_f32_32x32x16_bf16 v[64:79], v[116:119], v[128:131], v[64:79]
    v_mfma_f32_32x32x16_bf16 v[80:95], v[112:115], v[132:135], v[80:95]
    v_mfma_f32_32x32x16_bf16 v[96:111], v[116:119], v[132:135], v[96:111]
    s_waitcnt vmcnt(4) lgkmcnt(0)
    ds_read_b64_tr_b16 v[112:113], v30 offset:4096
    ds_read_b64_tr_b16 v[114:115], v30 offset:5120
    ds_read_b64_tr_b16 v[116:117], v31 offset:4096
    ds_read_b64_tr_b16 v[118:119], v31 offset:5120
    v_mfma_f32_32x32x16_bf16 v[48:63], v[120:123], v[136:139], v[48:63]
    v_mfma_f32_32x32x16_bf16 v[64:79], v[124:127], v[136:139], v[64:79]
    v_mfma_f32_32x32x16_bf16 v[80:95], v[120:123], v[140:143], v[80:95]
    v_mfma_f32_32x32x16_bf16 v[96:111], v[124:127], v[140:143], v[96:111]
    s_waitcnt vmcnt(2) lgkmcnt(0)
    ds_read_b64_tr_b16 v[120:121], v30 offset:6144
    ds_read_b64_tr_b16 v[122:123], v30 offset:7168
    ds_read_b64_tr_b16 v[124:125], v31 offset:6144
    ds_read_b64_tr_b16 v[126:127], v31 offset:7168
    v_mfma_f32_32x32x16_bf16 v[48:63], v[112:115], v[144:147], v[48:63]
    v_mfma_f32_32x32x16_bf16 v[64:79], v[116:119], v[144:147], v[64:79]
    v_mfma_f32_32x32x16_bf16 v[80:95], v[112:115], v[148:151], v[80:95]
    v_mfma_f32_32x32x16_bf16 v[96:111], v[116:119], v[148:151], v[96:111]
    s_waitcnt vmcnt(0) lgkmcnt(0)
    v_mfma_f32_32x32x16_bf16 v[48:63], v[120:123], v[152:155], v[48:63]
    v_mfma_f32_32x32x16_bf16 v[64:79], v[124:127], v[152:155], v[64:79]
    v_mfma_f32_32x32x16_bf16 v[80:95], v[120:123], v[156:159], v[80:95]
    v_mfma_f32_32x32x16_bf16 v[96:111], v[124:127], v[156:159], v[96:111]
    s_setprio 3
g_tail:
    s_lshl_b32 s47, s57, 5
    s_lshl_b32 s48, s60, 4
    s_add_u32 s47, s47, s48
    s_lshl_b32 s47, s47, 7
    s_add_u32 s47, s47, 18874368
    v_and_b32 v5, 15, v1
    v_lshl_add_u32 v11, v5, 7, s47
    buffer_load_dword v14, v11, s[4:7], 0 offen sc1
    v_add_u32 v3, s61, v2
    v_add_u32 v4, 0x10000, v3
    v_xor_b32 v5, 16384, v4
    s_add_u32 s62, s53, 8388608
    s_mov_b32 s8, s38
    s_mov_b32 s9, s39
    s_mov_b32 s10, 2097152
    s_mov_b32 s11, 0x00020000
    ds_write_b128 v4, v[80:83] offset:8192
    ds_write_b128 v4, v[84:87] offset:9216
    ds_write_b128 v4, v[88:91] offset:10240
    ds_write_b128 v4, v[92:95] offset:11264
    ds_write_b128 v4, v[96:99] offset:12288
    ds_write_b128 v4, v[100:103] offset:13312
    ds_write_b128 v4, v[104:107] offset:14336
    ds_write_b128 v4, v[108:111] offset:15360
    s_waitcnt vmcnt(0) lgkmcnt(0)
    s_mov_b64 exec, 1
    ds_add_u32 v7, v8 offset:16
    s_mov_b64 exec, -1
    v_cmp_ne_u32 vcc, s50, v14
    s_mov_b32 s97, 0
    s_nop 0
    s_cmp_lg_u32 vcc_lo, 0
    s_cbranch_scc1 g_notyet
    s_xor_b32 s48, s62, 0
    buffer_load_dwordx4 v[128:131], v2, s[4:7], s48 offen sc1
    s_xor_b32 s48, s62, 1024
    buffer_load_dwordx4 v[132:135], v2, s[4:7], s48 offen sc1
    s_xor_b32 s48, s62, 2048
    buffer_load_dwordx4 v[136:139], v2, s[4:7], s48 offen sc1
    s_xor_b32 s48, s62, 3072
    buffer_load_dwordx4 v[140:143], v2, s[4:7], s48 offen sc1
    s_xor_b32 s48, s62, 4096
    buffer_load_dwordx4 v[144:147], v2, s[4:7], s48 offen sc1
    s_xor_b32 s48, s62, 5120
    buffer_load_dwordx4 v[148:151], v2, s[4:7], s48 offen sc1
    s_xor_b32 s48, s62, 6144
    buffer_load_dwordx4 v[152:155], v2, s[4:7], s48 offen sc1
    s_xor_b32 s48, s62, 7168
    buffer_load_dwordx4 v[156:159], v2, s[4:7], s48 offen sc1
    s_xor_b32 s48, s62, 8192
    buffer_load_dwordx4 v[160:163], v2, s[4:7], s48 offen sc1
    s_xor_b32 s48, s62, 9216
    buffer_load_dwordx4 v[164:167], v2, s[4:7], s48 offen sc1
    s_xor_b32 s48, s62, 10240
    buffer_load_dwordx4 v[168:171], v2, s[4:7], s48 offen sc1
    s_xor_b32 s48, s62, 11264
    buffer_load_dwordx4 v[172:175], v2, s[4:7], s48 offen sc1
    s_xor_b32 s48, s62, 12288
    buffer_load_dwordx4 v[176:179], v2, s[4:7], s48 offen sc1
    s_xor_b32 s48, s62, 13312
    buffer_load_dwordx4 v[180:183], v2, s[4:7], s48 offen sc1
    s_xor_b32 s48, s62, 14336
    buffer_load_dwordx4 v[184:187], v2, s[4:7], s48 offen sc1
    s_xor_b32 s48, s62, 15360
    buffer_load_dwordx4 v[188:191], v2, s[4:7], s48 offen sc1
    s_mov_b32 s97, 1
g_notyet:
    s_mov_b32 s49, 1600000
z_lw69:
    ds_read_b32 v17, v7 offset:16
    s_waitcnt lgkmcnt(0)
    v_readfirstlane_b32 s48, v17
    s_nop 1
    s_cmp_ge_u32 s48, 4
    s_cbranch_scc1 z_lwd70
    s_sleep 1
    s_sub_u32 s49, s49, 1
    s_cmp_lg_u32 s49, 0
    s_cbranch_scc1 z_lw69
z_lwd70:
    ds_read_b128 v[80:83], v5 offset:8192
    ds_read_b128 v[84:87], v5 offset:9216
    ds_read_b128 v[88:91], v5 offset:10240
    ds_read_b128 v[92:95], v5 offset:11264
    ds_read_b128 v[96:99], v5 offset:12288
    ds_read_b128 v[100:103], v5 offset:13312
    ds_read_b128 v[104:107], v5 offset:14336
    ds_read_b128 v[108:111], v5 offset:15360
    s_lshl_b32 s47, s96, 15
    s_lshl_b32 s48, s58, 7
    s_add_u32 s47, s47, s48
    s_lshl_b32 s48, s60, 6
    s_add_u32 s63, s47, s48
    v_and_b32 v3, 31, v1
    v_lshlrev_b32 v3, 10, v3
    v_lshrrev_b32 v4, 5, v1
    v_lshl_add_u32 v6, v4, 4, v3
    s_add_u32 s3, s61, 4096
    s_waitcnt lgkmcnt(4)
    v_add_f32 v48, v48, v80
    v_add_f32 v49, v49, v81
    v_add_f32 v50, v50, v82
    v_add_f32 v51, v51, v83
    v_add_f32 v52, v52, v84
    v_add_f32 v53, v53, v85
    v_add_f32 v54, v54, v86
    v_add_f32 v55, v55, v87
    v_add_f32 v56, v56, v88
    v_add_f32 v57, v57, v89
    v_add_f32 v58, v58, v90
    v_add_f32 v59, v59, v91
    v_add_f32 v60, v60, v92
    v_add_f32 v61, v61, v93
    v_add_f32 v62, v62, v94
    v_add_f32 v63, v63, v95
    s_waitcnt lgkmcnt(0)
    v_add_f32 v64, v64, v96
    v_add_f32 v65, v65, v97
    v_add_f32 v66, v66, v98
    v_add_f32 v67, v67, v99
    v_add_f32 v68, v68, v100
    v_add_f32 v69, v69, v101
    v_add_f32 v70, v70, v102
    v_add_f32 v71, v71, v103
    v_add_f32 v72, v72, v104
    v_add_f32 v73, v73, v105
    v_add_f32 v74, v74, v106
    v_add_f32 v75, v75, v107
    v_add_f32 v76, v76, v108
    v_add_f32 v77, v77, v109
    v_add_f32 v78, v78, v110
    v_add_f32 v79, v79, v111
    s_cmp_lg_u32 s97, 0
    s_cbranch_scc1 g_have
    s_mov_b32 s49, 200000
z_poll71:
    buffer_load_dword v17, v11, s[4:7], 0 offen sc1
z_pchk73:
    s_waitcnt vmcnt(0)
    v_cmp_ne_u32 vcc, s50, v17
    s_nop 1
    s_and_b32 vcc_lo, vcc_lo, vcc_lo
    s_cbranch_scc0 z_pdone72
    s_sleep 2
    s_sub_u32 s49, s49, 1
    s_cmp_lg_u32 s49, 0
    s_cbranch_scc1 z_poll71
z_pdone72:
    s_xor_b32 s48, s62, 0
    buffer_load_dwordx4 v[128:131], v2, s[4:7], s48 offen sc1
    s_xor_b32 s48, s62, 1024
    buffer_load_dwordx4 v[132:135], v2, s[4:7], s48 offen sc1
    s_xor_b32 s48, s62, 2048
    buffer_load_dwordx4 v[136:139], v2, s[4:7], s48 offen sc1
    s_xor_b32 s48, s62, 3072
    buffer_load_dwordx4 v[140:143], v2, s[4:7], s48 offen sc1
    s_xor_b32 s48, s62, 4096
    buffer_load_dwordx4 v[144:147], v2, s[4:7], s48 offen sc1
    s_xor_b32 s48, s62, 5120
    buffer_load_dwordx4 v[148:151], v2, s[4:7], s48 offen sc1
    s_xor_b32 s48, s62, 6144
    buffer_load_dwordx4 v[152:155], v2, s[4:7], s48 offen sc1
    s_xor_b32 s48, s62, 7168
    buffer_load_dwordx4 v[156:159], v2, s[4:7], s48 offen sc1
    s_xor_b32 s48, s62, 8192
    buffer_load_dwordx4 v[160:163], v2, s[4:7], s48 offen sc1
    s_xor_b32 s48, s62, 9216
    buffer_load_dwordx4 v[164:167], v2, s[4:7], s48 offen sc1
    s_xor_b32 s48, s62, 10240
    buffer_load_dwordx4 v[168:171], v2, s[4:7], s48 offen sc1
    s_xor_b32 s48, s62, 11264
    buffer_load_dwordx4 v[172:175], v2, s[4:7], s48 offen sc1
    s_xor_b32 s48, s62, 12288
    buffer_load_dwordx4 v[176:179], v2, s[4:7], s48 offen sc1
    s_xor_b32 s48, s62, 13312
    buffer_load_dwordx4 v[180:183], v2, s[4:7], s48 offen sc1
    s_xor_b32 s48, s62, 14336
    buffer_load_dwordx4 v[184:187], v2, s[4:7], s48 offen sc1
    s_xor_b32 s48, s62, 15360
    buffer_load_dwordx4 v[188:191], v2, s[4:7], s48 offen sc1
g_have:
    v_xor_b32 v15, 0x0, v30
    v_xor_b32 v18, 0x0, v31
    ds_read_b64_tr_b16 v[112:113], v15 offset:8192
    ds_read_b64_tr_b16 v[114:115], v15 offset:9216
    ds_read_b64_tr_b16 v[116:117], v18 offset:8192
    ds_read_b64_tr_b16 v[118:119], v18 offset:9216
    ds_read_b64_tr_b16 v[120:121], v15 offset:10240
    ds_read_b64_tr_b16 v[122:123], v15 offset:11264
    ds_read_b64_tr_b16 v[124:125], v18 offset:10240
    ds_read_b64_tr_b16 v[126:127], v18 offset:11264
    ds_read_b64_tr_b16 v[192:193], v15 offset:12288
    ds_read_b64_tr_b16 v[194:195], v15 offset:13312
    ds_read_b64_tr_b16 v[196:197], v18 offset:12288
    ds_read_b64_tr_b16 v[198:199], v18 offset:13312
    s_waitcnt vmcnt(15) lgkmcnt(8)
    v_mfma_f32_32x32x16_bf16 v[64:79], v[116:119], v[128:131], v[64:79]
    v_mfma_f32_32x32x16_bf16 v[48:63], v[112:115], v[128:131], v[48:63]
    ds_read_b64_tr_b16 v[112:113], v15 offset:14336
    ds_read_b64_tr_b16 v[114:115], v15 offset:15360
    ds_read_b64_tr_b16 v[116:117], v18 offset:14336
    ds_read_b64_tr_b16 v[118:119], v18 offset:15360
    s_waitcnt vmcnt(14) lgkmcnt(8)
    v_mfma_f32_32x32x16_bf16 v[64:79], v[124:127], v[132:135], v[64:79]
    v_mfma_f32_32x32x16_bf16 v[48:63], v[120:123], v[132:135], v[48:63]
    v_xor_b32 v15, 0x10000, v30
    v_xor_b32 v18, 0x10000, v31
    ds_read_b64_tr_b16 v[120:121], v15 offset:0
    ds_read_b64_tr_b16 v[122:123], v15 offset:1024
    ds_read_b64_tr_b16 v[124:125], v18 offset:0
    ds_read_b64_tr_b16 v[126:127], v18 offset:1024
    s_waitcnt vmcnt(13) lgkmcnt(8)
    v_mfma_f32_32x32x16_bf16 v[64:79], v[196:199], v[136:139], v[64:79]
    v_mfma_f32_32x32x16_bf16 v[48:63], v[192:195], v[136:139], v[48:63]
    ds_read_b64_tr_b16 v[192:193], v15 offset:2048
    ds_read_b64_tr_b16 v[194:195], v15 offset:3072
    ds_read_b64_tr_b16 v[196:197], v18 offset:2048
    ds_read_b64_tr_b16 v[198:199], v18 offset:3072
    s_waitcnt vmcnt(12) lgkmcnt(8)
    v_mfma_f32_32x32x16_bf16 v[64:79], v[116:119], v[140:143], v[64:79]
    v_mfma_f32_32x32x16_bf16 v[48:63], v[112:115], v[140:143], v[48:63]
    ds_read_b64_tr_b16 v[112:113], v15 offset:4096
    ds_read_b64_tr_b16 v[114:115], v15 offset:5120
    ds_read_b64_tr_b16 v[116:117], v18 offset:4096
    ds_read_b64_tr_b16 v[118:119], v18 offset:5120
    s_waitcnt vmcnt(11) lgkmcnt(8)
    v_mfma_f32_32x32x16_bf16 v[64:79], v[124:127], v[144:147], v[64:79]
    v_mfma_f32_32x32x16_bf16 v[48:63], v[120:123], v[144:147], v[48:63]
    ds_read_b64_tr_b16 v[120:121], v15 offset:6144
    ds_read_b64_tr_b16 v[122:123], v15 offset:7168
    ds_read_b64_tr_b16 v[124:125], v18 offset:6144
    ds_read_b64_tr_b16 v[126:127], v18 offset:7168
    s_waitcnt vmcnt(10) lgkmcnt(8)
    v_mfma_f32_32x32x16_bf16 v[64:79], v[196:199], v[148:151], v[64:79]
    v_mfma_f32_32x32x16_bf16 v[48:63], v[192:195], v[148:151], v[48:63]
    v_xor_b32 v15, 0x4000, v30
    v_xor_b32 v18, 0x4000, v31
    ds_read_b64_tr_b16 v[192:193], v15 offset:8192
    ds_read_b64_tr_b16 v[194:195], v15 offset:9216
    ds_read_b64_tr_b16 v[196:197], v18 offset:8192
    ds_read_b64_tr_b16 v[198:199], v18 offset:9216
    s_waitcnt vmcnt(9) lgkmcnt(8)
    v_mfma_f32_32x32x16_bf16 v[64:79], v[116:119], v[152:155], v[64:79]
    v_mfma_f32_32x32x16_bf16 v[48:63], v[112:115], v[152:155], v[48:63]
    ds_read_b64_tr_b16 v[112:113], v15 offset:10240
    ds_read_b64_tr_b16 v[114:115], v15 offset:11264
    ds_read_b64_tr_b16 v[116:117], v18 offset:10240
    ds_read_b64_tr_b16 v[118:119], v18 offset:11264
    s_waitcnt vmcnt(8) lgkmcnt(8)
    v_mfma_f32_32x32x16_bf16 v[64:79], v[124:127], v[156:159], v[64:79]
    v_mfma_f32_32x32x16_bf16 v[48:63], v[120:123], v[156:159], v[48:63]
    ds_read_b64_tr_b16 v[120:121], v15 offset:12288
    ds_read_b64_tr_b16 v[122:123], v15 offset:13312
    ds_read_b64_tr_b16 v[124:125], v18 offset:12288
    ds_read_b64_tr_b16 v[126:127], v18 offset:13312
    s_waitcnt vmcnt(7) lgkmcnt(8)
    v_mfma_f32_32x32x16_bf16 v[64:79], v[196:199], v[160:163], v[64:79]
    v_mfma_f32_32x32x16_bf16 v[48:63], v[192:195], v[160:163], v[48:63]
    ds_read_b64_tr_b16 v[192:193], v15 offset:14336
    ds_read_b64_tr_b16 v[194:195], v15 offset:15360
    ds_read_b64_tr_b16 v[196:197], v18 offset:14336
    ds_read_b64_tr_b16 v[198:199], v18 offset:15360
    s_waitcnt vmcnt(6) lgkmcnt(8)
    v_mfma_f32_32x32x16_bf16 v[64:79], v[116:119], v[164:167], v[64:79]
    v_mfma_f32_32x32x16_bf16 v[48:63], v[112:115], v[164:167], v[48:63]
    v_xor_b32 v15, 0x14000, v30
    v_xor_b32 v18, 0x14000, v31
    ds_read_b64_tr_b16 v[112:113], v15 offset:0
    ds_read_b64_tr_b16 v[114:115], v15 offset:1024
    ds_read_b64_tr_b16 v[116:117], v18 offset:0
    ds_read_b64_tr_b16 v[118:119], v18 offset:1024
    s_waitcnt vmcnt(5) lgkmcnt(8)
    v_mfma_f32_32x32x16_bf16 v[64:79], v[124:127], v[168:171], v[64:79]
    v_mfma_f32_32x32x16_bf16 v[48:63], v[120:123], v[168:171], v[48:63]
    ds_read_b64_tr_b16 v[120:121], v15 offset:2048
    ds_read_b64_tr_b16 v[122:123], v15 offset:3072
    ds_read_b64_tr_b16 v[124:125], v18 offset:2048
    ds_read_b64_tr_b16 v[126:127], v18 offset:3072
    s_waitcnt vmcnt(4) lgkmcnt(8)
    v_mfma_f32_32x32x16_bf16 v[64:79], v[196:199], v[172:175], v[64:79]
    v_mfma_f32_32x32x16_bf16 v[48:63], v[192:195], v[172:175], v[48:63]
    ds_read_b64_tr_b16 v[192:193], v15 offset:4096
    ds_read_b64_tr_b16 v[194:195], v15 offset:5120
    ds_read_b64_tr_b16 v[196:197], v18 offset:4096
    ds_read_b64_tr_b16 v[198:199], v18 offset:5120
    s_waitcnt vmcnt(3) lgkmcnt(8)
    v_mfma_f32_32x32x16_bf16 v[64:79], v[116:119], v[176:179], v[64:79]
    v_mfma_f32_32x32x16_bf16 v[48:63], v[112:115], v[176:179], v[48:63]
    ds_read_b64_tr_b16 v[112:113], v15 offset:6144
    ds_read_b64_tr_b16 v[114:115], v15 offset:7168
    ds_read_b64_tr_b16 v[116:117], v18 offset:6144
    ds_read_b64_tr_b16 v[118:119], v18 offset:7168
    s_waitcnt vmcnt(2) lgkmcnt(8)
    v_mfma_f32_32x32x16_bf16 v[64:79], v[124:127], v[180:183], v[64:79]
    v_mfma_f32_32x32x16_bf16 v[48:63], v[120:123], v[180:183], v[48:63]
    s_waitcnt vmcnt(1) lgkmcnt(4)
    v_mfma_f32_32x32x16_bf16 v[64:79], v[196:199], v[184:187], v[64:79]
    v_mfma_f32_32x32x16_bf16 v[48:63], v[192:195], v[184:187], v[48:63]
    s_waitcnt vmcnt(0) lgkmcnt(0)
    v_mfma_f32_32x32x16_bf16 v[64:79], v[116:119], v[188:191], v[64:79]
    v_mfma_f32_32x32x16_bf16 v[48:63], v[112:115], v[188:191], v[48:63]
    v_add_u32 v3, s3, v2
    v_xor_b32 v4, 0x8000, v3
    s_nop 8
    ds_write_b128 v3, v[64:67] offset:0
    ds_write_b128 v3, v[68:71] offset:1024
    ds_write_b128 v3, v[72:75] offset:2048
    ds_write_b128 v3, v[76:79] offset:3072
    s_waitcnt lgkmcnt(0)
    s_mov_b64 exec, 1
    ds_add_u32 v7, v8 offset:28
    s_mov_b64 exec, -1
    s_mov_b32 s49, 1600000
z_lw74:
    ds_read_b32 v17, v7 offset:28
    s_waitcnt lgkmcnt(0)
    v_readfirstlane_b32 s48, v17
    s_nop 1
    s_cmp_ge_u32 s48, 4
    s_cbranch_scc1 z_lwd75
    s_sleep 1
    s_sub_u32 s49, s49, 1
    s_cmp_lg_u32 s49, 0
    s_cbranch_scc1 z_lw74
z_lwd75:
    ds_read_b128 v[80:83], v4 offset:0
    ds_read_b128 v[84:87], v4 offset:1024
    ds_read_b128 v[88:91], v4 offset:2048
    ds_read_b128 v[92:95], v4 offset:3072
    s_waitcnt lgkmcnt(3)
    v_add_f32 v48, v48, v80
    v_add_f32 v49, v49, v81
    v_add_f32 v50, v50, v82
    v_add_f32 v51, v51, v83
    s_waitcnt lgkmcnt(2)
    v_add_f32 v52, v52, v84
    v_add_f32 v53, v53, v85
    v_add_f32 v54, v54, v86
    v_add_f32 v55, v55, v87
    s_waitcnt lgkmcnt(1)
    v_add_f32 v56, v56, v88
    v_add_f32 v57, v57, v89
    v_add_f32 v58, v58, v90
    v_add_f32 v59, v59, v91
    s_waitcnt lgkmcnt(0)
    v_add_f32 v60, v60, v92
    v_add_f32 v61, v61, v93
    v_add_f32 v62, v62, v94
    v_add_f32 v63, v63, v95
    v_cvt_pk_bf16_f32 v64, v48, v49
    v_cvt_pk_bf16_f32 v65, v50, v51
    v_cvt_pk_bf16_f32 v66, v52, v53
    v_cvt_pk_bf16_f32 v67, v54, v55
    v_cvt_pk_bf16_f32 v68, v56, v57
    v_cvt_pk_bf16_f32 v69, v58, v59
    v_cvt_pk_bf16_f32 v70, v60, v61
    v_cvt_pk_bf16_f32 v71, v62, v63
    s_nop 1
    v_permlane32_swap_b32 v64, v66
    v_permlane32_swap_b32 v65, v67
    v_permlane32_swap_b32 v68, v70
    v_permlane32_swap_b32 v69, v71
    buffer_store_dwordx4 v[64:67], v6, s[8:11], s63 offen
    buffer_store_dwordx4 v[68:71], v6, s[8:11], s63 offen offset:32
k_end:
    s_endpgm
k_codeend:
.section .rodata,"a"
.p2align 6
.amdhsa_kernel gated_mix__softmax_full_mha__mixer_s_mlp__prompt_kernel
  .amdhsa_next_free_vgpr 256
  .amdhsa_next_free_sgpr 102
  .amdhsa_accum_offset 256
  .amdhsa_group_segment_fixed_size 0
  .amdhsa_kernarg_size 96
  .amdhsa_user_sgpr_count 2
  .amdhsa_user_sgpr_kernarg_segment_ptr 1
  .amdhsa_system_sgpr_workgroup_id_x 1
.end_amdhsa_kernel
```
